```python
import torch

def _softmax(x, axis=-1):
    return torch.softmax(x, dim=axis)
def _gelu(x):
    return torch.nn.functional.gelu(x, approximate="tanh")
def _silu(x):
    return torch.nn.functional.silu(x)
def _sigmoid(x):
    return torch.sigmoid(x)
def _layernorm(x, axis=-1, eps=1e-5):
    m = x.mean(dim=axis, keepdim=True)
    v = x.var(dim=axis, keepdim=True, unbiased=False)
    return (x - m) / torch.sqrt(v + eps)
def _scatter_add(tgt, idx, src, axis=0):
    return tgt.clone().index_add_(axis, idx, src)
def _segment_sum(src, seg, n):
    out = torch.zeros((n,) + src.shape[1:], dtype=src.dtype)
    return out.index_add_(0, seg, src)
def _pad(x, pw):
    flat = tuple(v for pair in reversed(pw) for v in pair)
    return torch.nn.functional.pad(x, flat)

kernel_name = 'sequential_preLN__sliding_block__swiglu_ffn__prompt'

def setup_inputs():

    _w = (lambda a: (lambda t: t.to(torch.bfloat16) if t.is_floating_point() else t)(torch.as_tensor(a)))
    def _A_setup():
        B, S, D = 1, 2048, 576
        return {
            "x": _w((lambda *s: torch.randn(*s, dtype=torch.bfloat16) * 0.05)(B, S, D)),
            "wqkv": _w((lambda *s: torch.randn(*s, dtype=torch.bfloat16) * 0.05)(D, 3 * D)),
            "wo": _w((lambda *s: torch.randn(*s, dtype=torch.bfloat16) * 0.05)(D, D)),
        }
    _A_in = _A_setup()

    def _B_setup():
        B, S, D, F = 1, 2048, 576, 4608
        return {
            "x": _w((lambda *s: torch.randn(*s, dtype=torch.bfloat16) * 0.05)(B, S, D)),
            "w_gate": _w((lambda *s: torch.randn(*s, dtype=torch.bfloat16) * 0.05)(D, F)),
            "w_up": _w((lambda *s: torch.randn(*s, dtype=torch.bfloat16) * 0.05)(D, F)),
            "w_down": _w((lambda *s: torch.randn(*s, dtype=torch.bfloat16) * 0.05)(F, D)),
        }
    _B_in = _B_setup()

    return {
        "A_x": _A_in["x"],
        "A_wqkv": _A_in["wqkv"],
        "A_wo": _A_in["wo"],
        "B_x": _B_in["x"],
        "B_w_gate": _B_in["w_gate"],
        "B_w_up": _B_in["w_up"],
        "B_w_down": _B_in["w_down"],
    }

def reference(A_x, A_wqkv, A_wo, B_x, B_w_gate, B_w_up, B_w_down):
    def _A_ref(x, wqkv, wo):
        B, S, D = x.shape
        H = 32; Dh = D // H; W = 256
        qkv = (lambda x, *d: x.permute(*d))((x @ wqkv).reshape(B, S, 3, H, Dh), 2, 0, 3, 1, 4)
        q, k, v = qkv[0], qkv[1], qkv[2]
        scores = torch.einsum("bhqd,bhkd->bhqk", q, k) * (Dh ** -0.5)
        idx = torch.arange(S)
        mask = (idx[:, None] - idx[None, :] >= 0) & (idx[:, None] - idx[None, :] < W)
        scores = torch.where(mask[None, None], scores, -1e9)
        p = _softmax(scores, axis=-1)
        o = torch.einsum("bhqk,bhkd->bhqd", p, v)
        return (lambda x, *d: x.permute(*d))(o, 0, 2, 1, 3).reshape(B, S, D) @ wo

    def _B_ref(x, w_gate, w_up, w_down):
        g = _silu(x @ w_gate)
        u = x @ w_up
        return (g * u) @ w_down

    x = A_x
    h = x + _A_ref(_layernorm(x, axis=-1), A_wqkv, A_wo)
    h2 = h + _B_ref(_layernorm(h, axis=-1), B_w_gate, B_w_up, B_w_down)
    return h2
```

```asm
; @launch grid=(256,1,1) block=(256,1,1) lds=163840
.amdgcn_target "amdgcn-amd-amdhsa--gfx950"
.text
.globl sequential_preLN__sliding_block__swiglu_ffn__prompt_kernel
.p2align 8
.type sequential_preLN__sliding_block__swiglu_ffn__prompt_kernel,@function
sequential_preLN__sliding_block__swiglu_ffn__prompt_kernel:
    s_cmp_ge_u32 s2, 256
    s_cbranch_scc1 L_exit
    s_load_dwordx4 s[64:67], s[0:1], 0
    s_load_dwordx2 s[68:69], s[0:1], 16
    s_load_dwordx8 s[72:79], s[0:1], 32
    s_load_dwordx4 s[4:7], s[0:1], 64
    v_lshrrev_b32 v1, 6, v0
    v_and_b32 v0, 63, v0
    v_readfirstlane_b32 s3, v1
    s_cmp_ge_u32 s2, 224
    s_cbranch_scc1 L_p1_aux
    s_and_b32 s10, s2, 7
    s_lshr_b32 s11, s2, 3
    s_and_b32 s12, s10, 3
    s_lshl_b32 s12, s12, 2
    s_and_b32 s13, s11, 3
    s_add_u32 s12, s12, s13
    s_lshr_b32 s13, s10, 2
    s_mul_i32 s13, s13, 7
    s_lshr_b32 s14, s11, 2
    s_add_u32 s13, s13, s14
    s_and_b32 s15, s11, 3
    s_mul_i32 s15, s15, 1
    s_mul_i32 s14, s14, 4
    s_add_u32 s28, s14, s15
    s_mul_i32 s14, s28, 57
    s_lshr_b32 s14, s14, 9
    s_mul_i32 s14, s14, 9
    s_sub_u32 s28, s28, s14
    v_lshrrev_b32 v1, 3, v0
    s_lshl_b32 s14, s12, 7
    s_lshl_b32 s15, s3, 5
    s_add_u32 s44, s14, s15
    v_add_u32 v5, s44, v1
    v_mul_u32_u24 v5, 1152, v5
    s_lshl_b32 s15, s28, 7
    v_add_u32 v5, s15, v5
    v_lshrrev_b32 v62, 4, v0
    v_and_b32 v63, 7, v0
    v_xor_b32 v62, v62, v63
    v_lshl_add_u32 v2, v62, 4, v5
    v_xor_b32 v62, 4, v62
    v_lshl_add_u32 v3, v62, 4, v5
    s_and_b32 s14, s3, 1
    s_lshl_b32 s14, s14, 3
    v_add_u32 v5, s14, v1
    v_mul_u32_u24 v5, 3456, v5
    v_lshrrev_b32 v62, 2, v0
    v_and_b32 v62, 4, v62
    v_xor_b32 v62, v62, v63
    v_lshl_add_u32 v5, v62, 4, v5
    s_lshl_b32 s14, s13, 8
    s_lshr_b32 s15, s3, 1
    s_lshl_b32 s15, s15, 7
    s_add_u32 s14, s14, s15
    s_mul_i32 s15, s28, 221184
    s_add_u32 s14, s14, s15
    v_add_u32 v4, s14, v5
    s_mov_b32 s33, 8192
    s_mov_b32 s37, 54272
    s_mov_b32 s34, 16384
    s_mov_b32 s38, 108544
    s_mov_b32 s35, 24576
    s_mov_b32 s39, 162816
    s_lshl_b32 s29, s3, 12
    s_waitcnt lgkmcnt(0)
    s_mov_b32 s16, s64
    s_mov_b32 s17, s65
    s_mov_b32 s18, 2359296
    s_mov_b32 s19, 0x20000
    s_mov_b32 s20, s66
    s_mov_b32 s21, s67
    s_mov_b32 s22, 1990656
    s_mov_b32 s23, 0x20000
    s_mov_b32 s24, s6
    s_mov_b32 s25, s7
    s_mov_b32 s26, 268435456
    s_mov_b32 s27, 0x20000
    s_mov_b32 s48, s4
    s_mov_b32 s49, s5
    s_mov_b32 s50, 256
    s_mov_b32 s51, 0x20000
    s_mov_b32 m0, s29
    s_cmp_eq_u32 s28, 8
    s_cselect_b32 s30, -8, 1
    buffer_load_dwordx4 v2, s[16:19], 0 offen lds
    s_cselect_b32 s28, -1, s28
    s_mul_i32 s31, s30, 221184
    buffer_load_dwordx4 v3, s[16:19], s33 offen offset:1024 lds
    s_mul_i32 s30, s30, 128
    s_add_u32 s28, s28, 1
    buffer_load_dwordx4 v2, s[16:19], s34 offen offset:2048 lds
    buffer_load_dwordx4 v3, s[16:19], s35 offen offset:3072 lds
    s_add_u32 m0, s29, 81920
    v_add_u32 v2, s30, v2
    buffer_load_dwordx4 v4, s[20:23], 0 offen lds
    s_add_u32 s29, s29, 16384
    buffer_load_dwordx4 v4, s[20:23], s37 offen offset:1024 lds
    v_add_u32 v3, s30, v3
    s_cmp_ge_u32 s29, 81920
    buffer_load_dwordx4 v4, s[20:23], s38 offen offset:2048 lds
    s_cselect_b32 s43, 81920, 0
    s_sub_u32 s29, s29, s43
    buffer_load_dwordx4 v4, s[20:23], s39 offen offset:3072 lds
    v_add_u32 v4, s31, v4
    v_and_b32 v1, 31, v0
    v_lshlrev_b32 v5, 7, v1
    s_lshl_b32 s14, s3, 12
    v_add_u32 v5, s14, v5
    v_lshrrev_b32 v1, 1, v1
    v_and_b32 v1, 7, v1
    v_lshrrev_b32 v62, 5, v0
    v_xor_b32 v1, v1, v62
    v_xor_b32 v63, 0, v1
    v_lshl_add_u32 v6, v63, 4, v5
    v_xor_b32 v63, 2, v1
    v_lshl_add_u32 v7, v63, 4, v5
    v_xor_b32 v63, 4, v1
    v_lshl_add_u32 v8, v63, 4, v5
    v_xor_b32 v63, 6, v1
    v_lshl_add_u32 v9, v63, 4, v5
    v_lshlrev_b32 v5, 12, v62
    v_add_u32 v5, 81920, v5
    v_lshrrev_b32 v1, 2, v0
    v_and_b32 v1, 3, v1
    v_lshl_add_u32 v5, v1, 7, v5
    v_and_b32 v63, 1, v0
    v_lshl_add_u32 v5, v63, 3, v5
    v_and_b32 v1, 2, v1
    v_lshlrev_b32 v1, 1, v1
    v_lshrrev_b32 v63, 3, v0
    v_and_b32 v63, 2, v63
    v_or_b32 v1, v1, v63
    v_lshrrev_b32 v63, 1, v0
    v_and_b32 v63, 1, v63
    v_or_b32 v1, v1, v63
    s_xor_b32 s14, s3, 0
    s_and_b32 s15, s14, 1
    s_lshl_b32 s15, s15, 2
    s_lshr_b32 s14, s14, 1
    s_lshl_b32 s14, s14, 13
    v_xor_b32 v63, s15, v1
    v_lshl_add_u32 v63, v63, 4, v5
    v_add_u32 v10, s14, v63
    s_xor_b32 s14, s3, 1
    s_and_b32 s15, s14, 1
    s_lshl_b32 s15, s15, 2
    s_lshr_b32 s14, s14, 1
    s_lshl_b32 s14, s14, 13
    v_xor_b32 v63, s15, v1
    v_lshl_add_u32 v63, v63, 4, v5
    v_add_u32 v11, s14, v63
    s_xor_b32 s14, s3, 2
    s_and_b32 s15, s14, 1
    s_lshl_b32 s15, s15, 2
    s_lshr_b32 s14, s14, 1
    s_lshl_b32 s14, s14, 13
    v_xor_b32 v63, s15, v1
    v_lshl_add_u32 v63, v63, 4, v5
    v_add_u32 v12, s14, v63
    s_xor_b32 s14, s3, 3
    s_and_b32 s15, s14, 1
    s_lshl_b32 s15, s15, 2
    s_lshr_b32 s14, s14, 1
    s_lshl_b32 s14, s14, 13
    v_xor_b32 v63, s15, v1
    v_lshl_add_u32 v63, v63, 4, v5
    v_add_u32 v13, s14, v63
    v_lshrrev_b32 v1, 2, v0
    v_lshrrev_b32 v5, 4, v0
    v_xor_b32 v1, v1, v5
    v_and_b32 v1, 1, v1
    v_cmp_eq_u32 vcc, 0, v1
    v_mov_b32 v5, 0x3f803f80
    v_and_b32 v60, 31, v0
    v_lshlrev_b32 v60, 2, v60
    v_cndmask_b32 v14, 0, v5, vcc
    v_mov_b32 v15, v14
    v_mov_b32 v16, v14
    v_mov_b32 v17, v14
    v_mov_b32 v61, 32
    v_mov_b32 v76, 0
    v_mov_b32 v77, 0
    v_mov_b32 v78, 0
    v_mov_b32 v79, 0
    v_mov_b32 v80, 0
    v_mov_b32 v81, 0
    v_mov_b32 v82, 0
    v_mov_b32 v83, 0
    v_mov_b32 v84, 0
    v_mov_b32 v85, 0
    v_mov_b32 v86, 0
    v_mov_b32 v87, 0
    v_mov_b32 v88, 0
    v_mov_b32 v89, 0
    v_mov_b32 v90, 0
    v_mov_b32 v91, 0
    v_mov_b32 v92, 0
    v_mov_b32 v93, 0
    v_mov_b32 v94, 0
    v_mov_b32 v95, 0
    v_mov_b32 v96, 0
    v_mov_b32 v97, 0
    v_mov_b32 v98, 0
    v_mov_b32 v99, 0
    v_mov_b32 v100, 0
    v_mov_b32 v101, 0
    v_mov_b32 v102, 0
    v_mov_b32 v103, 0
    v_mov_b32 v104, 0
    v_mov_b32 v105, 0
    v_mov_b32 v106, 0
    v_mov_b32 v107, 0
    v_mov_b32 v108, 0
    v_mov_b32 v109, 0
    v_mov_b32 v110, 0
    v_mov_b32 v111, 0
    v_mov_b32 v112, 0
    v_mov_b32 v113, 0
    v_mov_b32 v114, 0
    v_mov_b32 v115, 0
    v_mov_b32 v116, 0
    v_mov_b32 v117, 0
    v_mov_b32 v118, 0
    v_mov_b32 v119, 0
    v_mov_b32 v120, 0
    v_mov_b32 v121, 0
    v_mov_b32 v122, 0
    v_mov_b32 v123, 0
    v_mov_b32 v124, 0
    v_mov_b32 v125, 0
    v_mov_b32 v126, 0
    v_mov_b32 v127, 0
    v_mov_b32 v128, 0
    v_mov_b32 v129, 0
    v_mov_b32 v130, 0
    v_mov_b32 v131, 0
    v_mov_b32 v132, 0
    v_mov_b32 v133, 0
    v_mov_b32 v134, 0
    v_mov_b32 v135, 0
    v_mov_b32 v136, 0
    v_mov_b32 v137, 0
    v_mov_b32 v138, 0
    v_mov_b32 v139, 0
    v_mov_b32 v140, 0
    v_mov_b32 v141, 0
    v_mov_b32 v142, 0
    v_mov_b32 v143, 0
    s_mov_b32 s40, 0
    s_mov_b32 s41, 0
    v_and_b32 v1, 31, v0
    v_add_u32 v1, s44, v1
    v_lshlrev_b32 v64, 4, v1
    v_lshrrev_b32 v65, 5, v0
    v_lshlrev_b32 v65, 4, v65
    s_mov_b32 s45, 14942208
    s_lshl_b32 s46, s44, 2
    s_add_u32 s46, s46, 14974976
    s_mov_b32 s52, 0
    s_lshl_b32 s53, s3, 5
    s_mov_b32 m0, s29
    s_cmp_eq_u32 s28, 8
    s_cselect_b32 s30, -8, 1
    buffer_load_dwordx4 v2, s[16:19], 0 offen lds
    s_cselect_b32 s28, -1, s28
    s_mul_i32 s31, s30, 221184
    buffer_load_dwordx4 v3, s[16:19], s33 offen offset:1024 lds
    s_mul_i32 s30, s30, 128
    s_add_u32 s28, s28, 1
    buffer_load_dwordx4 v2, s[16:19], s34 offen offset:2048 lds
    buffer_load_dwordx4 v3, s[16:19], s35 offen offset:3072 lds
    s_add_u32 m0, s29, 81920
    v_add_u32 v2, s30, v2
    buffer_load_dwordx4 v4, s[20:23], 0 offen lds
    s_add_u32 s29, s29, 16384
    buffer_load_dwordx4 v4, s[20:23], s37 offen offset:1024 lds
    v_add_u32 v3, s30, v3
    s_cmp_ge_u32 s29, 81920
    buffer_load_dwordx4 v4, s[20:23], s38 offen offset:2048 lds
    s_cselect_b32 s43, 81920, 0
    s_sub_u32 s29, s29, s43
    buffer_load_dwordx4 v4, s[20:23], s39 offen offset:3072 lds
    v_add_u32 v4, s31, v4
    s_waitcnt vmcnt(8)
    s_barrier
    ds_read_b128 v[20:23], v6
    ds_read_b64_tr_b16 v[28:29], v10 offset:0
    ds_read_b64_tr_b16 v[30:31], v10 offset:512
    ds_read_b64_tr_b16 v[32:33], v11 offset:0
    ds_read_b64_tr_b16 v[34:35], v11 offset:512
    ds_read_b64_tr_b16 v[36:37], v12 offset:0
    ds_read_b64_tr_b16 v[38:39], v12 offset:512
    ds_read_b64_tr_b16 v[40:41], v13 offset:0
    ds_read_b64_tr_b16 v[42:43], v13 offset:512
    s_cmp_ge_u32 s13, 9
    s_cbranch_scc1 L_p1_v
L_p1_loopT:
    s_waitcnt lgkmcnt(4)
    v_mfma_f32_32x32x16_bf16 v[80:95], v[28:31], v[20:23], v[80:95]
    ds_read_b128 v[24:27], v7
    ds_read_b64_tr_b16 v[44:45], v10 offset:1024
    ds_read_b64_tr_b16 v[46:47], v10 offset:1536
    s_mov_b32 m0, s29
    s_cmp_eq_u32 s28, 8
    s_cselect_b32 s30, -8, 1
    buffer_load_dwordx4 v2, s[16:19], 0 offen lds
    s_cselect_b32 s28, -1, s28
    v_mfma_f32_32x32x16_bf16 v[96:111], v[32:35], v[20:23], v[96:111]
    ds_read_b64_tr_b16 v[48:49], v11 offset:1024
    ds_read_b64_tr_b16 v[50:51], v11 offset:1536
    s_mul_i32 s31, s30, 221184
    buffer_load_dwordx4 v3, s[16:19], s33 offen offset:1024 lds
    s_mul_i32 s30, s30, 128
    s_waitcnt lgkmcnt(5)
    v_mfma_f32_32x32x16_bf16 v[112:127], v[36:39], v[20:23], v[112:127]
    ds_read_b64_tr_b16 v[52:53], v12 offset:1024
    ds_read_b64_tr_b16 v[54:55], v12 offset:1536
    v_mfma_f32_32x32x16_bf16 v[128:143], v[40:43], v[20:23], v[128:143]
    ds_read_b64_tr_b16 v[56:57], v13 offset:1024
    ds_read_b64_tr_b16 v[58:59], v13 offset:1536
    s_add_u32 s28, s28, 1
    buffer_load_dwordx4 v2, s[16:19], s34 offen offset:2048 lds
    v_mfma_f32_16x16x32_bf16 v[76:79], v[14:17], v[28:31], v[76:79]
    s_waitcnt lgkmcnt(4)
    v_mfma_f32_32x32x16_bf16 v[80:95], v[44:47], v[24:27], v[80:95]
    ds_read_b128 v[20:23], v8
    ds_read_b64_tr_b16 v[28:29], v10 offset:2048
    ds_read_b64_tr_b16 v[30:31], v10 offset:2560
    buffer_load_dwordx4 v3, s[16:19], s35 offen offset:3072 lds
    v_mfma_f32_32x32x16_bf16 v[96:111], v[48:51], v[24:27], v[96:111]
    ds_read_b64_tr_b16 v[32:33], v11 offset:2048
    ds_read_b64_tr_b16 v[34:35], v11 offset:2560
    s_add_u32 m0, s29, 81920
    v_add_u32 v2, s30, v2
    buffer_load_dwordx4 v4, s[20:23], 0 offen lds
    s_waitcnt lgkmcnt(5)
    v_mfma_f32_32x32x16_bf16 v[112:127], v[52:55], v[24:27], v[112:127]
    ds_read_b64_tr_b16 v[36:37], v12 offset:2048
    ds_read_b64_tr_b16 v[38:39], v12 offset:2560
    v_mfma_f32_32x32x16_bf16 v[128:143], v[56:59], v[24:27], v[128:143]
    ds_read_b64_tr_b16 v[40:41], v13 offset:2048
    ds_read_b64_tr_b16 v[42:43], v13 offset:2560
    s_add_u32 s29, s29, 16384
    buffer_load_dwordx4 v4, s[20:23], s37 offen offset:1024 lds
    v_add_u32 v3, s30, v3
    v_mfma_f32_16x16x32_bf16 v[76:79], v[14:17], v[44:47], v[76:79]
    s_waitcnt lgkmcnt(4)
    v_mfma_f32_32x32x16_bf16 v[80:95], v[28:31], v[20:23], v[80:95]
    ds_read_b128 v[24:27], v9
    ds_read_b64_tr_b16 v[44:45], v10 offset:3072
    ds_read_b64_tr_b16 v[46:47], v10 offset:3584
    s_cmp_ge_u32 s29, 81920
    buffer_load_dwordx4 v4, s[20:23], s38 offen offset:2048 lds
    s_cselect_b32 s43, 81920, 0
    v_mfma_f32_32x32x16_bf16 v[96:111], v[32:35], v[20:23], v[96:111]
    ds_read_b64_tr_b16 v[48:49], v11 offset:3072
    ds_read_b64_tr_b16 v[50:51], v11 offset:3584
    s_sub_u32 s29, s29, s43
    buffer_load_dwordx4 v4, s[20:23], s39 offen offset:3072 lds
    v_add_u32 v4, s31, v4
    s_waitcnt lgkmcnt(5)
    v_mfma_f32_32x32x16_bf16 v[112:127], v[36:39], v[20:23], v[112:127]
    ds_read_b64_tr_b16 v[52:53], v12 offset:3072
    ds_read_b64_tr_b16 v[54:55], v12 offset:3584
    s_cmp_eq_u32 s41, 4
    s_cselect_b32 s42, -4, 1
    s_cselect_b32 s41, -1, s41
    v_mfma_f32_32x32x16_bf16 v[128:143], v[40:43], v[20:23], v[128:143]
    ds_read_b64_tr_b16 v[56:57], v13 offset:3072
    ds_read_b64_tr_b16 v[58:59], v13 offset:3584
    s_add_u32 s41, s41, 1
    s_mul_i32 s42, s42, 16384
    v_add_u32 v10, s42, v10
    v_add_u32 v11, s42, v11
    v_add_u32 v12, s42, v12
    v_mfma_f32_16x16x32_bf16 v[76:79], v[14:17], v[28:31], v[76:79]
    v_add_u32 v13, s42, v13
    v_add_u32 v6, s42, v6
    s_waitcnt lgkmcnt(4)
    v_mfma_f32_32x32x16_bf16 v[80:95], v[44:47], v[24:27], v[80:95]
    s_waitcnt vmcnt(8)
    s_cmp_lg_u32 s53, 6
    s_cbranch_scc1 L_p1_n6T
    v_cmp_ne_u32 vcc, 0, v66
    s_nop 0
    s_bcnt1_i32_b32 s52, vcc_lo
    s_nop 0
    s_cmp_ge_u32 s52, 32
    s_cbranch_scc0 L_p1_spinT
L_p1_n6T:
    s_barrier
    ds_read_b128 v[20:23], v6
    ds_read_b64_tr_b16 v[28:29], v10 offset:0
    ds_read_b64_tr_b16 v[30:31], v10 offset:512
    v_mfma_f32_32x32x16_bf16 v[96:111], v[48:51], v[24:27], v[96:111]
    ds_read_b64_tr_b16 v[32:33], v11 offset:0
    ds_read_b64_tr_b16 v[34:35], v11 offset:512
    v_add_u32 v7, s42, v7
    v_add_u32 v8, s42, v8
    v_add_u32 v9, s42, v9
    s_cmp_lg_u32 s40, 6
    s_cbranch_scc1 L_p1_n7T
    buffer_load_dwordx4 v[160:163], v64, s[24:27], s45 offen sc1
L_p1_n7T:
    s_waitcnt lgkmcnt(5)
    v_mfma_f32_32x32x16_bf16 v[112:127], v[52:55], v[24:27], v[112:127]
    ds_read_b64_tr_b16 v[36:37], v12 offset:0
    ds_read_b64_tr_b16 v[38:39], v12 offset:512
    v_mfma_f32_32x32x16_bf16 v[128:143], v[56:59], v[24:27], v[128:143]
    ds_read_b64_tr_b16 v[40:41], v13 offset:0
    ds_read_b64_tr_b16 v[42:43], v13 offset:512
    s_cmp_lg_u32 s53, 5
    s_cbranch_scc1 L_p1_n5T
    buffer_load_dword v66, v60, s[48:51], 0 offen sc1
L_p1_n5T:
    v_mfma_f32_16x16x32_bf16 v[76:79], v[14:17], v[44:47], v[76:79]
    s_cmp_ge_u32 s40, 6
    s_cselect_b32 s18, 0, s18
    s_cselect_b32 s22, 0, s22
    s_add_u32 s53, s53, 1
    s_add_u32 s40, s40, 1
    s_cmp_lt_u32 s40, 9
    s_cbranch_scc1 L_p1_loopT
    s_waitcnt vmcnt(0) lgkmcnt(0)
    s_barrier
    s_lshl_b32 s14, s3, 8
    v_lshl_add_u32 v1, v0, 2, s14
    ds_write_b32 v1, v76
    s_waitcnt lgkmcnt(0)
    s_barrier
    v_xor_b32 v62, 256, v1
    ds_read_b32 v77, v62
    v_xor_b32 v62, 512, v1
    ds_read_b32 v78, v62
    v_xor_b32 v62, 768, v1
    ds_read_b32 v79, v62
    v_cvt_pk_bf16_f32 v144, v76, v76
    v_mov_b32 v146, 0
    v_and_b32 v62, 0xffff0000, v144
    v_mov_b32 v147, 0
    v_sub_f32 v62, v76, v62
    v_cvt_pk_bf16_f32 v145, v62, 0
    s_waitcnt lgkmcnt(0)
    v_cvt_pk_bf16_f32 v148, v77, v77
    v_mov_b32 v150, 0
    v_and_b32 v62, 0xffff0000, v148
    v_mov_b32 v151, 0
    v_sub_f32 v62, v77, v62
    v_cvt_pk_bf16_f32 v149, v62, 0
    v_cvt_pk_bf16_f32 v152, v78, v78
    v_mov_b32 v154, 0
    v_and_b32 v62, 0xffff0000, v152
    v_mov_b32 v155, 0
    v_sub_f32 v62, v78, v62
    v_cvt_pk_bf16_f32 v153, v62, 0
    v_cvt_pk_bf16_f32 v156, v79, v79
    v_mov_b32 v158, 0
    v_and_b32 v62, 0xffff0000, v156
    v_mov_b32 v159, 0
    v_sub_f32 v62, v79, v62
    v_cvt_pk_bf16_f32 v157, v62, 0
    v_cmp_gt_u32 vcc, 32, v0
    v_mov_b32 v6, 0
    v_mov_b32 v7, 0
    v_cndmask_b32 v4, 0, v160, vcc
    v_cndmask_b32 v5, 0, v161, vcc
    s_nop 1
    v_mfma_f32_32x32x16_bf16 v[80:95], v[144:147], v[4:7], v[80:95]
    v_mfma_f32_32x32x16_bf16 v[96:111], v[148:151], v[4:7], v[96:111]
    v_mfma_f32_32x32x16_bf16 v[112:127], v[152:155], v[4:7], v[112:127]
    v_mfma_f32_32x32x16_bf16 v[128:143], v[156:159], v[4:7], v[128:143]
    s_lshl_b32 s14, s12, 2
    s_add_u32 s14, s14, s3
    s_mul_i32 s14, s14, 73728
    s_lshl_b32 s15, s13, 13
    s_add_u32 s14, s14, s15
    v_lshl_add_u32 v1, v0, 4, s14
    v_mul_f32 v2, 0x3eae1a93, v162
    s_xor_b32 s15, s3, 0
    s_lshl_b32 s30, s13, 2
    s_add_u32 s30, s30, s15
    s_cmp_lt_u32 s30, 18
    s_cselect_b64 vcc, -1, 0
    s_lshl_b32 s15, s15, 11
    v_cndmask_b32 v62, v162, v2, vcc
    v_mul_f32 v80, v62, v80
    v_mul_f32 v81, v62, v81
    v_mul_f32 v82, v62, v82
    v_mul_f32 v83, v62, v83
    v_mul_f32 v84, v62, v84
    v_mul_f32 v85, v62, v85
    v_mul_f32 v86, v62, v86
    v_mul_f32 v87, v62, v87
    v_cvt_pk_bf16_f32 v80, v80, v81
    v_cvt_pk_bf16_f32 v81, v82, v83
    v_cvt_pk_bf16_f32 v82, v84, v85
    v_cvt_pk_bf16_f32 v83, v86, v87
    buffer_store_dwordx4 v[80:83], v1, s[24:27], s15 offen offset:0 sc1
    v_mul_f32 v88, v62, v88
    v_mul_f32 v89, v62, v89
    v_mul_f32 v90, v62, v90
    v_mul_f32 v91, v62, v91
    v_mul_f32 v92, v62, v92
    v_mul_f32 v93, v62, v93
    v_mul_f32 v94, v62, v94
    v_mul_f32 v95, v62, v95
    v_cvt_pk_bf16_f32 v88, v88, v89
    v_cvt_pk_bf16_f32 v89, v90, v91
    v_cvt_pk_bf16_f32 v90, v92, v93
    v_cvt_pk_bf16_f32 v91, v94, v95
    buffer_store_dwordx4 v[88:91], v1, s[24:27], s15 offen offset:1024 sc1
    s_xor_b32 s15, s3, 1
    s_lshl_b32 s30, s13, 2
    s_add_u32 s30, s30, s15
    s_cmp_lt_u32 s30, 18
    s_cselect_b64 vcc, -1, 0
    s_lshl_b32 s15, s15, 11
    v_cndmask_b32 v62, v162, v2, vcc
    v_mul_f32 v96, v62, v96
    v_mul_f32 v97, v62, v97
    v_mul_f32 v98, v62, v98
    v_mul_f32 v99, v62, v99
    v_mul_f32 v100, v62, v100
    v_mul_f32 v101, v62, v101
    v_mul_f32 v102, v62, v102
    v_mul_f32 v103, v62, v103
    v_cvt_pk_bf16_f32 v96, v96, v97
    v_cvt_pk_bf16_f32 v97, v98, v99
    v_cvt_pk_bf16_f32 v98, v100, v101
    v_cvt_pk_bf16_f32 v99, v102, v103
    buffer_store_dwordx4 v[96:99], v1, s[24:27], s15 offen offset:0 sc1
    v_mul_f32 v104, v62, v104
    v_mul_f32 v105, v62, v105
    v_mul_f32 v106, v62, v106
    v_mul_f32 v107, v62, v107
    v_mul_f32 v108, v62, v108
    v_mul_f32 v109, v62, v109
    v_mul_f32 v110, v62, v110
    v_mul_f32 v111, v62, v111
    v_cvt_pk_bf16_f32 v104, v104, v105
    v_cvt_pk_bf16_f32 v105, v106, v107
    v_cvt_pk_bf16_f32 v106, v108, v109
    v_cvt_pk_bf16_f32 v107, v110, v111
    buffer_store_dwordx4 v[104:107], v1, s[24:27], s15 offen offset:1024 sc1
    s_xor_b32 s15, s3, 2
    s_lshl_b32 s30, s13, 2
    s_add_u32 s30, s30, s15
    s_cmp_lt_u32 s30, 18
    s_cselect_b64 vcc, -1, 0
    s_lshl_b32 s15, s15, 11
    v_cndmask_b32 v62, v162, v2, vcc
    v_mul_f32 v112, v62, v112
    v_mul_f32 v113, v62, v113
    v_mul_f32 v114, v62, v114
    v_mul_f32 v115, v62, v115
    v_mul_f32 v116, v62, v116
    v_mul_f32 v117, v62, v117
    v_mul_f32 v118, v62, v118
    v_mul_f32 v119, v62, v119
    v_cvt_pk_bf16_f32 v112, v112, v113
    v_cvt_pk_bf16_f32 v113, v114, v115
    v_cvt_pk_bf16_f32 v114, v116, v117
    v_cvt_pk_bf16_f32 v115, v118, v119
    buffer_store_dwordx4 v[112:115], v1, s[24:27], s15 offen offset:0 sc1
    v_mul_f32 v120, v62, v120
    v_mul_f32 v121, v62, v121
    v_mul_f32 v122, v62, v122
    v_mul_f32 v123, v62, v123
    v_mul_f32 v124, v62, v124
    v_mul_f32 v125, v62, v125
    v_mul_f32 v126, v62, v126
    v_mul_f32 v127, v62, v127
    v_cvt_pk_bf16_f32 v120, v120, v121
    v_cvt_pk_bf16_f32 v121, v122, v123
    v_cvt_pk_bf16_f32 v122, v124, v125
    v_cvt_pk_bf16_f32 v123, v126, v127
    buffer_store_dwordx4 v[120:123], v1, s[24:27], s15 offen offset:1024 sc1
    s_xor_b32 s15, s3, 3
    s_lshl_b32 s30, s13, 2
    s_add_u32 s30, s30, s15
    s_cmp_lt_u32 s30, 18
    s_cselect_b64 vcc, -1, 0
    s_lshl_b32 s15, s15, 11
    v_cndmask_b32 v62, v162, v2, vcc
    v_mul_f32 v128, v62, v128
    v_mul_f32 v129, v62, v129
    v_mul_f32 v130, v62, v130
    v_mul_f32 v131, v62, v131
    v_mul_f32 v132, v62, v132
    v_mul_f32 v133, v62, v133
    v_mul_f32 v134, v62, v134
    v_mul_f32 v135, v62, v135
    v_cvt_pk_bf16_f32 v128, v128, v129
    v_cvt_pk_bf16_f32 v129, v130, v131
    v_cvt_pk_bf16_f32 v130, v132, v133
    v_cvt_pk_bf16_f32 v131, v134, v135
    buffer_store_dwordx4 v[128:131], v1, s[24:27], s15 offen offset:0 sc1
    v_mul_f32 v136, v62, v136
    v_mul_f32 v137, v62, v137
    v_mul_f32 v138, v62, v138
    v_mul_f32 v139, v62, v139
    v_mul_f32 v140, v62, v140
    v_mul_f32 v141, v62, v141
    v_mul_f32 v142, v62, v142
    v_mul_f32 v143, v62, v143
    v_cvt_pk_bf16_f32 v136, v136, v137
    v_cvt_pk_bf16_f32 v137, v138, v139
    v_cvt_pk_bf16_f32 v138, v140, v141
    v_cvt_pk_bf16_f32 v139, v142, v143
    buffer_store_dwordx4 v[136:139], v1, s[24:27], s15 offen offset:1024 sc1
    s_branch L_p1_sig
L_p1_v:
L_p1_loopD:
    s_waitcnt lgkmcnt(4)
    v_mfma_f32_32x32x16_bf16 v[80:95], v[20:23], v[28:31], v[80:95]
    ds_read_b128 v[24:27], v7
    ds_read_b64_tr_b16 v[44:45], v10 offset:1024
    ds_read_b64_tr_b16 v[46:47], v10 offset:1536
    s_mov_b32 m0, s29
    s_cmp_eq_u32 s28, 8
    s_cselect_b32 s30, -8, 1
    buffer_load_dwordx4 v2, s[16:19], 0 offen lds
    s_cselect_b32 s28, -1, s28
    v_mfma_f32_32x32x16_bf16 v[96:111], v[20:23], v[32:35], v[96:111]
    ds_read_b64_tr_b16 v[48:49], v11 offset:1024
    ds_read_b64_tr_b16 v[50:51], v11 offset:1536
    s_mul_i32 s31, s30, 221184
    buffer_load_dwordx4 v3, s[16:19], s33 offen offset:1024 lds
    s_mul_i32 s30, s30, 128
    s_waitcnt lgkmcnt(5)
    v_mfma_f32_32x32x16_bf16 v[112:127], v[20:23], v[36:39], v[112:127]
    ds_read_b64_tr_b16 v[52:53], v12 offset:1024
    ds_read_b64_tr_b16 v[54:55], v12 offset:1536
    v_mfma_f32_32x32x16_bf16 v[128:143], v[20:23], v[40:43], v[128:143]
    ds_read_b64_tr_b16 v[56:57], v13 offset:1024
    ds_read_b64_tr_b16 v[58:59], v13 offset:1536
    s_add_u32 s28, s28, 1
    buffer_load_dwordx4 v2, s[16:19], s34 offen offset:2048 lds
    v_mfma_f32_16x16x32_bf16 v[76:79], v[14:17], v[28:31], v[76:79]
    s_waitcnt lgkmcnt(4)
    v_mfma_f32_32x32x16_bf16 v[80:95], v[24:27], v[44:47], v[80:95]
    ds_read_b128 v[20:23], v8
    ds_read_b64_tr_b16 v[28:29], v10 offset:2048
    ds_read_b64_tr_b16 v[30:31], v10 offset:2560
    buffer_load_dwordx4 v3, s[16:19], s35 offen offset:3072 lds
    v_mfma_f32_32x32x16_bf16 v[96:111], v[24:27], v[48:51], v[96:111]
    ds_read_b64_tr_b16 v[32:33], v11 offset:2048
    ds_read_b64_tr_b16 v[34:35], v11 offset:2560
    s_add_u32 m0, s29, 81920
    v_add_u32 v2, s30, v2
    buffer_load_dwordx4 v4, s[20:23], 0 offen lds
    s_waitcnt lgkmcnt(5)
    v_mfma_f32_32x32x16_bf16 v[112:127], v[24:27], v[52:55], v[112:127]
    ds_read_b64_tr_b16 v[36:37], v12 offset:2048
    ds_read_b64_tr_b16 v[38:39], v12 offset:2560
    v_mfma_f32_32x32x16_bf16 v[128:143], v[24:27], v[56:59], v[128:143]
    ds_read_b64_tr_b16 v[40:41], v13 offset:2048
    ds_read_b64_tr_b16 v[42:43], v13 offset:2560
    s_add_u32 s29, s29, 16384
    buffer_load_dwordx4 v4, s[20:23], s37 offen offset:1024 lds
    v_add_u32 v3, s30, v3
    v_mfma_f32_16x16x32_bf16 v[76:79], v[14:17], v[44:47], v[76:79]
    s_waitcnt lgkmcnt(4)
    v_mfma_f32_32x32x16_bf16 v[80:95], v[20:23], v[28:31], v[80:95]
    ds_read_b128 v[24:27], v9
    ds_read_b64_tr_b16 v[44:45], v10 offset:3072
    ds_read_b64_tr_b16 v[46:47], v10 offset:3584
    s_cmp_ge_u32 s29, 81920
    buffer_load_dwordx4 v4, s[20:23], s38 offen offset:2048 lds
    s_cselect_b32 s43, 81920, 0
    v_mfma_f32_32x32x16_bf16 v[96:111], v[20:23], v[32:35], v[96:111]
    ds_read_b64_tr_b16 v[48:49], v11 offset:3072
    ds_read_b64_tr_b16 v[50:51], v11 offset:3584
    s_sub_u32 s29, s29, s43
    buffer_load_dwordx4 v4, s[20:23], s39 offen offset:3072 lds
    v_add_u32 v4, s31, v4
    s_waitcnt lgkmcnt(5)
    v_mfma_f32_32x32x16_bf16 v[112:127], v[20:23], v[36:39], v[112:127]
    ds_read_b64_tr_b16 v[52:53], v12 offset:3072
    ds_read_b64_tr_b16 v[54:55], v12 offset:3584
    s_cmp_eq_u32 s41, 4
    s_cselect_b32 s42, -4, 1
    s_cselect_b32 s41, -1, s41
    v_mfma_f32_32x32x16_bf16 v[128:143], v[20:23], v[40:43], v[128:143]
    ds_read_b64_tr_b16 v[56:57], v13 offset:3072
    ds_read_b64_tr_b16 v[58:59], v13 offset:3584
    s_add_u32 s41, s41, 1
    s_mul_i32 s42, s42, 16384
    v_add_u32 v10, s42, v10
    v_add_u32 v11, s42, v11
    v_add_u32 v12, s42, v12
    v_mfma_f32_16x16x32_bf16 v[76:79], v[14:17], v[28:31], v[76:79]
    v_add_u32 v13, s42, v13
    v_add_u32 v6, s42, v6
    s_waitcnt lgkmcnt(4)
    v_mfma_f32_32x32x16_bf16 v[80:95], v[24:27], v[44:47], v[80:95]
    s_waitcnt vmcnt(8)
    s_cmp_lg_u32 s53, 6
    s_cbranch_scc1 L_p1_n6D
    v_cmp_ne_u32 vcc, 0, v66
    s_nop 0
    s_bcnt1_i32_b32 s52, vcc_lo
    s_nop 0
    s_cmp_ge_u32 s52, 32
    s_cbranch_scc0 L_p1_spinD
L_p1_n6D:
    s_barrier
    ds_read_b128 v[20:23], v6
    ds_read_b64_tr_b16 v[28:29], v10 offset:0
    ds_read_b64_tr_b16 v[30:31], v10 offset:512
    v_mfma_f32_32x32x16_bf16 v[96:111], v[24:27], v[48:51], v[96:111]
    ds_read_b64_tr_b16 v[32:33], v11 offset:0
    ds_read_b64_tr_b16 v[34:35], v11 offset:512
    v_add_u32 v7, s42, v7
    v_add_u32 v8, s42, v8
    v_add_u32 v9, s42, v9
    s_cmp_lg_u32 s40, 6
    s_cbranch_scc1 L_p1_n7D
    buffer_load_dwordx4 v[160:163], v64, s[24:27], s45 offen sc1
    buffer_load_dwordx4 v[164:167], v65, s[24:27], s46 offen offset:0 sc1
    buffer_load_dwordx4 v[168:171], v65, s[24:27], s46 offen offset:32 sc1
    buffer_load_dwordx4 v[172:175], v65, s[24:27], s46 offen offset:64 sc1
    buffer_load_dwordx4 v[176:179], v65, s[24:27], s46 offen offset:96 sc1
L_p1_n7D:
    s_waitcnt lgkmcnt(5)
    v_mfma_f32_32x32x16_bf16 v[112:127], v[24:27], v[52:55], v[112:127]
    ds_read_b64_tr_b16 v[36:37], v12 offset:0
    ds_read_b64_tr_b16 v[38:39], v12 offset:512
    v_mfma_f32_32x32x16_bf16 v[128:143], v[24:27], v[56:59], v[128:143]
    ds_read_b64_tr_b16 v[40:41], v13 offset:0
    ds_read_b64_tr_b16 v[42:43], v13 offset:512
    s_cmp_lg_u32 s53, 5
    s_cbranch_scc1 L_p1_n5D
    buffer_load_dword v66, v60, s[48:51], 0 offen sc1
L_p1_n5D:
    v_mfma_f32_16x16x32_bf16 v[76:79], v[14:17], v[44:47], v[76:79]
    s_cmp_ge_u32 s40, 6
    s_cselect_b32 s18, 0, s18
    s_cselect_b32 s22, 0, s22
    s_add_u32 s53, s53, 1
    s_add_u32 s40, s40, 1
    s_cmp_lt_u32 s40, 9
    s_cbranch_scc1 L_p1_loopD
    s_waitcnt vmcnt(0) lgkmcnt(0)
    s_barrier
    s_lshl_b32 s14, s3, 8
    v_lshl_add_u32 v1, v0, 2, s14
    ds_write_b32 v1, v76
    s_waitcnt lgkmcnt(0)
    s_barrier
    v_xor_b32 v62, 256, v1
    ds_read_b32 v77, v62
    v_xor_b32 v62, 512, v1
    ds_read_b32 v78, v62
    v_xor_b32 v62, 768, v1
    ds_read_b32 v79, v62
    v_cvt_pk_bf16_f32 v144, v76, v76
    v_mov_b32 v146, 0
    v_and_b32 v62, 0xffff0000, v144
    v_mov_b32 v147, 0
    v_sub_f32 v62, v76, v62
    v_cvt_pk_bf16_f32 v145, v62, 0
    s_waitcnt lgkmcnt(0)
    v_cvt_pk_bf16_f32 v148, v77, v77
    v_mov_b32 v150, 0
    v_and_b32 v62, 0xffff0000, v148
    v_mov_b32 v151, 0
    v_sub_f32 v62, v77, v62
    v_cvt_pk_bf16_f32 v149, v62, 0
    v_cvt_pk_bf16_f32 v152, v78, v78
    v_mov_b32 v154, 0
    v_and_b32 v62, 0xffff0000, v152
    v_mov_b32 v155, 0
    v_sub_f32 v62, v78, v62
    v_cvt_pk_bf16_f32 v153, v62, 0
    v_cvt_pk_bf16_f32 v156, v79, v79
    v_mov_b32 v158, 0
    v_and_b32 v62, 0xffff0000, v156
    v_mov_b32 v159, 0
    v_sub_f32 v62, v79, v62
    v_cvt_pk_bf16_f32 v157, v62, 0
    v_cmp_gt_u32 vcc, 32, v0
    v_mov_b32 v6, 0
    v_mov_b32 v7, 0
    v_cndmask_b32 v4, 0, v160, vcc
    v_cndmask_b32 v5, 0, v161, vcc
    s_nop 1
    v_mfma_f32_32x32x16_bf16 v[80:95], v[4:7], v[144:147], v[80:95]
    v_mfma_f32_32x32x16_bf16 v[96:111], v[4:7], v[148:151], v[96:111]
    v_mfma_f32_32x32x16_bf16 v[112:127], v[4:7], v[152:155], v[112:127]
    v_mfma_f32_32x32x16_bf16 v[128:143], v[4:7], v[156:159], v[128:143]
    s_lshl_b32 s14, s12, 2
    s_add_u32 s14, s14, s3
    s_mul_i32 s14, s14, 36864
    s_sub_u32 s15, s13, 9
    s_lshl_b32 s31, s15, 2
    s_lshl_b32 s15, s15, 11
    s_add_u32 s14, s14, s15
    s_add_u32 s14, s14, 5242880
    v_lshrrev_b32 v62, 5, v0
    v_mul_u32_u24 v62, 9216, v62
    v_and_b32 v1, 31, v0
    v_lshl_add_u32 v1, v1, 4, v62
    v_add_u32 v1, s14, v1
    v_add_u32 v2, 18432, v1
    s_waitcnt vmcnt(0)
    s_xor_b32 s15, s3, 0
    s_add_u32 s30, s31, s15
    s_lshl_b32 s15, s15, 9
    s_cmp_lt_u32 s30, 18
    s_cselect_b32 s15, s15, 0x40000000
    v_mul_f32 v80, v164, v80
    v_mul_f32 v81, v165, v81
    v_mul_f32 v82, v166, v82
    v_mul_f32 v83, v167, v83
    v_mul_f32 v84, v168, v84
    v_mul_f32 v85, v169, v85
    v_mul_f32 v86, v170, v86
    v_mul_f32 v87, v171, v87
    v_cvt_pk_bf16_f32 v80, v80, v81
    v_cvt_pk_bf16_f32 v81, v82, v83
    v_cvt_pk_bf16_f32 v82, v84, v85
    v_cvt_pk_bf16_f32 v83, v86, v87
    buffer_store_dwordx4 v[80:83], v1, s[24:27], s15 offen sc1
    v_mul_f32 v88, v172, v88
    v_mul_f32 v89, v173, v89
    v_mul_f32 v90, v174, v90
    v_mul_f32 v91, v175, v91
    v_mul_f32 v92, v176, v92
    v_mul_f32 v93, v177, v93
    v_mul_f32 v94, v178, v94
    v_mul_f32 v95, v179, v95
    v_cvt_pk_bf16_f32 v88, v88, v89
    v_cvt_pk_bf16_f32 v89, v90, v91
    v_cvt_pk_bf16_f32 v90, v92, v93
    v_cvt_pk_bf16_f32 v91, v94, v95
    buffer_store_dwordx4 v[88:91], v2, s[24:27], s15 offen sc1
    s_xor_b32 s15, s3, 1
    s_add_u32 s30, s31, s15
    s_lshl_b32 s15, s15, 9
    s_cmp_lt_u32 s30, 18
    s_cselect_b32 s15, s15, 0x40000000
    v_mul_f32 v96, v164, v96
    v_mul_f32 v97, v165, v97
    v_mul_f32 v98, v166, v98
    v_mul_f32 v99, v167, v99
    v_mul_f32 v100, v168, v100
    v_mul_f32 v101, v169, v101
    v_mul_f32 v102, v170, v102
    v_mul_f32 v103, v171, v103
    v_cvt_pk_bf16_f32 v96, v96, v97
    v_cvt_pk_bf16_f32 v97, v98, v99
    v_cvt_pk_bf16_f32 v98, v100, v101
    v_cvt_pk_bf16_f32 v99, v102, v103
    buffer_store_dwordx4 v[96:99], v1, s[24:27], s15 offen sc1
    v_mul_f32 v104, v172, v104
    v_mul_f32 v105, v173, v105
    v_mul_f32 v106, v174, v106
    v_mul_f32 v107, v175, v107
    v_mul_f32 v108, v176, v108
    v_mul_f32 v109, v177, v109
    v_mul_f32 v110, v178, v110
    v_mul_f32 v111, v179, v111
    v_cvt_pk_bf16_f32 v104, v104, v105
    v_cvt_pk_bf16_f32 v105, v106, v107
    v_cvt_pk_bf16_f32 v106, v108, v109
    v_cvt_pk_bf16_f32 v107, v110, v111
    buffer_store_dwordx4 v[104:107], v2, s[24:27], s15 offen sc1
    s_xor_b32 s15, s3, 2
    s_add_u32 s30, s31, s15
    s_lshl_b32 s15, s15, 9
    s_cmp_lt_u32 s30, 18
    s_cselect_b32 s15, s15, 0x40000000
    v_mul_f32 v112, v164, v112
    v_mul_f32 v113, v165, v113
    v_mul_f32 v114, v166, v114
    v_mul_f32 v115, v167, v115
    v_mul_f32 v116, v168, v116
    v_mul_f32 v117, v169, v117
    v_mul_f32 v118, v170, v118
    v_mul_f32 v119, v171, v119
    v_cvt_pk_bf16_f32 v112, v112, v113
    v_cvt_pk_bf16_f32 v113, v114, v115
    v_cvt_pk_bf16_f32 v114, v116, v117
    v_cvt_pk_bf16_f32 v115, v118, v119
    buffer_store_dwordx4 v[112:115], v1, s[24:27], s15 offen sc1
    v_mul_f32 v120, v172, v120
    v_mul_f32 v121, v173, v121
    v_mul_f32 v122, v174, v122
    v_mul_f32 v123, v175, v123
    v_mul_f32 v124, v176, v124
    v_mul_f32 v125, v177, v125
    v_mul_f32 v126, v178, v126
    v_mul_f32 v127, v179, v127
    v_cvt_pk_bf16_f32 v120, v120, v121
    v_cvt_pk_bf16_f32 v121, v122, v123
    v_cvt_pk_bf16_f32 v122, v124, v125
    v_cvt_pk_bf16_f32 v123, v126, v127
    buffer_store_dwordx4 v[120:123], v2, s[24:27], s15 offen sc1
    s_xor_b32 s15, s3, 3
    s_add_u32 s30, s31, s15
    s_lshl_b32 s15, s15, 9
    s_cmp_lt_u32 s30, 18
    s_cselect_b32 s15, s15, 0x40000000
    v_mul_f32 v128, v164, v128
    v_mul_f32 v129, v165, v129
    v_mul_f32 v130, v166, v130
    v_mul_f32 v131, v167, v131
    v_mul_f32 v132, v168, v132
    v_mul_f32 v133, v169, v133
    v_mul_f32 v134, v170, v134
    v_mul_f32 v135, v171, v135
    v_cvt_pk_bf16_f32 v128, v128, v129
    v_cvt_pk_bf16_f32 v129, v130, v131
    v_cvt_pk_bf16_f32 v130, v132, v133
    v_cvt_pk_bf16_f32 v131, v134, v135
    buffer_store_dwordx4 v[128:131], v1, s[24:27], s15 offen sc1
    v_mul_f32 v136, v172, v136
    v_mul_f32 v137, v173, v137
    v_mul_f32 v138, v174, v138
    v_mul_f32 v139, v175, v139
    v_mul_f32 v140, v176, v140
    v_mul_f32 v141, v177, v141
    v_mul_f32 v142, v178, v142
    v_mul_f32 v143, v179, v143
    v_cvt_pk_bf16_f32 v136, v136, v137
    v_cvt_pk_bf16_f32 v137, v138, v139
    v_cvt_pk_bf16_f32 v138, v140, v141
    v_cvt_pk_bf16_f32 v139, v142, v143
    buffer_store_dwordx4 v[136:139], v2, s[24:27], s15 offen sc1
L_p1_sig:
    s_lshl_b32 s47, s12, 4
    s_add_u32 s47, s47, s13
    s_lshl_b32 s47, s47, 7
    s_add_u32 s47, s47, 15859712
    s_branch L_p1_end
L_p1_aux:
    s_sub_u32 s12, s2, 224
    s_getpc_b64 s[28:29]
L_p1_pc:
    s_sub_u32 s28, s28, L_p1_pc-L_p1_loopT
    s_subb_u32 s29, s29, 0
    s_mov_b32 s30, L_code_end-L_p1_loopT
    s_mov_b32 s31, 0x20000
    s_lshr_b32 s14, s12, 3
    s_lshl_b32 s14, s14, 2
    s_add_u32 s14, s14, s3
    s_mul_i32 s14, s14, 4608
    v_min_u32 v4, 35, v0
    v_lshlrev_b32 v4, 7, v4
    buffer_load_dword v90, v4, s[28:31], s14 offen sc0 sc1
    s_lshl_b32 s13, s12, 6
    s_lshl_b32 s14, s3, 4
    s_add_u32 s13, s13, s14
    v_lshrrev_b32 v1, 3, v0
    v_add_u32 v2, s13, v1
    v_mul_u32_u24 v2, 1152, v2
    v_and_b32 v3, 7, v0
    v_lshl_add_u32 v2, v3, 4, v2
    s_waitcnt lgkmcnt(0)
    s_mov_b32 s16, s64
    s_mov_b32 s17, s65
    s_mov_b32 s18, 2359296
    s_mov_b32 s19, 0x20000
    s_mov_b32 s20, s68
    s_mov_b32 s21, s69
    s_mov_b32 s22, 663552
    s_mov_b32 s23, 0x20000
    s_mov_b32 s24, s6
    s_mov_b32 s25, s7
    s_mov_b32 s26, 268435456
    s_mov_b32 s27, 0x20000
    s_mov_b32 s48, s4
    s_mov_b32 s49, s5
    s_mov_b32 s50, 256
    s_mov_b32 s51, 0x20000
    s_mov_b32 s15, 9216
    buffer_load_dwordx4 v[16:19], v2, s[16:19], 0 offen offset:0
    buffer_load_dwordx4 v[20:23], v2, s[16:19], 0 offen offset:128
    buffer_load_dwordx4 v[24:27], v2, s[16:19], 0 offen offset:256
    buffer_load_dwordx4 v[28:31], v2, s[16:19], 0 offen offset:384
    buffer_load_dwordx4 v[32:35], v2, s[16:19], 0 offen offset:512
    buffer_load_dwordx4 v[36:39], v2, s[16:19], 0 offen offset:640
    buffer_load_dwordx4 v[40:43], v2, s[16:19], 0 offen offset:768
    buffer_load_dwordx4 v[44:47], v2, s[16:19], 0 offen offset:896
    buffer_load_dwordx4 v[48:51], v2, s[16:19], 0 offen offset:1024
    buffer_load_dwordx4 v[52:55], v2, s[16:19], s15 offen offset:0
    buffer_load_dwordx4 v[56:59], v2, s[16:19], s15 offen offset:128
    buffer_load_dwordx4 v[60:63], v2, s[16:19], s15 offen offset:256
    buffer_load_dwordx4 v[64:67], v2, s[16:19], s15 offen offset:384
    buffer_load_dwordx4 v[68:71], v2, s[16:19], s15 offen offset:512
    buffer_load_dwordx4 v[72:75], v2, s[16:19], s15 offen offset:640
    buffer_load_dwordx4 v[76:79], v2, s[16:19], s15 offen offset:768
    buffer_load_dwordx4 v[80:83], v2, s[16:19], s15 offen offset:896
    buffer_load_dwordx4 v[84:87], v2, s[16:19], s15 offen offset:1024
    s_lshl_b32 s14, s12, 12
    s_lshl_b32 s15, s3, 10
    s_add_u32 s14, s14, s15
    s_add_u32 s14, s14, 15728640
    v_lshlrev_b32 v4, 4, v0
    v_mov_b32 v8, 0
    v_mov_b32 v9, 0
    v_mov_b32 v10, 0
    v_mov_b32 v11, 0
    buffer_store_dwordx4 v[8:11], v4, s[24:27], s14 offen sc1
    s_add_u32 s15, s14, 131072
    buffer_store_dwordx4 v[8:11], v4, s[24:27], s15 offen sc1
    s_mov_b32 s14, 0x3f803f80
    v_mov_b32 v4, 0
    v_mov_b32 v5, 0
    s_waitcnt vmcnt(19)
    v_dot2c_f32_bf16 v4, s14, v16
    v_dot2c_f32_bf16 v5, v16, v16
    v_dot2c_f32_bf16 v4, s14, v17
    v_dot2c_f32_bf16 v5, v17, v17
    v_dot2c_f32_bf16 v4, s14, v18
    v_dot2c_f32_bf16 v5, v18, v18
    v_dot2c_f32_bf16 v4, s14, v19
    v_dot2c_f32_bf16 v5, v19, v19
    s_waitcnt vmcnt(18)
    v_dot2c_f32_bf16 v4, s14, v20
    v_dot2c_f32_bf16 v5, v20, v20
    v_dot2c_f32_bf16 v4, s14, v21
    v_dot2c_f32_bf16 v5, v21, v21
    v_dot2c_f32_bf16 v4, s14, v22
    v_dot2c_f32_bf16 v5, v22, v22
    v_dot2c_f32_bf16 v4, s14, v23
    v_dot2c_f32_bf16 v5, v23, v23
    s_waitcnt vmcnt(17)
    v_dot2c_f32_bf16 v4, s14, v24
    v_dot2c_f32_bf16 v5, v24, v24
    v_dot2c_f32_bf16 v4, s14, v25
    v_dot2c_f32_bf16 v5, v25, v25
    v_dot2c_f32_bf16 v4, s14, v26
    v_dot2c_f32_bf16 v5, v26, v26
    v_dot2c_f32_bf16 v4, s14, v27
    v_dot2c_f32_bf16 v5, v27, v27
    s_waitcnt vmcnt(16)
    v_dot2c_f32_bf16 v4, s14, v28
    v_dot2c_f32_bf16 v5, v28, v28
    v_dot2c_f32_bf16 v4, s14, v29
    v_dot2c_f32_bf16 v5, v29, v29
    v_dot2c_f32_bf16 v4, s14, v30
    v_dot2c_f32_bf16 v5, v30, v30
    v_dot2c_f32_bf16 v4, s14, v31
    v_dot2c_f32_bf16 v5, v31, v31
    s_waitcnt vmcnt(15)
    v_dot2c_f32_bf16 v4, s14, v32
    v_dot2c_f32_bf16 v5, v32, v32
    v_dot2c_f32_bf16 v4, s14, v33
    v_dot2c_f32_bf16 v5, v33, v33
    v_dot2c_f32_bf16 v4, s14, v34
    v_dot2c_f32_bf16 v5, v34, v34
    v_dot2c_f32_bf16 v4, s14, v35
    v_dot2c_f32_bf16 v5, v35, v35
    s_waitcnt vmcnt(14)
    v_dot2c_f32_bf16 v4, s14, v36
    v_dot2c_f32_bf16 v5, v36, v36
    v_dot2c_f32_bf16 v4, s14, v37
    v_dot2c_f32_bf16 v5, v37, v37
    v_dot2c_f32_bf16 v4, s14, v38
    v_dot2c_f32_bf16 v5, v38, v38
    v_dot2c_f32_bf16 v4, s14, v39
    v_dot2c_f32_bf16 v5, v39, v39
    s_waitcnt vmcnt(13)
    v_dot2c_f32_bf16 v4, s14, v40
    v_dot2c_f32_bf16 v5, v40, v40
    v_dot2c_f32_bf16 v4, s14, v41
    v_dot2c_f32_bf16 v5, v41, v41
    v_dot2c_f32_bf16 v4, s14, v42
    v_dot2c_f32_bf16 v5, v42, v42
    v_dot2c_f32_bf16 v4, s14, v43
    v_dot2c_f32_bf16 v5, v43, v43
    s_waitcnt vmcnt(12)
    v_dot2c_f32_bf16 v4, s14, v44
    v_dot2c_f32_bf16 v5, v44, v44
    v_dot2c_f32_bf16 v4, s14, v45
    v_dot2c_f32_bf16 v5, v45, v45
    v_dot2c_f32_bf16 v4, s14, v46
    v_dot2c_f32_bf16 v5, v46, v46
    v_dot2c_f32_bf16 v4, s14, v47
    v_dot2c_f32_bf16 v5, v47, v47
    s_waitcnt vmcnt(11)
    v_dot2c_f32_bf16 v4, s14, v48
    v_dot2c_f32_bf16 v5, v48, v48
    v_dot2c_f32_bf16 v4, s14, v49
    v_dot2c_f32_bf16 v5, v49, v49
    v_dot2c_f32_bf16 v4, s14, v50
    v_dot2c_f32_bf16 v5, v50, v50
    v_dot2c_f32_bf16 v4, s14, v51
    v_dot2c_f32_bf16 v5, v51, v51
    v_mov_b32 v6, 0
    v_mov_b32 v7, 0
    s_waitcnt vmcnt(10)
    v_dot2c_f32_bf16 v6, s14, v52
    v_dot2c_f32_bf16 v7, v52, v52
    v_dot2c_f32_bf16 v6, s14, v53
    v_dot2c_f32_bf16 v7, v53, v53
    v_dot2c_f32_bf16 v6, s14, v54
    v_dot2c_f32_bf16 v7, v54, v54
    v_dot2c_f32_bf16 v6, s14, v55
    v_dot2c_f32_bf16 v7, v55, v55
    s_waitcnt vmcnt(9)
    v_dot2c_f32_bf16 v6, s14, v56
    v_dot2c_f32_bf16 v7, v56, v56
    v_dot2c_f32_bf16 v6, s14, v57
    v_dot2c_f32_bf16 v7, v57, v57
    v_dot2c_f32_bf16 v6, s14, v58
    v_dot2c_f32_bf16 v7, v58, v58
    v_dot2c_f32_bf16 v6, s14, v59
    v_dot2c_f32_bf16 v7, v59, v59
    s_waitcnt vmcnt(8)
    v_dot2c_f32_bf16 v6, s14, v60
    v_dot2c_f32_bf16 v7, v60, v60
    v_dot2c_f32_bf16 v6, s14, v61
    v_dot2c_f32_bf16 v7, v61, v61
    v_dot2c_f32_bf16 v6, s14, v62
    v_dot2c_f32_bf16 v7, v62, v62
    v_dot2c_f32_bf16 v6, s14, v63
    v_dot2c_f32_bf16 v7, v63, v63
    s_waitcnt vmcnt(7)
    v_dot2c_f32_bf16 v6, s14, v64
    v_dot2c_f32_bf16 v7, v64, v64
    v_dot2c_f32_bf16 v6, s14, v65
    v_dot2c_f32_bf16 v7, v65, v65
    v_dot2c_f32_bf16 v6, s14, v66
    v_dot2c_f32_bf16 v7, v66, v66
    v_dot2c_f32_bf16 v6, s14, v67
    v_dot2c_f32_bf16 v7, v67, v67
    s_waitcnt vmcnt(6)
    v_dot2c_f32_bf16 v6, s14, v68
    v_dot2c_f32_bf16 v7, v68, v68
    v_dot2c_f32_bf16 v6, s14, v69
    v_dot2c_f32_bf16 v7, v69, v69
    v_dot2c_f32_bf16 v6, s14, v70
    v_dot2c_f32_bf16 v7, v70, v70
    v_dot2c_f32_bf16 v6, s14, v71
    v_dot2c_f32_bf16 v7, v71, v71
    s_waitcnt vmcnt(5)
    v_dot2c_f32_bf16 v6, s14, v72
    v_dot2c_f32_bf16 v7, v72, v72
    v_dot2c_f32_bf16 v6, s14, v73
    v_dot2c_f32_bf16 v7, v73, v73
    v_dot2c_f32_bf16 v6, s14, v74
    v_dot2c_f32_bf16 v7, v74, v74
    v_dot2c_f32_bf16 v6, s14, v75
    v_dot2c_f32_bf16 v7, v75, v75
    s_waitcnt vmcnt(4)
    v_dot2c_f32_bf16 v6, s14, v76
    v_dot2c_f32_bf16 v7, v76, v76
    v_dot2c_f32_bf16 v6, s14, v77
    v_dot2c_f32_bf16 v7, v77, v77
    v_dot2c_f32_bf16 v6, s14, v78
    v_dot2c_f32_bf16 v7, v78, v78
    v_dot2c_f32_bf16 v6, s14, v79
    v_dot2c_f32_bf16 v7, v79, v79
    s_waitcnt vmcnt(3)
    v_dot2c_f32_bf16 v6, s14, v80
    v_dot2c_f32_bf16 v7, v80, v80
    v_dot2c_f32_bf16 v6, s14, v81
    v_dot2c_f32_bf16 v7, v81, v81
    v_dot2c_f32_bf16 v6, s14, v82
    v_dot2c_f32_bf16 v7, v82, v82
    v_dot2c_f32_bf16 v6, s14, v83
    v_dot2c_f32_bf16 v7, v83, v83
    s_waitcnt vmcnt(2)
    v_dot2c_f32_bf16 v6, s14, v84
    v_dot2c_f32_bf16 v7, v84, v84
    v_dot2c_f32_bf16 v6, s14, v85
    v_dot2c_f32_bf16 v7, v85, v85
    v_dot2c_f32_bf16 v6, s14, v86
    v_dot2c_f32_bf16 v7, v86, v86
    v_dot2c_f32_bf16 v6, s14, v87
    v_dot2c_f32_bf16 v7, v87, v87
    s_nop 2
    v_add_f32_dpp v4, v4, v4 quad_perm:[1,0,3,2] row_mask:0xf bank_mask:0xf
    v_add_f32_dpp v5, v5, v5 quad_perm:[1,0,3,2] row_mask:0xf bank_mask:0xf
    v_add_f32_dpp v6, v6, v6 quad_perm:[1,0,3,2] row_mask:0xf bank_mask:0xf
    v_add_f32_dpp v7, v7, v7 quad_perm:[1,0,3,2] row_mask:0xf bank_mask:0xf
    v_add_f32_dpp v4, v4, v4 quad_perm:[2,3,0,1] row_mask:0xf bank_mask:0xf
    v_add_f32_dpp v5, v5, v5 quad_perm:[2,3,0,1] row_mask:0xf bank_mask:0xf
    v_add_f32_dpp v6, v6, v6 quad_perm:[2,3,0,1] row_mask:0xf bank_mask:0xf
    v_add_f32_dpp v7, v7, v7 quad_perm:[2,3,0,1] row_mask:0xf bank_mask:0xf
    v_add_f32_dpp v4, v4, v4 row_half_mirror row_mask:0xf bank_mask:0xf
    v_add_f32_dpp v5, v5, v5 row_half_mirror row_mask:0xf bank_mask:0xf
    v_add_f32_dpp v6, v6, v6 row_half_mirror row_mask:0xf bank_mask:0xf
    v_add_f32_dpp v7, v7, v7 row_half_mirror row_mask:0xf bank_mask:0xf
    v_cmp_eq_u32 vcc, 1, v3
    v_lshl_add_u32 v1, v3, 3, v1
    v_add_u32 v1, s13, v1
    v_cndmask_b32 v4, v4, v6, vcc
    v_cndmask_b32 v5, v5, v7, vcc
    v_mul_f32 v15, 0x3ae38e39, v4
    v_mul_f32 v6, v15, v15
    s_mov_b32 s14, 0x3ae38e39
    v_fma_f32 v6, v5, s14, -v6
    v_max_f32 v6, 0, v6
    v_add_f32 v6, 0x3727c5ac, v6
    v_rsq_f32 v14, v6
    v_cvt_pk_bf16_f32 v6, -v15, -v15
    v_and_b32 v7, 0xffff0000, v6
    v_sub_f32 v8, 0, v15
    v_sub_f32 v8, v8, v7
    v_cvt_pk_bf16_f32 v12, v7, v8
    v_lshrrev_b32 v13, 16, v6
    v_cmp_gt_u32 vcc, 2, v3
    v_lshlrev_b32 v6, 4, v1
    v_lshlrev_b32 v7, 2, v1
    s_mov_b32 s14, 14942208
    s_mov_b32 s15, 14974976
    s_mov_b64 exec, vcc
    buffer_store_dwordx4 v[12:15], v6, s[24:27], s14 offen sc1
    buffer_store_dword v14, v7, s[24:27], s15 offen sc1
    s_mov_b64 exec, -1
    s_waitcnt vmcnt(0)
    s_barrier
    s_cmp_lg_u32 s3, 0
    s_cbranch_scc1 L_p1_da0
    v_mov_b32 v1, 1
    s_mov_b64 exec, 1
    s_lshl_b32 s14, s12, 2
    buffer_store_dword v1, off, s[48:51], s14 offset:0 sc1
    s_mov_b64 exec, -1
L_p1_da0:
    v_lshrrev_b32 v1, 3, v0
    s_lshl_b32 s13, s3, 3
    v_add_u32 v1, s13, v1
    v_min_u32 v2, 17, v1
    s_mul_i32 s13, s12, 18
    v_add_u32 v2, s13, v2
    v_mul_u32_u24 v2, 1152, v2
    v_lshl_add_u32 v2, v3, 4, v2
    buffer_load_dwordx4 v[16:19], v2, s[20:23], 0 offen offset:0
    buffer_load_dwordx4 v[20:23], v2, s[20:23], 0 offen offset:128
    buffer_load_dwordx4 v[24:27], v2, s[20:23], 0 offen offset:256
    buffer_load_dwordx4 v[28:31], v2, s[20:23], 0 offen offset:384
    buffer_load_dwordx4 v[32:35], v2, s[20:23], 0 offen offset:512
    buffer_load_dwordx4 v[36:39], v2, s[20:23], 0 offen offset:640
    buffer_load_dwordx4 v[40:43], v2, s[20:23], 0 offen offset:768
    buffer_load_dwordx4 v[44:47], v2, s[20:23], 0 offen offset:896
    buffer_load_dwordx4 v[48:51], v2, s[20:23], 0 offen offset:1024
    v_lshrrev_b32 v4, 3, v1
    v_lshlrev_b32 v4, 5, v4
    v_and_b32 v5, 7, v1
    v_lshl_add_u32 v4, v5, 1, v4
    s_lshl_b32 s13, s12, 6
    v_add_u32 v4, s13, v4
    s_lshr_b32 s13, s12, 3
    s_add_u32 s13, s13, 32
    s_lshl_b32 s13, s13, 6
    s_and_b32 s14, s12, 1
    s_lshl_b32 s14, s14, 5
    s_add_u32 s13, s13, s14
    s_lshr_b32 s14, s12, 1
    s_and_b32 s14, s14, 3
    s_lshl_b32 s14, s14, 2
    s_add_u32 s13, s13, s14
    v_lshl_add_u32 v5, v5, 1, s13
    v_cmp_gt_u32 vcc, 16, v1
    s_nop 1
    v_cndmask_b32 v4, v5, v4, vcc
    v_lshl_add_u32 v4, v3, 4, v4
    v_cmp_gt_u32 vcc, 18, v1
    v_cmp_gt_u32 s[14:15], 2, v3
    s_nop 0
    s_and_b64 vcc, vcc, s[14:15]
    v_mov_b32 v5, 0x40000000
    v_cndmask_b32 v4, v5, v4, vcc
    v_mov_b32 v6, 0
    s_mov_b32 s14, 0x3f803f80
    s_waitcnt vmcnt(0)
    v_dot2c_f32_bf16 v6, s14, v16
    v_dot2c_f32_bf16 v6, s14, v17
    v_dot2c_f32_bf16 v6, s14, v18
    v_dot2c_f32_bf16 v6, s14, v19
    v_dot2c_f32_bf16 v6, s14, v20
    v_dot2c_f32_bf16 v6, s14, v21
    v_dot2c_f32_bf16 v6, s14, v22
    v_dot2c_f32_bf16 v6, s14, v23
    v_dot2c_f32_bf16 v6, s14, v24
    v_dot2c_f32_bf16 v6, s14, v25
    v_dot2c_f32_bf16 v6, s14, v26
    v_dot2c_f32_bf16 v6, s14, v27
    v_dot2c_f32_bf16 v6, s14, v28
    v_dot2c_f32_bf16 v6, s14, v29
    v_dot2c_f32_bf16 v6, s14, v30
    v_dot2c_f32_bf16 v6, s14, v31
    v_dot2c_f32_bf16 v6, s14, v32
    v_dot2c_f32_bf16 v6, s14, v33
    v_dot2c_f32_bf16 v6, s14, v34
    v_dot2c_f32_bf16 v6, s14, v35
    v_dot2c_f32_bf16 v6, s14, v36
    v_dot2c_f32_bf16 v6, s14, v37
    v_dot2c_f32_bf16 v6, s14, v38
    v_dot2c_f32_bf16 v6, s14, v39
    v_dot2c_f32_bf16 v6, s14, v40
    v_dot2c_f32_bf16 v6, s14, v41
    v_dot2c_f32_bf16 v6, s14, v42
    v_dot2c_f32_bf16 v6, s14, v43
    v_dot2c_f32_bf16 v6, s14, v44
    v_dot2c_f32_bf16 v6, s14, v45
    v_dot2c_f32_bf16 v6, s14, v46
    v_dot2c_f32_bf16 v6, s14, v47
    v_dot2c_f32_bf16 v6, s14, v48
    v_dot2c_f32_bf16 v6, s14, v49
    v_dot2c_f32_bf16 v6, s14, v50
    v_dot2c_f32_bf16 v6, s14, v51
    s_nop 2
    v_add_f32_dpp v6, v6, v6 quad_perm:[1,0,3,2] row_mask:0xf bank_mask:0xf
    s_nop 1
    v_add_f32_dpp v6, v6, v6 quad_perm:[2,3,0,1] row_mask:0xf bank_mask:0xf
    s_nop 1
    v_add_f32_dpp v6, v6, v6 row_half_mirror row_mask:0xf bank_mask:0xf
    v_mul_f32 v6, 0x3ae38e39, v6
    v_cvt_pk_bf16_f32 v7, v6, v6
    v_and_b32 v8, 0xffff0000, v7
    v_sub_f32 v8, v6, v8
    v_cvt_pk_bf16_f32 v8, v8, v8
    v_cmp_eq_u32 vcc, 0, v3
    s_mov_b32 s13, 14999552
    s_nop 0
    v_cndmask_b32 v7, v8, v7, vcc
    buffer_store_short v7, v4, s[24:27], s13 offen sc1
    s_waitcnt vmcnt(0)
    s_barrier
    s_cmp_lg_u32 s3, 0
    s_cbranch_scc1 L_p1_da1
    v_mov_b32 v1, 1
    s_mov_b64 exec, 1
    s_lshl_b32 s14, s12, 2
    buffer_store_dword v1, off, s[48:51], s14 offset:128 sc1
    s_mov_b64 exec, -1
L_p1_da1:
    s_waitcnt lgkmcnt(0)
    v_lshlrev_b32 v60, 2, v0
    v_mov_b32 v61, 1
    s_cmp_lg_u32 s3, 0
    s_cbranch_scc1 L_pdone1
    s_mov_b32 s14, 0
    s_mov_b32 exec_lo, 4294967295
    s_mov_b32 exec_hi, 0
L_poll1:
    buffer_load_dword v62, v60, s[48:51], 0 offen sc1
    s_add_u32 s14, s14, 1
    s_waitcnt vmcnt(0)
    v_cmp_lt_u32 vcc, v62, v61
    s_cmp_gt_u32 s14, 1048576
    s_cbranch_scc1 L_pexit1
    s_nop 2
    s_cbranch_vccz L_pexit1
    s_sleep 1
    s_branch L_poll1
L_pexit1:
    s_mov_b64 exec, -1
L_pdone1:
    s_waitcnt vmcnt(0)
    s_barrier
    s_mov_b32 s47, 0x40000000
L_p1_end:
    s_and_b32 s10, s2, 7
    s_lshr_b32 s11, s2, 3
    s_lshl_b32 s12, s10, 2
    s_and_b32 s13, s11, 3
    s_add_u32 s12, s12, s13
    s_lshr_b32 s13, s11, 2
    s_mul_i32 s14, s12, 18
    s_lshr_b32 s15, s14, 3
    s_lshr_b32 s16, s15, 1
    s_and_b32 s17, s15, 1
    s_lshl_b32 s18, s13, 3
    s_lshl_b32 s19, s3, 1
    s_add_u32 s19, s19, s18
    s_lshl_b32 s20, s3, 2
    s_add_u32 s20, s20, s18
    s_sub_u32 s20, s20, 8
    s_and_b32 s21, s20, 7
    s_cmp_lt_i32 s20, 0
    s_cselect_b32 s20, s21, s20
    v_lshlrev_b32 v1, 4, v0
    s_lshl_b32 s28, s17, 3
    s_mul_i32 s29, s17, 1016
    s_add_u32 s29, s29, 8
    s_add_u32 s30, s28, 1024
    v_add_u32 v2, s28, v1
    v_add_u32 v3, s29, v1
    v_add_u32 v4, s30, v1
    v_and_b32 v5, 31, v0
    v_and_b32 v6, 3, v0
    v_lshrrev_b32 v7, 1, v0
    v_and_b32 v7, 4, v7
    v_or_b32 v6, v6, v7
    v_lshlrev_b32 v7, 1, v0
    v_and_b32 v7, 8, v7
    v_or_b32 v6, v6, v7
    v_and_b32 v7, 1, v0
    v_or_b32 v7, 16, v7
    v_cmp_gt_u32 vcc, 16, v5
    v_lshrrev_b32 v8, 5, v0
    v_mul_u32_u24 v8, 9216, v8
    v_cndmask_b32 v6, v7, v6, vcc
    v_add_u32 v6, s14, v6
    v_lshl_add_u32 v6, v6, 4, v8
    s_and_b32 s28, s12, 1
    s_lshl_b32 s28, s28, 2
    s_add_u32 s28, s28, 18
    v_cmp_eq_u32 s[32:33], s28, v5
    s_lshl_b32 s23, s3, 13
    s_add_u32 s28, s23, 32768
    v_add_u32 v7, s28, v1
    s_mov_b64 exec, -1
    v_lshrrev_b32 v8, 5, v0
    v_lshlrev_b32 v8, 2, v8
    v_sub_u32 v8, v5, v8
    v_mov_b32 v9, 0xf1000000
    v_cmp_gt_i32 s[34:35], 0, v8
    v_cmp_gt_i32 s[36:37], 1, v8
    v_cmp_gt_i32 s[38:39], 2, v8
    v_cmp_gt_i32 s[40:41], 3, v8
    v_cndmask_b32 v112, v9, 0, s[34:35]
    v_cndmask_b32 v128, 0, v9, s[34:35]
    v_cndmask_b32 v113, v9, 0, s[36:37]
    v_cndmask_b32 v129, 0, v9, s[36:37]
    v_cndmask_b32 v114, v9, 0, s[38:39]
    v_cndmask_b32 v130, 0, v9, s[38:39]
    v_cndmask_b32 v115, v9, 0, s[40:41]
    v_cndmask_b32 v131, 0, v9, s[40:41]
    v_cmp_gt_i32 s[34:35], 8, v8
    v_cmp_gt_i32 s[36:37], 9, v8
    v_cmp_gt_i32 s[38:39], 10, v8
    v_cmp_gt_i32 s[40:41], 11, v8
    v_cndmask_b32 v116, v9, 0, s[34:35]
    v_cndmask_b32 v132, 0, v9, s[34:35]
    v_cndmask_b32 v117, v9, 0, s[36:37]
    v_cndmask_b32 v133, 0, v9, s[36:37]
    v_cndmask_b32 v118, v9, 0, s[38:39]
    v_cndmask_b32 v134, 0, v9, s[38:39]
    v_cndmask_b32 v119, v9, 0, s[40:41]
    v_cndmask_b32 v135, 0, v9, s[40:41]
    v_cmp_gt_i32 s[34:35], 16, v8
    v_cmp_gt_i32 s[36:37], 17, v8
    v_cmp_gt_i32 s[38:39], 18, v8
    v_cmp_gt_i32 s[40:41], 19, v8
    v_cndmask_b32 v120, v9, 0, s[34:35]
    v_cndmask_b32 v136, 0, v9, s[34:35]
    v_cndmask_b32 v121, v9, 0, s[36:37]
    v_cndmask_b32 v137, 0, v9, s[36:37]
    v_cndmask_b32 v122, v9, 0, s[38:39]
    v_cndmask_b32 v138, 0, v9, s[38:39]
    v_cndmask_b32 v123, v9, 0, s[40:41]
    v_cndmask_b32 v139, 0, v9, s[40:41]
    v_cmp_gt_i32 s[34:35], 24, v8
    v_cmp_gt_i32 s[36:37], 25, v8
    v_cmp_gt_i32 s[38:39], 26, v8
    v_cmp_gt_i32 s[40:41], 27, v8
    v_cndmask_b32 v124, v9, 0, s[34:35]
    v_cndmask_b32 v140, 0, v9, s[34:35]
    v_cndmask_b32 v125, v9, 0, s[36:37]
    v_cndmask_b32 v141, 0, v9, s[36:37]
    v_cndmask_b32 v126, v9, 0, s[38:39]
    v_cndmask_b32 v142, 0, v9, s[38:39]
    v_cndmask_b32 v127, v9, 0, s[40:41]
    v_cndmask_b32 v143, 0, v9, s[40:41]
    s_waitcnt vmcnt(0) lgkmcnt(0)
    s_barrier
    s_cmp_lg_u32 s3, 0
    s_cbranch_scc1 L_sig2
    v_mov_b32 v10, 1
    s_mov_b64 exec, 1
    buffer_store_dword v10, off, s[24:27], s47 sc1
    s_mov_b64 exec, -1
L_sig2:
    v_mov_b32 v12, 0x3f803f80
    v_mov_b32 v13, v12
    v_mov_b32 v14, v12
    v_mov_b32 v15, v12
    s_mov_b64 exec, s[32:33]
    ds_write_b128 v7, v[12:15] offset:0
    ds_write_b128 v7, v[12:15] offset:1024
    ds_write_b128 v7, v[12:15] offset:2048
    ds_write_b128 v7, v[12:15] offset:3072
    ds_write_b128 v7, v[12:15] offset:4096
    ds_write_b128 v7, v[12:15] offset:5120
    ds_write_b128 v7, v[12:15] offset:6144
    ds_write_b128 v7, v[12:15] offset:7168
    s_mov_b64 exec, -1
    v_mov_b32 v16, 0
    v_mov_b32 v17, 0
    v_mov_b32 v18, 0
    v_mov_b32 v19, 0
    s_lshl_b32 s28, s3, 10
    s_add_u32 s28, s28, 159744
    v_add_u32 v10, s28, v1
    ds_write_b128 v10, v[16:19]
    s_sub_u32 s28, 8, s19
    s_cmp_gt_i32 s28, 0
    s_cselect_b32 s29, 0x3f80, 0
    s_lshl_b32 s29, s29, 16
    s_or_b32 s29, s29, 0x3f80
    v_mov_b32 v22, 0x3f803f80
    v_mov_b32 v23, s29
    s_cmp_gt_i32 s28, 1
    s_cselect_b32 s29, 0x3f80, 0
    s_lshl_b32 s29, s29, 16
    s_or_b32 s29, s29, 0x3f80
    v_mov_b32 v30, 0x3f803f80
    v_mov_b32 v31, s29
    s_cmp_gt_i32 s28, 2
    s_cselect_b32 s29, 0x3f80, 0
    s_lshl_b32 s29, s29, 16
    s_or_b32 s29, s29, 0x3f80
    v_mov_b32 v38, 0x3f803f80
    v_mov_b32 v39, s29
    s_cmp_gt_i32 s28, 3
    s_cselect_b32 s29, 0x3f80, 0
    s_lshl_b32 s29, s29, 16
    s_or_b32 s29, s29, 0x3f80
    v_mov_b32 v46, 0x3f803f80
    v_mov_b32 v47, s29
    s_cmp_gt_i32 s28, 4
    s_cselect_b32 s29, 0x3f80, 0
    s_lshl_b32 s29, s29, 16
    s_or_b32 s29, s29, 0x3f80
    v_mov_b32 v54, 0x3f803f80
    v_mov_b32 v55, s29
    s_cmp_gt_i32 s28, 5
    s_cselect_b32 s29, 0x3f80, 0
    s_lshl_b32 s29, s29, 16
    s_or_b32 s29, s29, 0x3f80
    v_mov_b32 v62, 0x3f803f80
    v_mov_b32 v63, s29
    s_cmp_gt_i32 s28, 6
    s_cselect_b32 s29, 0x3f80, 0
    s_lshl_b32 s29, s29, 16
    s_or_b32 s29, s29, 0x3f80
    v_mov_b32 v70, 0x3f803f80
    v_mov_b32 v71, s29
    s_cmp_gt_i32 s28, 7
    s_cselect_b32 s29, 0x3f80, 0
    s_lshl_b32 s29, s29, 16
    s_or_b32 s29, s29, 0x3f80
    v_mov_b32 v78, 0x3f803f80
    v_mov_b32 v79, s29
    s_cmp_gt_i32 s28, 8
    s_cselect_b32 s29, 0x3f80, 0
    s_lshl_b32 s29, s29, 16
    s_or_b32 s29, s29, 0x3f80
    v_mov_b32 v86, 0x3f803f80
    v_mov_b32 v87, s29
    s_cmp_gt_i32 s28, 9
    s_cselect_b32 s29, 0x3f80, 0
    s_lshl_b32 s29, s29, 16
    s_or_b32 s29, s29, 0x3f80
    v_mov_b32 v94, 0x3f803f80
    v_mov_b32 v95, s29
    s_lshl_b32 s28, s15, 3
    s_sub_u32 s28, s28, s14
    v_lshrrev_b32 v8, 5, v0
    v_lshl_add_u32 v8, v8, 2, s28
    v_add_u32 v10, 0, v8
    v_cmp_gt_u32 s[34:35], 18, v10
    v_add_u32 v10, 2, v8
    v_cmp_gt_u32 s[36:37], 18, v10
    v_add_u32 v10, 8, v8
    v_cmp_gt_u32 s[38:39], 18, v10
    v_add_u32 v10, 10, v8
    v_cmp_gt_u32 s[40:41], 18, v10
    v_add_u32 v10, 16, v8
    v_cmp_gt_u32 s[42:43], 18, v10
    v_add_u32 v10, 18, v8
    v_cmp_gt_u32 s[44:45], 18, v10
    v_cmp_gt_u32 vcc, 32, v0
    v_mov_b32 v102, 0
    v_mov_b32 v110, 0
    v_cndmask_b32 v103, 0, v9, vcc
    v_cndmask_b32 v111, 0, v9, vcc
    s_lshl_b32 s28, s13, 1
    s_sub_u32 s28, s28, 2
    v_and_b32 v10, 3, v0
    v_lshrrev_b32 v11, 3, v0
    v_cmp_gt_u32 vcc, 2, v10
    v_max_u32 v12, 1, v11
    s_nop 0
    v_cndmask_b32 v11, v11, v12, vcc
    v_add_u32 v10, s28, v10
    v_max_i32 v10, 0, v10
    s_lshl_b32 s28, s16, 4
    v_mov_b32 v12, s28
    v_mov_b32 v13, 31
    v_cmp_eq_u32 vcc, 2, v11
    v_mov_b32 v14, s14
    s_nop 0
    v_cndmask_b32 v12, v12, v14, vcc
    v_cndmask_b32 v13, v13, 17, vcc
    v_bfe_u32 v14, v0, 2, 1
    v_mad_u32_u24 v12, v13, v14, v12
    s_movk_i32 s28, 576
    v_mad_u32_u24 v12, v11, s28, v12
    v_lshrrev_b32 v12, 7, v12
    v_lshl_add_u32 v10, v10, 4, v12
    v_lshlrev_b32 v10, 7, v10
    v_add_u32 v10, 15859712, v10
    v_mov_b32 v11, 1
    s_mul_i32 s21, s20, 73728
    s_lshl_b32 s22, s16, 10
    s_add_u32 s21, s21, s22
    s_add_u32 s21, s21, 36864
    s_mul_i32 s30, s19, 73728
    s_add_u32 s30, s30, s22
    s_add_u32 s30, s30, 0
    s_add_u32 s31, s30, 73728
    s_mul_i32 s46, s20, 36864
    s_add_u32 s46, s46, 5242880
    s_and_b32 s28, s2, 7
    s_lshr_b32 s29, s2, 3
    s_lshl_b32 s56, s28, 1
    s_and_b32 s57, s29, 1
    s_add_u32 s56, s56, s57
    s_lshr_b32 s57, s29, 1
    s_mov_b32 s52, s68
    s_mov_b32 s53, s69
    s_mov_b32 s54, 663552
    s_mov_b32 s55, 0x20000
    s_cmp_lt_u32 s2, 144
    s_cselect_b32 s54, s54, 0
    v_lshrrev_b32 v252, 3, v0
    v_lshrrev_b32 v253, 2, v0
    v_and_b32 v253, 4, v253
    v_and_b32 v254, 7, v0
    v_xor_b32 v253, v253, v254
    v_lshlrev_b32 v253, 4, v253
    s_lshl_b32 s28, s57, 7
    v_add_u32 v253, s28, v253
    s_and_b32 s28, s3, 1
    s_lshr_b32 s29, s3, 1
    s_lshl_b32 s58, s28, 3
    s_mul_i32 s59, s29, 18
    s_add_u32 s58, s58, s59
    v_add_u32 v254, s58, v252
    v_mul_u32_u24 v254, 1152, v254
    v_add_u32 v250, v254, v253
    s_mul_i32 s58, s28, 18
    s_mul_i32 s59, s29, 144
    s_add_u32 s58, s58, s59
    s_add_u32 s58, s58, 16
    v_lshrrev_b32 v254, 1, v252
    v_mul_u32_u24 v254, 36, v254
    v_and_b32 v252, 1, v252
    v_add3_u32 v254, v254, v252, s58
    v_mul_u32_u24 v254, 1152, v254
    v_add_u32 v251, v254, v253
    s_mul_i32 s58, s3, 18432
    s_add_u32 s58, s58, 81920
    s_mov_b32 s60, s64
    s_mov_b32 s61, s65
    s_mov_b32 s62, 2359296
    s_mov_b32 s63, 0x20000
    s_mov_b32 s71, 14942208
    s_cmp_lt_u32 s2, 144
    s_cselect_b32 s62, s62, 0
    s_cselect_b32 s71, s71, 0x40000000
    s_lshl_b32 s70, s56, 2
    s_add_u32 s70, s70, s3
    s_lshl_b32 s70, s70, 5
    v_and_b32 v246, 31, v0
    v_lshlrev_b32 v245, 2, v246
    v_add_u32 v246, s70, v246
    v_lshlrev_b32 v247, 4, v246
    v_mul_u32_u24 v246, 1152, v246
    v_lshrrev_b32 v248, 5, v0
    v_lshl_add_u32 v246, v248, 4, v246
    s_lshl_b32 s70, s57, 7
    s_lshl_b32 s8, s3, 10
    s_add_u32 s9, s8, 14999552
    s_add_u32 s8, s8, 155648
    s_cmp_lg_u32 s3, 0
    s_cbranch_scc1 L_pdone3
    s_mov_b32 s28, 0
    s_mov_b32 exec_lo, 16777215
    s_mov_b32 exec_hi, 0
L_poll3:
    buffer_load_dword v12, v10, s[24:27], 0 offen sc1
    s_add_u32 s28, s28, 1
    s_waitcnt vmcnt(0)
    v_cmp_lt_u32 vcc, v12, v11
    s_cmp_gt_u32 s28, 1048576
    s_cbranch_scc1 L_pexit3
    s_nop 2
    s_cbranch_vccz L_pexit3
    s_sleep 1
    s_branch L_poll3
L_pexit3:
    s_mov_b64 exec, -1
L_pdone3:
    s_waitcnt vmcnt(0)
    s_barrier
    s_add_u32 m0, s23, 0
    s_add_u32 s28, s21, 0
    buffer_load_dwordx4 v1, s[24:27], s28 offen offset:0 lds
    buffer_load_dwordx4 v1, s[24:27], s28 offen offset:1024 lds
    s_add_u32 s28, s21, 71680
    buffer_load_dwordx4 v1, s[24:27], s28 offen offset:2048 lds
    buffer_load_dwordx4 v1, s[24:27], s28 offen offset:3072 lds
    s_add_u32 m0, s23, 4096
    s_add_u32 s28, s21, 147456
    buffer_load_dwordx4 v1, s[24:27], s28 offen offset:0 lds
    buffer_load_dwordx4 v1, s[24:27], s28 offen offset:1024 lds
    s_add_u32 s28, s21, 219136
    buffer_load_dwordx4 v1, s[24:27], s28 offen offset:2048 lds
    buffer_load_dwordx4 v1, s[24:27], s28 offen offset:3072 lds
    buffer_load_dwordx2 v[96:97], v2, s[24:27], s30 offen
    buffer_load_dwordx2 v[98:99], v3, s[24:27], s30 offen
    buffer_load_dwordx2 v[100:101], v4, s[24:27], s30 offen
    buffer_load_dwordx2 v[104:105], v2, s[24:27], s31 offen
    buffer_load_dwordx2 v[106:107], v3, s[24:27], s31 offen
    buffer_load_dwordx2 v[108:109], v4, s[24:27], s31 offen
    buffer_load_dword v244, v245, s[48:51], 0 offen offset:128 sc1
    s_not_b64 exec, s[32:33]
    s_add_u32 m0, s23, 32768
    s_add_u32 s28, s46, 0
    buffer_load_dwordx4 v6, s[24:27], s28 offen offset:0 lds
    s_add_u32 s28, s46, 17408
    buffer_load_dwordx4 v6, s[24:27], s28 offen offset:1024 lds
    s_add_u32 s28, s46, 34816
    buffer_load_dwordx4 v6, s[24:27], s28 offen offset:2048 lds
    s_add_u32 s28, s46, 52224
    buffer_load_dwordx4 v6, s[24:27], s28 offen offset:3072 lds
    s_add_u32 m0, s23, 36864
    s_add_u32 s28, s46, 73728
    buffer_load_dwordx4 v6, s[24:27], s28 offen offset:0 lds
    s_add_u32 s28, s46, 91136
    buffer_load_dwordx4 v6, s[24:27], s28 offen offset:1024 lds
    s_add_u32 s28, s46, 108544
    buffer_load_dwordx4 v6, s[24:27], s28 offen offset:2048 lds
    s_add_u32 s28, s46, 125952
    buffer_load_dwordx4 v6, s[24:27], s28 offen offset:3072 lds
    s_mov_b64 exec, -1
    s_lshl_b32 s28, s3, 12
    v_add_u32 v2, s28, v2
    v_add_u32 v3, s28, v3
    v_add_u32 v4, s28, v4
    s_add_u32 s28, s28, 32768
    v_add_u32 v7, s28, v1
    s_waitcnt vmcnt(9)
    v_cndmask_b32 v96, 0, v96, s[34:35]
    v_cndmask_b32 v104, 0, v104, s[34:35]
    v_cndmask_b32 v97, 0, v97, s[36:37]
    v_cndmask_b32 v105, 0, v105, s[36:37]
    v_cndmask_b32 v98, 0, v98, s[38:39]
    v_cndmask_b32 v106, 0, v106, s[38:39]
    v_cndmask_b32 v99, 0, v99, s[40:41]
    v_cndmask_b32 v107, 0, v107, s[40:41]
    v_cndmask_b32 v100, 0, v100, s[42:43]
    v_cndmask_b32 v108, 0, v108, s[42:43]
    v_cndmask_b32 v101, 0, v101, s[44:45]
    v_cndmask_b32 v109, 0, v109, s[44:45]
    s_barrier
    ds_read_b64 v[16:17], v2 offset:0
    ds_read_b64 v[18:19], v3 offset:0
    ds_read_b64 v[20:21], v4 offset:0
    ds_read_b64 v[24:25], v2 offset:2048
    ds_read_b64 v[26:27], v3 offset:2048
    ds_read_b64 v[28:29], v4 offset:2048
    ds_read_b64 v[32:33], v2 offset:4096
    ds_read_b64 v[34:35], v3 offset:4096
    ds_read_b64 v[36:37], v4 offset:4096
    ds_read_b64 v[40:41], v2 offset:6144
    ds_read_b64 v[42:43], v3 offset:6144
    ds_read_b64 v[44:45], v4 offset:6144
    ds_read_b64 v[48:49], v2 offset:8192
    ds_read_b64 v[50:51], v3 offset:8192
    ds_read_b64 v[52:53], v4 offset:8192
    ds_read_b64 v[56:57], v2 offset:10240
    ds_read_b64 v[58:59], v3 offset:10240
    ds_read_b64 v[60:61], v4 offset:10240
    ds_read_b64 v[64:65], v2 offset:12288
    ds_read_b64 v[66:67], v3 offset:12288
    ds_read_b64 v[68:69], v4 offset:12288
    ds_read_b64 v[72:73], v2 offset:14336
    ds_read_b64 v[74:75], v3 offset:14336
    ds_read_b64 v[76:77], v4 offset:14336
    ds_read_b64 v[80:81], v2 offset:16384
    ds_read_b64 v[82:83], v3 offset:16384
    ds_read_b64 v[84:85], v4 offset:16384
    ds_read_b64 v[88:89], v2 offset:18432
    ds_read_b64 v[90:91], v3 offset:18432
    ds_read_b64 v[92:93], v4 offset:18432
    s_mov_b32 s28, 0
    s_waitcnt vmcnt(0)
    v_cmp_eq_u32 vcc, 0, v244
    s_barrier
    s_nop 3
    s_cbranch_vccnz L_p2_wbspin
L_p2_wbok:
    s_cmp_lt_u32 s2, 144
    s_cbranch_scc1 L_p2_nt
    s_sub_u32 s70, s2, 144
    s_lshr_b32 s71, s70, 3
    s_and_b32 s70, s70, 1
    s_mul_i32 s70, s70, 14
    s_add_u32 s70, s70, s71
    s_lshl_b32 s70, s70, 2
    s_add_u32 s70, s70, s3
    s_and_b32 s71, s70, 1
    s_cmp_eq_u32 s71, 0
    s_cselect_b32 s60, s72, s74
    s_cselect_b32 s61, s73, s75
    s_mov_b32 s62, 5308416
    s_mov_b32 s63, 0x20000
    s_lshr_b32 s70, s70, 1
    s_mul_i32 s70, s70, 11
    v_lshrrev_b32 v176, 2, v0
    v_add_u32 v176, s70, v176
    v_mul_u32_u24 v176, 9216, v176
    v_and_b32 v177, 1, v0
    v_mul_u32_u24 v177, 640, v177
    v_bfe_u32 v178, v0, 1, 1
    v_mul_u32_u24 v178, 1152, v178
    v_add3_u32 v176, v176, v177, v178
    s_bfe_u32 s70, s2, 0x20001
    s_mul_i32 s70, s70, 2304
    v_add_u32 v176, s70, v176
    s_mov_b32 exec_hi, 0xfff
    s_mov_b32 s70, 0
    buffer_load_dword v177, v176, s[60:63], s70 offen offset:0
    s_mov_b64 exec, -1
    s_mov_b32 s62, 0
    s_mov_b32 s71, 0x40000000
L_p2_nt:
    s_waitcnt lgkmcnt(0)
L_p2_pass2:
    v_mfma_f32_32x32x16_bf16 v[144:159], v[16:19], v[96:99], v[112:127]
    v_mfma_f32_32x32x16_bf16 v[144:159], v[20:23], v[100:103], v[144:159]
L_p2_pass2b:
    ds_read_b128 a[0:3], v7 offset:0
    ds_read_b128 a[4:7], v7 offset:1024
    s_nop 9
    v_exp_f32 v144, v144
    v_exp_f32 v145, v145
    v_exp_f32 v146, v146
    v_exp_f32 v147, v147
    v_exp_f32 v148, v148
    v_mfma_f32_32x32x16_bf16 v[160:175], v[24:27], v[96:99], 0
    ds_read_b128 a[8:11], v7 offset:2048
    ds_read_b128 a[12:15], v7 offset:3072
    v_exp_f32 v149, v149
    v_exp_f32 v150, v150
    v_exp_f32 v151, v151
    v_mfma_f32_32x32x16_bf16 v[160:175], v[28:31], v[100:103], v[160:175]
    v_exp_f32 v152, v152
    v_cvt_pk_bf16_f32 v192, v144, v145
    v_cvt_pk_bf16_f32 v193, v146, v147
    v_cvt_pk_bf16_f32 v194, v148, v149
    v_cvt_pk_bf16_f32 v195, v150, v151
    v_exp_f32 v153, v153
    v_exp_f32 v154, v154
    s_waitcnt lgkmcnt(2)
    v_mfma_f32_32x32x16_bf16 v[208:223], a[0:3], v[192:195], 0
    v_exp_f32 v155, v155
    v_exp_f32 v156, v156
    v_exp_f32 v157, v157
    v_exp_f32 v158, v158
    v_exp_f32 v159, v159
    v_cvt_pk_bf16_f32 v196, v152, v153
    v_cvt_pk_bf16_f32 v197, v154, v155
    v_cvt_pk_bf16_f32 v198, v156, v157
    v_cvt_pk_bf16_f32 v199, v158, v159
    v_exp_f32 v160, v160
    v_exp_f32 v161, v161
    v_mfma_f32_32x32x16_bf16 v[208:223], a[4:7], v[196:199], v[208:223]
    s_add_u32 m0, s58, 0
    s_mov_b32 s59, 0
    v_exp_f32 v162, v162
    v_exp_f32 v163, v163
    v_exp_f32 v164, v164
    v_mfma_f32_32x32x16_bf16 v[144:159], v[24:27], v[104:107], v[112:127]
    ds_read_b128 a[0:3], v7 offset:4096
    ds_read_b128 a[4:7], v7 offset:5120
    v_exp_f32 v165, v165
    v_exp_f32 v166, v166
    v_exp_f32 v167, v167
    buffer_load_dwordx4 v250, s[52:55], s59 offen offset:0 lds
    v_mfma_f32_32x32x16_bf16 v[144:159], v[28:31], v[108:111], v[144:159]
    v_exp_f32 v168, v168
    v_cvt_pk_bf16_f32 v200, v160, v161
    v_cvt_pk_bf16_f32 v201, v162, v163
    v_cvt_pk_bf16_f32 v202, v164, v165
    v_cvt_pk_bf16_f32 v203, v166, v167
    v_exp_f32 v169, v169
    v_exp_f32 v170, v170
    s_waitcnt lgkmcnt(2)
    v_mfma_f32_32x32x16_bf16 v[208:223], a[8:11], v[200:203], v[208:223]
    v_exp_f32 v171, v171
    v_exp_f32 v172, v172
    v_exp_f32 v173, v173
    v_exp_f32 v174, v174
    v_exp_f32 v175, v175
    v_cvt_pk_bf16_f32 v204, v168, v169
    v_cvt_pk_bf16_f32 v205, v170, v171
    v_cvt_pk_bf16_f32 v206, v172, v173
    v_cvt_pk_bf16_f32 v207, v174, v175
    v_exp_f32 v144, v144
    v_exp_f32 v145, v145
    v_mfma_f32_32x32x16_bf16 v[208:223], a[12:15], v[204:207], v[208:223]
    s_mov_b32 s59, 40448
    buffer_load_dwordx4 v250, s[52:55], s59 offen offset:1024 lds
    s_mov_b32 s59, 80896
    v_exp_f32 v146, v146
    v_exp_f32 v147, v147
    v_exp_f32 v148, v148
    v_mfma_f32_32x32x16_bf16 v[160:175], v[32:35], v[96:99], 0
    v_exp_f32 v149, v149
    v_exp_f32 v150, v150
    v_exp_f32 v151, v151
    buffer_load_dwordx4 v250, s[52:55], s59 offen offset:2048 lds
    v_mfma_f32_32x32x16_bf16 v[160:175], v[36:39], v[100:103], v[160:175]
    v_exp_f32 v152, v152
    v_cvt_pk_bf16_f32 v192, v144, v145
    v_cvt_pk_bf16_f32 v193, v146, v147
    v_cvt_pk_bf16_f32 v194, v148, v149
    v_cvt_pk_bf16_f32 v195, v150, v151
    v_exp_f32 v153, v153
    v_exp_f32 v154, v154
    v_mfma_f32_32x32x16_bf16 v[224:239], a[8:11], v[192:195], 0
    v_exp_f32 v155, v155
    v_exp_f32 v156, v156
    v_exp_f32 v157, v157
    v_exp_f32 v158, v158
    v_exp_f32 v159, v159
    v_cvt_pk_bf16_f32 v196, v152, v153
    v_cvt_pk_bf16_f32 v197, v154, v155
    v_cvt_pk_bf16_f32 v198, v156, v157
    v_cvt_pk_bf16_f32 v199, v158, v159
    v_exp_f32 v160, v160
    v_exp_f32 v161, v161
    v_mfma_f32_32x32x16_bf16 v[224:239], a[12:15], v[196:199], v[224:239]
    s_mov_b32 s59, 121344
    v_exp_f32 v162, v162
    v_exp_f32 v163, v163
    v_exp_f32 v164, v164
    v_mfma_f32_32x32x16_bf16 v[144:159], v[32:35], v[104:107], 0
    ds_read_b128 a[8:11], v7 offset:6144
    ds_read_b128 a[12:15], v7 offset:7168
    v_exp_f32 v165, v165
    v_exp_f32 v166, v166
    v_exp_f32 v167, v167
    buffer_load_dwordx4 v250, s[52:55], s59 offen offset:3072 lds
    v_mfma_f32_32x32x16_bf16 v[144:159], v[36:39], v[108:111], v[144:159]
    v_exp_f32 v168, v168
    v_cvt_pk_bf16_f32 v200, v160, v161
    v_cvt_pk_bf16_f32 v201, v162, v163
    v_cvt_pk_bf16_f32 v202, v164, v165
    v_cvt_pk_bf16_f32 v203, v166, v167
    v_exp_f32 v169, v169
    v_exp_f32 v170, v170
    s_waitcnt lgkmcnt(2)
    v_mfma_f32_32x32x16_bf16 v[208:223], a[0:3], v[200:203], v[208:223]
    v_exp_f32 v171, v171
    v_exp_f32 v172, v172
    v_exp_f32 v173, v173
    v_exp_f32 v174, v174
    v_exp_f32 v175, v175
    v_cvt_pk_bf16_f32 v204, v168, v169
    v_cvt_pk_bf16_f32 v205, v170, v171
    v_cvt_pk_bf16_f32 v206, v172, v173
    v_cvt_pk_bf16_f32 v207, v174, v175
    v_exp_f32 v144, v144
    v_exp_f32 v145, v145
    v_mfma_f32_32x32x16_bf16 v[208:223], a[4:7], v[204:207], v[208:223]
    s_add_u32 m0, s58, 4096
    s_mov_b32 s59, 165888
    buffer_load_dwordx4 v250, s[52:55], s59 offen offset:0 lds
    s_mov_b32 s59, 206336
    v_exp_f32 v146, v146
    v_exp_f32 v147, v147
    v_exp_f32 v148, v148
    v_mfma_f32_32x32x16_bf16 v[160:175], v[40:43], v[96:99], 0
    v_exp_f32 v149, v149
    v_exp_f32 v150, v150
    v_exp_f32 v151, v151
    buffer_load_dwordx4 v250, s[52:55], s59 offen offset:1024 lds
    v_mfma_f32_32x32x16_bf16 v[160:175], v[44:47], v[100:103], v[160:175]
    v_exp_f32 v152, v152
    v_cvt_pk_bf16_f32 v192, v144, v145
    v_cvt_pk_bf16_f32 v193, v146, v147
    v_cvt_pk_bf16_f32 v194, v148, v149
    v_cvt_pk_bf16_f32 v195, v150, v151
    v_exp_f32 v153, v153
    v_exp_f32 v154, v154
    v_mfma_f32_32x32x16_bf16 v[224:239], a[0:3], v[192:195], v[224:239]
    v_exp_f32 v155, v155
    v_exp_f32 v156, v156
    v_exp_f32 v157, v157
    v_exp_f32 v158, v158
    v_exp_f32 v159, v159
    v_cvt_pk_bf16_f32 v196, v152, v153
    v_cvt_pk_bf16_f32 v197, v154, v155
    v_cvt_pk_bf16_f32 v198, v156, v157
    v_cvt_pk_bf16_f32 v199, v158, v159
    v_exp_f32 v160, v160
    v_exp_f32 v161, v161
    v_mfma_f32_32x32x16_bf16 v[224:239], a[4:7], v[196:199], v[224:239]
    s_mov_b32 s59, 246784
    v_exp_f32 v162, v162
    v_exp_f32 v163, v163
    v_exp_f32 v164, v164
    v_mfma_f32_32x32x16_bf16 v[144:159], v[40:43], v[104:107], 0
    ds_read_b128 a[0:3], v7 offset:8192
    ds_read_b128 a[4:7], v7 offset:9216
    v_exp_f32 v165, v165
    v_exp_f32 v166, v166
    v_exp_f32 v167, v167
    buffer_load_dwordx4 v250, s[52:55], s59 offen offset:2048 lds
    v_mfma_f32_32x32x16_bf16 v[144:159], v[44:47], v[108:111], v[144:159]
    v_exp_f32 v168, v168
    v_cvt_pk_bf16_f32 v200, v160, v161
    v_cvt_pk_bf16_f32 v201, v162, v163
    v_cvt_pk_bf16_f32 v202, v164, v165
    v_cvt_pk_bf16_f32 v203, v166, v167
    v_exp_f32 v169, v169
    v_exp_f32 v170, v170
    s_waitcnt lgkmcnt(2)
    v_mfma_f32_32x32x16_bf16 v[208:223], a[8:11], v[200:203], v[208:223]
    v_exp_f32 v171, v171
    v_exp_f32 v172, v172
    v_exp_f32 v173, v173
    v_exp_f32 v174, v174
    v_exp_f32 v175, v175
    v_cvt_pk_bf16_f32 v204, v168, v169
    v_cvt_pk_bf16_f32 v205, v170, v171
    v_cvt_pk_bf16_f32 v206, v172, v173
    v_cvt_pk_bf16_f32 v207, v174, v175
    v_exp_f32 v144, v144
    v_exp_f32 v145, v145
    v_mfma_f32_32x32x16_bf16 v[208:223], a[12:15], v[204:207], v[208:223]
    s_mov_b32 s59, 287232
    buffer_load_dwordx4 v250, s[52:55], s59 offen offset:3072 lds
    s_add_u32 m0, s58, 8192
    s_mov_b32 s59, 331776
    v_exp_f32 v146, v146
    v_exp_f32 v147, v147
    v_exp_f32 v148, v148
    v_mfma_f32_32x32x16_bf16 v[160:175], v[48:51], v[96:99], 0
    v_exp_f32 v149, v149
    v_exp_f32 v150, v150
    v_exp_f32 v151, v151
    buffer_load_dwordx4 v250, s[52:55], s59 offen offset:0 lds
    v_mfma_f32_32x32x16_bf16 v[160:175], v[52:55], v[100:103], v[160:175]
    v_exp_f32 v152, v152
    v_cvt_pk_bf16_f32 v192, v144, v145
    v_cvt_pk_bf16_f32 v193, v146, v147
    v_cvt_pk_bf16_f32 v194, v148, v149
    v_cvt_pk_bf16_f32 v195, v150, v151
    v_exp_f32 v153, v153
    v_exp_f32 v154, v154
    v_mfma_f32_32x32x16_bf16 v[224:239], a[8:11], v[192:195], v[224:239]
    v_exp_f32 v155, v155
    v_exp_f32 v156, v156
    v_exp_f32 v157, v157
    v_exp_f32 v158, v158
    v_exp_f32 v159, v159
    v_cvt_pk_bf16_f32 v196, v152, v153
    v_cvt_pk_bf16_f32 v197, v154, v155
    v_cvt_pk_bf16_f32 v198, v156, v157
    v_cvt_pk_bf16_f32 v199, v158, v159
    v_exp_f32 v160, v160
    v_exp_f32 v161, v161
    v_mfma_f32_32x32x16_bf16 v[224:239], a[12:15], v[196:199], v[224:239]
    s_mov_b32 s59, 372224
    v_exp_f32 v162, v162
    v_exp_f32 v163, v163
    v_exp_f32 v164, v164
    v_mfma_f32_32x32x16_bf16 v[144:159], v[48:51], v[104:107], 0
    ds_read_b128 a[8:11], v7 offset:10240
    ds_read_b128 a[12:15], v7 offset:11264
    v_exp_f32 v165, v165
    v_exp_f32 v166, v166
    v_exp_f32 v167, v167
    buffer_load_dwordx4 v250, s[52:55], s59 offen offset:1024 lds
    v_mfma_f32_32x32x16_bf16 v[144:159], v[52:55], v[108:111], v[144:159]
    v_exp_f32 v168, v168
    v_cvt_pk_bf16_f32 v200, v160, v161
    v_cvt_pk_bf16_f32 v201, v162, v163
    v_cvt_pk_bf16_f32 v202, v164, v165
    v_cvt_pk_bf16_f32 v203, v166, v167
    v_exp_f32 v169, v169
    v_exp_f32 v170, v170
    s_waitcnt lgkmcnt(2)
    v_mfma_f32_32x32x16_bf16 v[208:223], a[0:3], v[200:203], v[208:223]
    v_exp_f32 v171, v171
    v_exp_f32 v172, v172
    v_exp_f32 v173, v173
    v_exp_f32 v174, v174
    v_exp_f32 v175, v175
    v_cvt_pk_bf16_f32 v204, v168, v169
    v_cvt_pk_bf16_f32 v205, v170, v171
    v_cvt_pk_bf16_f32 v206, v172, v173
    v_cvt_pk_bf16_f32 v207, v174, v175
    v_exp_f32 v144, v144
    v_exp_f32 v145, v145
    v_mfma_f32_32x32x16_bf16 v[208:223], a[4:7], v[204:207], v[208:223]
    s_mov_b32 s59, 412672
    buffer_load_dwordx4 v250, s[52:55], s59 offen offset:2048 lds
    s_mov_b32 s59, 453120
    v_exp_f32 v146, v146
    v_exp_f32 v147, v147
    v_exp_f32 v148, v148
    v_mfma_f32_32x32x16_bf16 v[160:175], v[56:59], v[96:99], 0
    v_exp_f32 v149, v149
    v_exp_f32 v150, v150
    v_exp_f32 v151, v151
    buffer_load_dwordx4 v250, s[52:55], s59 offen offset:3072 lds
    v_mfma_f32_32x32x16_bf16 v[160:175], v[60:63], v[100:103], v[160:175]
    v_exp_f32 v152, v152
    v_cvt_pk_bf16_f32 v192, v144, v145
    v_cvt_pk_bf16_f32 v193, v146, v147
    v_cvt_pk_bf16_f32 v194, v148, v149
    v_cvt_pk_bf16_f32 v195, v150, v151
    v_exp_f32 v153, v153
    v_exp_f32 v154, v154
    v_mfma_f32_32x32x16_bf16 v[224:239], a[0:3], v[192:195], v[224:239]
    v_exp_f32 v155, v155
    v_exp_f32 v156, v156
    v_exp_f32 v157, v157
    v_exp_f32 v158, v158
    v_exp_f32 v159, v159
    v_cvt_pk_bf16_f32 v196, v152, v153
    v_cvt_pk_bf16_f32 v197, v154, v155
    v_cvt_pk_bf16_f32 v198, v156, v157
    v_cvt_pk_bf16_f32 v199, v158, v159
    v_exp_f32 v160, v160
    v_exp_f32 v161, v161
    v_mfma_f32_32x32x16_bf16 v[224:239], a[4:7], v[196:199], v[224:239]
    s_add_u32 m0, s58, 12288
    s_mov_b32 s59, 497664
    v_exp_f32 v162, v162
    v_exp_f32 v163, v163
    v_exp_f32 v164, v164
    v_mfma_f32_32x32x16_bf16 v[144:159], v[56:59], v[104:107], 0
    ds_read_b128 a[0:3], v7 offset:12288
    ds_read_b128 a[4:7], v7 offset:13312
    v_exp_f32 v165, v165
    v_exp_f32 v166, v166
    v_exp_f32 v167, v167
    buffer_load_dwordx4 v250, s[52:55], s59 offen offset:0 lds
    v_mfma_f32_32x32x16_bf16 v[144:159], v[60:63], v[108:111], v[144:159]
    v_exp_f32 v168, v168
    v_cvt_pk_bf16_f32 v200, v160, v161
    v_cvt_pk_bf16_f32 v201, v162, v163
    v_cvt_pk_bf16_f32 v202, v164, v165
    v_cvt_pk_bf16_f32 v203, v166, v167
    v_exp_f32 v169, v169
    v_exp_f32 v170, v170
    s_waitcnt lgkmcnt(2)
    v_mfma_f32_32x32x16_bf16 v[208:223], a[8:11], v[200:203], v[208:223]
    v_exp_f32 v171, v171
    v_exp_f32 v172, v172
    v_exp_f32 v173, v173
    v_exp_f32 v174, v174
    v_exp_f32 v175, v175
    v_cvt_pk_bf16_f32 v204, v168, v169
    v_cvt_pk_bf16_f32 v205, v170, v171
    v_cvt_pk_bf16_f32 v206, v172, v173
    v_cvt_pk_bf16_f32 v207, v174, v175
    v_exp_f32 v144, v144
    v_exp_f32 v145, v145
    v_mfma_f32_32x32x16_bf16 v[208:223], a[12:15], v[204:207], v[208:223]
    s_mov_b32 s59, 538112
    buffer_load_dwordx4 v250, s[52:55], s59 offen offset:1024 lds
    s_mov_b32 s59, 578560
    v_exp_f32 v146, v146
    v_exp_f32 v147, v147
    v_exp_f32 v148, v148
    v_mfma_f32_32x32x16_bf16 v[160:175], v[64:67], v[96:99], 0
    v_exp_f32 v149, v149
    v_exp_f32 v150, v150
    v_exp_f32 v151, v151
    buffer_load_dwordx4 v250, s[52:55], s59 offen offset:2048 lds
    v_mfma_f32_32x32x16_bf16 v[160:175], v[68:71], v[100:103], v[160:175]
    v_exp_f32 v152, v152
    v_cvt_pk_bf16_f32 v192, v144, v145
    v_cvt_pk_bf16_f32 v193, v146, v147
    v_cvt_pk_bf16_f32 v194, v148, v149
    v_cvt_pk_bf16_f32 v195, v150, v151
    v_exp_f32 v153, v153
    v_exp_f32 v154, v154
    v_mfma_f32_32x32x16_bf16 v[224:239], a[8:11], v[192:195], v[224:239]
    v_exp_f32 v155, v155
    v_exp_f32 v156, v156
    v_exp_f32 v157, v157
    v_exp_f32 v158, v158
    v_exp_f32 v159, v159
    v_cvt_pk_bf16_f32 v196, v152, v153
    v_cvt_pk_bf16_f32 v197, v154, v155
    v_cvt_pk_bf16_f32 v198, v156, v157
    v_cvt_pk_bf16_f32 v199, v158, v159
    v_exp_f32 v160, v160
    v_exp_f32 v161, v161
    v_mfma_f32_32x32x16_bf16 v[224:239], a[12:15], v[196:199], v[224:239]
    s_mov_b32 s59, 619008
    v_exp_f32 v162, v162
    v_exp_f32 v163, v163
    v_exp_f32 v164, v164
    v_mfma_f32_32x32x16_bf16 v[144:159], v[64:67], v[104:107], 0
    ds_read_b128 a[8:11], v7 offset:14336
    ds_read_b128 a[12:15], v7 offset:15360
    v_exp_f32 v165, v165
    v_exp_f32 v166, v166
    v_exp_f32 v167, v167
    buffer_load_dwordx4 v250, s[52:55], s59 offen offset:3072 lds
    v_mfma_f32_32x32x16_bf16 v[144:159], v[68:71], v[108:111], v[144:159]
    v_exp_f32 v168, v168
    v_cvt_pk_bf16_f32 v200, v160, v161
    v_cvt_pk_bf16_f32 v201, v162, v163
    v_cvt_pk_bf16_f32 v202, v164, v165
    v_cvt_pk_bf16_f32 v203, v166, v167
    v_exp_f32 v169, v169
    v_exp_f32 v170, v170
    s_waitcnt lgkmcnt(2)
    v_mfma_f32_32x32x16_bf16 v[208:223], a[0:3], v[200:203], v[208:223]
    v_exp_f32 v171, v171
    v_exp_f32 v172, v172
    v_exp_f32 v173, v173
    v_exp_f32 v174, v174
    v_exp_f32 v175, v175
    v_cvt_pk_bf16_f32 v204, v168, v169
    v_cvt_pk_bf16_f32 v205, v170, v171
    v_cvt_pk_bf16_f32 v206, v172, v173
    v_cvt_pk_bf16_f32 v207, v174, v175
    v_exp_f32 v144, v144
    v_exp_f32 v145, v145
    v_mfma_f32_32x32x16_bf16 v[208:223], a[4:7], v[204:207], v[208:223]
    s_add_u32 m0, s58, 16384
    s_mov_b32 s59, 330752
    buffer_load_dwordx4 v251, s[52:55], 0 offen lds
    v_exp_f32 v146, v146
    v_exp_f32 v147, v147
    v_exp_f32 v148, v148
    v_mfma_f32_32x32x16_bf16 v[160:175], v[72:75], v[96:99], 0
    v_exp_f32 v149, v149
    v_exp_f32 v150, v150
    v_exp_f32 v151, v151
    buffer_load_dwordx4 v251, s[52:55], s59 offen offset:1024 lds
    v_mfma_f32_32x32x16_bf16 v[160:175], v[76:79], v[100:103], v[160:175]
    v_exp_f32 v152, v152
    v_cvt_pk_bf16_f32 v192, v144, v145
    v_cvt_pk_bf16_f32 v193, v146, v147
    v_cvt_pk_bf16_f32 v194, v148, v149
    v_cvt_pk_bf16_f32 v195, v150, v151
    v_exp_f32 v153, v153
    v_exp_f32 v154, v154
    v_mfma_f32_32x32x16_bf16 v[224:239], a[0:3], v[192:195], v[224:239]
    v_exp_f32 v155, v155
    v_exp_f32 v156, v156
    v_exp_f32 v157, v157
    v_exp_f32 v158, v158
    v_exp_f32 v159, v159
    v_cvt_pk_bf16_f32 v196, v152, v153
    v_cvt_pk_bf16_f32 v197, v154, v155
    v_cvt_pk_bf16_f32 v198, v156, v157
    v_cvt_pk_bf16_f32 v199, v158, v159
    v_exp_f32 v160, v160
    v_exp_f32 v161, v161
    v_mfma_f32_32x32x16_bf16 v[224:239], a[4:7], v[196:199], v[224:239]
    s_mov_b32 m0, s8
    s_nop 0
    v_exp_f32 v162, v162
    v_exp_f32 v163, v163
    v_exp_f32 v164, v164
    v_mfma_f32_32x32x16_bf16 v[144:159], v[72:75], v[104:107], 0
    ds_read_b128 a[0:3], v7 offset:16384
    ds_read_b128 a[4:7], v7 offset:17408
    v_exp_f32 v165, v165
    v_exp_f32 v166, v166
    v_exp_f32 v167, v167
    buffer_load_dwordx4 v1, s[24:27], s9 offen sc1 lds
    v_mfma_f32_32x32x16_bf16 v[144:159], v[76:79], v[108:111], v[144:159]
    v_exp_f32 v168, v168
    v_cvt_pk_bf16_f32 v200, v160, v161
    v_cvt_pk_bf16_f32 v201, v162, v163
    v_cvt_pk_bf16_f32 v202, v164, v165
    v_cvt_pk_bf16_f32 v203, v166, v167
    v_exp_f32 v169, v169
    v_exp_f32 v170, v170
    s_waitcnt lgkmcnt(2)
    v_mfma_f32_32x32x16_bf16 v[208:223], a[8:11], v[200:203], v[208:223]
    v_exp_f32 v171, v171
    v_exp_f32 v172, v172
    v_exp_f32 v173, v173
    v_exp_f32 v174, v174
    v_exp_f32 v175, v175
    v_cvt_pk_bf16_f32 v204, v168, v169
    v_cvt_pk_bf16_f32 v205, v170, v171
    v_cvt_pk_bf16_f32 v206, v172, v173
    v_cvt_pk_bf16_f32 v207, v174, v175
    v_exp_f32 v144, v144
    v_exp_f32 v145, v145
    v_mfma_f32_32x32x16_bf16 v[208:223], a[12:15], v[204:207], v[208:223]
    buffer_load_dwordx4 v[176:179], v246, s[60:63], s70 offen offset:0
    v_exp_f32 v146, v146
    v_exp_f32 v147, v147
    v_exp_f32 v148, v148
    v_mfma_f32_32x32x16_bf16 v[160:175], v[80:83], v[96:99], v[128:143]
    v_exp_f32 v149, v149
    v_exp_f32 v150, v150
    v_exp_f32 v151, v151
    buffer_load_dwordx4 v[180:183], v246, s[60:63], s70 offen offset:32
    v_mfma_f32_32x32x16_bf16 v[160:175], v[84:87], v[100:103], v[160:175]
    v_exp_f32 v152, v152
    v_cvt_pk_bf16_f32 v192, v144, v145
    v_cvt_pk_bf16_f32 v193, v146, v147
    v_cvt_pk_bf16_f32 v194, v148, v149
    v_cvt_pk_bf16_f32 v195, v150, v151
    v_exp_f32 v153, v153
    v_exp_f32 v154, v154
    v_mfma_f32_32x32x16_bf16 v[224:239], a[8:11], v[192:195], v[224:239]
    v_exp_f32 v155, v155
    v_exp_f32 v156, v156
    v_exp_f32 v157, v157
    v_exp_f32 v158, v158
    v_exp_f32 v159, v159
    v_cvt_pk_bf16_f32 v196, v152, v153
    v_cvt_pk_bf16_f32 v197, v154, v155
    v_cvt_pk_bf16_f32 v198, v156, v157
    v_cvt_pk_bf16_f32 v199, v158, v159
    v_exp_f32 v160, v160
    v_exp_f32 v161, v161
    v_mfma_f32_32x32x16_bf16 v[224:239], a[12:15], v[196:199], v[224:239]
    v_exp_f32 v162, v162
    v_exp_f32 v163, v163
    v_exp_f32 v164, v164
    v_mfma_f32_32x32x16_bf16 v[144:159], v[80:83], v[104:107], 0
    ds_read_b128 a[8:11], v7 offset:18432
    ds_read_b128 a[12:15], v7 offset:19456
    v_exp_f32 v165, v165
    v_exp_f32 v166, v166
    v_exp_f32 v167, v167
    buffer_load_dwordx4 v[184:187], v246, s[60:63], s70 offen offset:64
    v_mfma_f32_32x32x16_bf16 v[144:159], v[84:87], v[108:111], v[144:159]
    v_exp_f32 v168, v168
    v_cvt_pk_bf16_f32 v200, v160, v161
    v_cvt_pk_bf16_f32 v201, v162, v163
    v_cvt_pk_bf16_f32 v202, v164, v165
    v_cvt_pk_bf16_f32 v203, v166, v167
    v_exp_f32 v169, v169
    v_exp_f32 v170, v170
    s_waitcnt lgkmcnt(2)
    v_mfma_f32_32x32x16_bf16 v[208:223], a[0:3], v[200:203], v[208:223]
    v_exp_f32 v171, v171
    v_exp_f32 v172, v172
    v_exp_f32 v173, v173
    v_exp_f32 v174, v174
    v_exp_f32 v175, v175
    v_cvt_pk_bf16_f32 v204, v168, v169
    v_cvt_pk_bf16_f32 v205, v170, v171
    v_cvt_pk_bf16_f32 v206, v172, v173
    v_cvt_pk_bf16_f32 v207, v174, v175
    v_exp_f32 v144, v144
    v_exp_f32 v145, v145
    v_mfma_f32_32x32x16_bf16 v[208:223], a[4:7], v[204:207], v[208:223]
    buffer_load_dwordx4 v[188:191], v246, s[60:63], s70 offen offset:96
    v_exp_f32 v146, v146
    v_exp_f32 v147, v147
    v_exp_f32 v148, v148
    v_mfma_f32_32x32x16_bf16 v[160:175], v[88:91], v[104:107], v[128:143]
    v_exp_f32 v149, v149
    v_exp_f32 v150, v150
    v_exp_f32 v151, v151
    buffer_load_dword v249, v247, s[24:27], s71 offen offset:12 sc1
    v_mfma_f32_32x32x16_bf16 v[160:175], v[92:95], v[108:111], v[160:175]
    v_exp_f32 v152, v152
    v_cvt_pk_bf16_f32 v192, v144, v145
    v_cvt_pk_bf16_f32 v193, v146, v147
    v_cvt_pk_bf16_f32 v194, v148, v149
    v_cvt_pk_bf16_f32 v195, v150, v151
    v_exp_f32 v153, v153
    v_exp_f32 v154, v154
    v_mfma_f32_32x32x16_bf16 v[224:239], a[0:3], v[192:195], v[224:239]
    v_exp_f32 v155, v155
    v_exp_f32 v156, v156
    v_exp_f32 v157, v157
    v_exp_f32 v158, v158
    v_exp_f32 v159, v159
    v_cvt_pk_bf16_f32 v196, v152, v153
    v_cvt_pk_bf16_f32 v197, v154, v155
    v_cvt_pk_bf16_f32 v198, v156, v157
    v_cvt_pk_bf16_f32 v199, v158, v159
    v_exp_f32 v160, v160
    v_exp_f32 v161, v161
    v_mfma_f32_32x32x16_bf16 v[224:239], a[4:7], v[196:199], v[224:239]
    v_exp_f32 v162, v162
    v_exp_f32 v163, v163
    v_exp_f32 v164, v164
    v_exp_f32 v165, v165
    v_exp_f32 v166, v166
    v_exp_f32 v167, v167
    v_exp_f32 v168, v168
    v_cvt_pk_bf16_f32 v200, v160, v161
    v_cvt_pk_bf16_f32 v201, v162, v163
    v_cvt_pk_bf16_f32 v202, v164, v165
    v_cvt_pk_bf16_f32 v203, v166, v167
    v_exp_f32 v169, v169
    v_exp_f32 v170, v170
    s_waitcnt lgkmcnt(0)
    v_mfma_f32_32x32x16_bf16 v[224:239], a[8:11], v[200:203], v[224:239]
    v_exp_f32 v171, v171
    v_exp_f32 v172, v172
    v_exp_f32 v173, v173
    v_exp_f32 v174, v174
    v_exp_f32 v175, v175
    v_cvt_pk_bf16_f32 v204, v168, v169
    v_cvt_pk_bf16_f32 v205, v170, v171
    v_cvt_pk_bf16_f32 v206, v172, v173
    v_cvt_pk_bf16_f32 v207, v174, v175
    s_nop 1
    v_mfma_f32_32x32x16_bf16 v[224:239], a[12:15], v[204:207], v[224:239]
    s_and_b32 s23, s12, 1
    s_cmp_eq_u32 s23, 0
    s_cselect_b32 s32, -1, 0
    s_cselect_b32 s33, 0, -1
    s_cmp_lg_u32 s28, 0
    s_cbranch_scc1 L_p2_done
    v_mov_b32 v8, 0x30800000
    v_mov_b32 v10, 0x4e800000
    v_cmp_nge_f32 vcc, v218, v8
    v_cmp_nle_f32 s[34:35], v218, v10
    s_nop 1
    v_cmp_nge_f32 s[36:37], v234, v8
    v_cmp_nle_f32 s[38:39], v234, v10
    s_or_b64 vcc, vcc, s[34:35]
    s_or_b64 s[36:37], s[36:37], s[38:39]
    s_or_b64 vcc, vcc, s[36:37]
    s_and_b64 vcc, vcc, s[32:33]
    s_cbranch_scc1 L_p2_max
L_p2_done:
    s_lshl_b32 s21, s19, 5
    s_add_u32 s21, s21, s12
    s_lshl_b32 s21, s21, 10
    s_add_u32 s21, s21, 8388608
    s_lshl_b32 s22, s19, 4
    s_lshr_b32 s23, s12, 1
    s_add_u32 s22, s22, s23
    s_lshl_b32 s22, s22, 8
    s_add_u32 s22, s22, 10485760
    s_and_b32 s23, s12, 1
    s_cmp_eq_u32 s23, 0
    s_cselect_b64 vcc, -1, 0
    v_lshlrev_b32 v2, 2, v0
    v_mov_b32 v8, v218
    v_mov_b32 v9, v218
    s_nop 1
    v_permlane32_swap_b32 v8, v9
    v_cndmask_b32 v8, v9, v8, vcc
    v_rcp_f32 v8, v8
    s_nop 0
    v_mul_f32 v208, v8, v208
    v_mul_f32 v209, v8, v209
    v_mul_f32 v210, v8, v210
    v_mul_f32 v211, v8, v211
    v_mul_f32 v212, v8, v212
    v_mul_f32 v213, v8, v213
    v_mul_f32 v214, v8, v214
    v_mul_f32 v215, v8, v215
    v_mul_f32 v216, v8, v216
    v_mul_f32 v217, v8, v217
    v_cvt_pk_bf16_f32 v208, v208, v209
    v_cvt_pk_bf16_f32 v209, v210, v211
    v_cvt_pk_bf16_f32 v210, v212, v213
    v_cvt_pk_bf16_f32 v211, v214, v215
    v_cvt_pk_bf16_f32 v212, v216, v217
    buffer_store_dwordx4 v[208:211], v1, s[24:27], s21 offen sc1
    s_mov_b64 exec, s[32:33]
    buffer_store_dword v212, v2, s[24:27], s22 offen sc1
    s_mov_b64 exec, -1
    s_add_u32 s21, s21, 32768
    s_add_u32 s22, s22, 4096
    v_mov_b32 v8, v234
    v_mov_b32 v9, v234
    s_nop 1
    v_permlane32_swap_b32 v8, v9
    v_cndmask_b32 v8, v9, v8, vcc
    v_rcp_f32 v8, v8
    s_nop 0
    v_mul_f32 v224, v8, v224
    v_mul_f32 v225, v8, v225
    v_mul_f32 v226, v8, v226
    v_mul_f32 v227, v8, v227
    v_mul_f32 v228, v8, v228
    v_mul_f32 v229, v8, v229
    v_mul_f32 v230, v8, v230
    v_mul_f32 v231, v8, v231
    v_mul_f32 v232, v8, v232
    v_mul_f32 v233, v8, v233
    v_cvt_pk_bf16_f32 v224, v224, v225
    v_cvt_pk_bf16_f32 v225, v226, v227
    v_cvt_pk_bf16_f32 v226, v228, v229
    v_cvt_pk_bf16_f32 v227, v230, v231
    v_cvt_pk_bf16_f32 v228, v232, v233
    buffer_store_dwordx4 v[224:227], v1, s[24:27], s21 offen sc1
    s_mov_b64 exec, s[32:33]
    buffer_store_dword v228, v2, s[24:27], s22 offen sc1
    s_mov_b64 exec, -1
    s_add_u32 s21, s21, 32768
    s_add_u32 s22, s22, 4096
    s_lshl_b32 s47, s13, 5
    s_add_u32 s47, s47, s12
    s_lshl_b32 s47, s47, 7
    s_add_u32 s47, s47, 15892480
    s_and_b32 s12, s2, 7
    s_lshr_b32 s13, s2, 3
    s_and_b32 s14, s12, 1
    s_lshl_b32 s14, s14, 3
    s_and_b32 s15, s13, 7
    s_add_u32 s28, s14, s15
    s_lshr_b32 s14, s12, 1
    s_lshl_b32 s14, s14, 2
    s_lshr_b32 s15, s13, 3
    s_add_u32 s29, s14, s15
    s_and_b32 s30, s29, 1
    s_and_b32 s31, s3, 1
    s_lshr_b32 s32, s3, 1
    s_lshl_b32 s38, s3, 12
    s_mov_b32 s33, 72704
    s_mov_b32 s34, 145408
    s_mov_b32 s35, 218112
    s_lshr_b32 s15, s29, 1
    s_mul_i32 s61, s15, 1152
    s_cmp_eq_u32 s32, 0
    s_cselect_b32 s16, s72, s74
    s_cselect_b32 s17, s73, s75
    s_mov_b32 s18, 5308416
    s_mov_b32 s19, 0x20000
    v_lshrrev_b32 v2, 3, v0
    s_lshl_b32 s15, s31, 5
    v_add_u32 v15, s15, v2
    v_mul_u32_u24 v15, 9216, v15
    v_and_b32 v2, 2, v2
    v_and_b32 v3, 7, v0
    v_xor_b32 v2, v2, v3
    v_lshl_add_u32 v15, v2, 4, v15
    s_mul_i32 s15, s30, 640
    s_add_u32 s15, s15, s61
    s_and_b32 s13, s29, 3
    s_mul_i32 s13, s13, 0
    s_sub_u32 s8, 8, s13
    s_mul_i32 s13, s13, 589824
    s_add_u32 s15, s15, s13
    s_mov_b32 s9, 589824
    s_mov_b32 s12, 4290248704
    v_add_u32 v15, s15, v15
    v_xor_b32 v16, 64, v15
    s_lshl_b32 s14, s56, 2
    s_add_u32 s14, s14, s3
    v_lshlrev_b32 v1, 4, v0
    v_lshlrev_b32 v248, 2, v0
    s_lshl_b32 s10, s14, 15
    s_add_u32 s10, s10, 8388608
    s_lshl_b32 s11, s14, 12
    s_add_u32 s11, s11, 10485760
    v_lshrrev_b32 v2, 5, v0
    v_mul_u32_u24 v3, 18432, v2
    v_add_u32 v3, 81920, v3
    v_lshrrev_b32 v6, 2, v0
    v_and_b32 v6, 3, v6
    v_lshl_add_u32 v3, v6, 7, v3
    v_and_b32 v7, 2, v0
    v_lshl_add_u32 v3, v7, 2, v3
    v_and_b32 v6, 2, v6
    v_lshlrev_b32 v6, 1, v6
    v_lshrrev_b32 v7, 3, v0
    v_and_b32 v7, 2, v7
    v_or_b32 v6, v6, v7
    v_and_b32 v7, 1, v0
    v_or_b32 v6, v6, v7
    v_lshl_add_u32 v250, v6, 4, v3
    v_xor_b32 v6, 4, v6
    v_lshl_add_u32 v251, v6, 4, v3
    v_lshl_add_u32 v7, v2, 1, v7
    v_lshlrev_b32 v7, 4, v7
    v_add_u32 v252, 155648, v7
    v_lshrrev_b32 v6, 2, v0
    v_lshrrev_b32 v7, 4, v0
    v_xor_b32 v6, v6, v7
    v_and_b32 v6, 1, v6
    v_cmp_eq_u32 vcc, 0, v6
    v_mov_b32 v6, 159744
    s_nop 0
    v_cndmask_b32 v252, v6, v252, vcc
    v_and_b32 v7, 31, v0
    v_lshlrev_b32 v253, 2, v7
    s_lshr_b32 s15, s56, 1
    s_lshl_b32 s15, s15, 12
    s_add_u32 s15, s15, 15892480
    v_lshl_add_u32 v6, v0, 7, s15
    v_mov_b32 v3, 1
    s_and_b32 s52, s57, 7
    s_lshl_b32 s53, s52, 12
    s_mov_b32 s54, s10
    s_add_u32 s10, s10, s53
    s_lshl_b32 s55, s52, 11
    v_add_u32 v250, s55, v250
    v_add_u32 v251, s55, v251
    s_lshl_b32 s55, s52, 8
    v_add_u32 v252, s55, v252
    s_waitcnt vmcnt(0) lgkmcnt(0)
    s_barrier
    s_cmp_lg_u32 s3, 0
    s_cbranch_scc1 L_sig4
    v_mov_b32 v2, 1
    s_mov_b64 exec, 1
    buffer_store_dword v2, off, s[24:27], s47 sc1
    s_mov_b64 exec, -1
L_sig4:
    s_cmp_ge_u32 s2, 144
    s_cbranch_scc1 L_p3_idle
    v_lshlrev_b32 v56, 16, v176
    v_and_b32 v57, 0xffff0000, v176
    v_lshlrev_b32 v58, 16, v177
    v_and_b32 v59, 0xffff0000, v177
    v_lshlrev_b32 v60, 16, v178
    v_and_b32 v61, 0xffff0000, v178
    v_lshlrev_b32 v62, 16, v179
    v_and_b32 v63, 0xffff0000, v179
    v_lshlrev_b32 v64, 16, v180
    v_and_b32 v65, 0xffff0000, v180
    v_lshlrev_b32 v66, 16, v181
    v_and_b32 v67, 0xffff0000, v181
    v_lshlrev_b32 v68, 16, v182
    v_and_b32 v69, 0xffff0000, v182
    v_lshlrev_b32 v70, 16, v183
    v_and_b32 v71, 0xffff0000, v183
    v_lshlrev_b32 v72, 16, v184
    v_and_b32 v73, 0xffff0000, v184
    v_lshlrev_b32 v74, 16, v185
    v_and_b32 v75, 0xffff0000, v185
    v_lshlrev_b32 v76, 16, v186
    v_and_b32 v77, 0xffff0000, v186
    v_lshlrev_b32 v78, 16, v187
    v_and_b32 v79, 0xffff0000, v187
    v_lshlrev_b32 v80, 16, v188
    v_and_b32 v81, 0xffff0000, v188
    v_lshlrev_b32 v82, 16, v189
    v_and_b32 v83, 0xffff0000, v189
    v_lshlrev_b32 v84, 16, v190
    v_and_b32 v85, 0xffff0000, v190
    v_lshlrev_b32 v86, 16, v191
    v_and_b32 v87, 0xffff0000, v191
    v_mov_b32 v88, v249
    v_mov_b32 v89, 0
    v_mov_b32 v90, 0
    v_mov_b32 v91, 0
    s_cmp_lg_u32 s3, 0
    s_cbranch_scc1 L_pdone5
    s_mov_b32 s15, 0
    s_mov_b32 exec_lo, 4294967295
    s_mov_b32 exec_hi, 0
L_poll5:
    buffer_load_dword v4, v6, s[24:27], 0 offen sc1
    s_add_u32 s15, s15, 1
    s_waitcnt vmcnt(0)
    v_cmp_lt_u32 vcc, v4, v3
    s_cmp_gt_u32 s15, 1048576
    s_cbranch_scc1 L_pexit5
    s_nop 2
    s_cbranch_vccz L_pexit5
    s_sleep 1
    s_branch L_poll5
L_pexit5:
    s_mov_b64 exec, -1
L_pdone5:
    s_waitcnt vmcnt(0)
    s_barrier
    buffer_load_dwordx4 a[0:3], v1, s[24:27], s10 offen offset:0 sc1
    buffer_load_dwordx4 a[4:7], v1, s[24:27], s10 offen offset:1024 sc1
    buffer_load_dwordx4 a[8:11], v1, s[24:27], s10 offen offset:2048 sc1
    buffer_load_dwordx4 a[12:15], v1, s[24:27], s10 offen offset:3072 sc1
    s_add_u32 s53, s53, 4096
    s_and_b32 s53, s53, 0x7fff
    s_add_u32 s10, s54, s53
    buffer_load_dwordx4 a[16:19], v1, s[24:27], s10 offen offset:0 sc1
    buffer_load_dwordx4 a[20:23], v1, s[24:27], s10 offen offset:1024 sc1
    buffer_load_dwordx4 a[24:27], v1, s[24:27], s10 offen offset:2048 sc1
    buffer_load_dwordx4 a[28:31], v1, s[24:27], s10 offen offset:3072 sc1
    s_add_u32 s53, s53, 4096
    s_and_b32 s53, s53, 0x7fff
    s_add_u32 s10, s54, s53
    buffer_load_dwordx4 a[32:35], v1, s[24:27], s10 offen offset:0 sc1
    buffer_load_dwordx4 a[36:39], v1, s[24:27], s10 offen offset:1024 sc1
    buffer_load_dwordx4 a[40:43], v1, s[24:27], s10 offen offset:2048 sc1
    buffer_load_dwordx4 a[44:47], v1, s[24:27], s10 offen offset:3072 sc1
    s_add_u32 s53, s53, 4096
    s_and_b32 s53, s53, 0x7fff
    s_add_u32 s10, s54, s53
    ds_read_b64_tr_b16 v[104:105], v250 offset:0
    ds_read_b64_tr_b16 v[106:107], v250 offset:512
    ds_read_b64_tr_b16 v[108:109], v251 offset:0
    ds_read_b64_tr_b16 v[110:111], v251 offset:512
    ds_read_b128 v[112:115], v252 offset:0
    ds_read_b64_tr_b16 v[116:117], v250 offset:36864
    ds_read_b64_tr_b16 v[118:119], v250 offset:37376
    ds_read_b64_tr_b16 v[120:121], v251 offset:36864
    ds_read_b64_tr_b16 v[122:123], v251 offset:37376
    ds_read_b128 v[124:127], v252 offset:64
    s_waitcnt lgkmcnt(5)
    s_waitcnt vmcnt(8)
    v_mfma_f32_32x32x16_bf16 v[56:71], v[104:107], a[0:3], v[56:71]
    ds_read_b64_tr_b16 v[128:129], v250 offset:1024
    ds_read_b64_tr_b16 v[130:131], v250 offset:1536
    buffer_load_dwordx4 a[48:51], v1, s[24:27], s10 offen offset:0 sc1
    v_mfma_f32_32x32x16_bf16 v[72:87], v[108:111], a[0:3], v[72:87]
    ds_read_b64_tr_b16 v[132:133], v251 offset:1024
    ds_read_b64_tr_b16 v[134:135], v251 offset:1536
    buffer_load_dwordx4 a[52:55], v1, s[24:27], s10 offen offset:1024 sc1
    v_mfma_f32_16x16x32_bf16 v[88:91], v[112:115], a[0:3], v[88:91]
    ds_read_b128 v[104:107], v252 offset:128
    s_waitcnt lgkmcnt(5)
    v_mfma_f32_32x32x16_bf16 v[56:71], v[116:119], a[4:7], v[56:71]
    ds_read_b64_tr_b16 v[108:109], v250 offset:37888
    ds_read_b64_tr_b16 v[110:111], v250 offset:38400
    buffer_load_dwordx4 a[56:59], v1, s[24:27], s10 offen offset:2048 sc1
    v_mfma_f32_32x32x16_bf16 v[72:87], v[120:123], a[4:7], v[72:87]
    ds_read_b64_tr_b16 v[112:113], v251 offset:37888
    ds_read_b64_tr_b16 v[114:115], v251 offset:38400
    buffer_load_dwordx4 a[60:63], v1, s[24:27], s10 offen offset:3072 sc1
    v_mfma_f32_16x16x32_bf16 v[88:91], v[124:127], a[4:7], v[88:91]
    s_add_u32 s53, s53, 4096
    ds_read_b128 v[116:119], v252 offset:192
    s_cmp_eq_u32 s52, 7
    s_cselect_b32 s55, -8, 0
    s_lshl_b32 s58, s55, 11
    s_lshl_b32 s59, s55, 8
    s_waitcnt lgkmcnt(5)
    v_mfma_f32_32x32x16_bf16 v[56:71], v[128:131], a[8:11], v[56:71]
    s_and_b32 s53, s53, 0x7fff
    v_add_u32 v250, s58, v250
    v_add_u32 v251, s58, v251
    v_add_u32 v252, s59, v252
    ds_read_b64_tr_b16 v[120:121], v250 offset:2048
    ds_read_b64_tr_b16 v[122:123], v250 offset:2560
    s_add_u32 s10, s54, s53
    v_mfma_f32_32x32x16_bf16 v[72:87], v[132:135], a[8:11], v[72:87]
    ds_read_b64_tr_b16 v[124:125], v251 offset:2048
    ds_read_b64_tr_b16 v[126:127], v251 offset:2560
    v_mfma_f32_16x16x32_bf16 v[88:91], v[104:107], a[8:11], v[88:91]
    ds_read_b128 v[128:131], v252 offset:256
    s_waitcnt lgkmcnt(5)
    v_mfma_f32_32x32x16_bf16 v[56:71], v[108:111], a[12:15], v[56:71]
    ds_read_b64_tr_b16 v[132:133], v250 offset:38912
    ds_read_b64_tr_b16 v[134:135], v250 offset:39424
    v_mfma_f32_32x32x16_bf16 v[72:87], v[112:115], a[12:15], v[72:87]
    ds_read_b64_tr_b16 v[104:105], v251 offset:38912
    ds_read_b64_tr_b16 v[106:107], v251 offset:39424
    v_mfma_f32_16x16x32_bf16 v[88:91], v[116:119], a[12:15], v[88:91]
    ds_read_b128 v[108:111], v252 offset:320
    s_waitcnt lgkmcnt(5)
    s_waitcnt vmcnt(8)
    v_mfma_f32_32x32x16_bf16 v[56:71], v[120:123], a[16:19], v[56:71]
    ds_read_b64_tr_b16 v[112:113], v250 offset:3072
    ds_read_b64_tr_b16 v[114:115], v250 offset:3584
    buffer_load_dwordx4 a[64:67], v1, s[24:27], s10 offen offset:0 sc1
    v_mfma_f32_32x32x16_bf16 v[72:87], v[124:127], a[16:19], v[72:87]
    ds_read_b64_tr_b16 v[116:117], v251 offset:3072
    ds_read_b64_tr_b16 v[118:119], v251 offset:3584
    buffer_load_dwordx4 a[68:71], v1, s[24:27], s10 offen offset:1024 sc1
    v_mfma_f32_16x16x32_bf16 v[88:91], v[128:131], a[16:19], v[88:91]
    ds_read_b128 v[120:123], v252 offset:384
    s_waitcnt lgkmcnt(5)
    v_mfma_f32_32x32x16_bf16 v[56:71], v[132:135], a[20:23], v[56:71]
    ds_read_b64_tr_b16 v[124:125], v250 offset:39936
    ds_read_b64_tr_b16 v[126:127], v250 offset:40448
    buffer_load_dwordx4 a[72:75], v1, s[24:27], s10 offen offset:2048 sc1
    v_mfma_f32_32x32x16_bf16 v[72:87], v[104:107], a[20:23], v[72:87]
    ds_read_b64_tr_b16 v[128:129], v251 offset:39936
    ds_read_b64_tr_b16 v[130:131], v251 offset:40448
    buffer_load_dwordx4 a[76:79], v1, s[24:27], s10 offen offset:3072 sc1
    v_mfma_f32_16x16x32_bf16 v[88:91], v[108:111], a[20:23], v[88:91]
    s_add_u32 s53, s53, 4096
    ds_read_b128 v[132:135], v252 offset:448
    s_cmp_eq_u32 s52, 6
    s_cselect_b32 s55, -8, 0
    s_lshl_b32 s58, s55, 11
    s_lshl_b32 s59, s55, 8
    s_waitcnt lgkmcnt(5)
    v_mfma_f32_32x32x16_bf16 v[56:71], v[112:115], a[24:27], v[56:71]
    s_and_b32 s53, s53, 0x7fff
    v_add_u32 v250, s58, v250
    v_add_u32 v251, s58, v251
    v_add_u32 v252, s59, v252
    ds_read_b64_tr_b16 v[104:105], v250 offset:4096
    ds_read_b64_tr_b16 v[106:107], v250 offset:4608
    s_add_u32 s10, s54, s53
    v_mfma_f32_32x32x16_bf16 v[72:87], v[116:119], a[24:27], v[72:87]
    ds_read_b64_tr_b16 v[108:109], v251 offset:4096
    ds_read_b64_tr_b16 v[110:111], v251 offset:4608
    v_mfma_f32_16x16x32_bf16 v[88:91], v[120:123], a[24:27], v[88:91]
    ds_read_b128 v[112:115], v252 offset:512
    s_waitcnt lgkmcnt(5)
    v_mfma_f32_32x32x16_bf16 v[56:71], v[124:127], a[28:31], v[56:71]
    ds_read_b64_tr_b16 v[116:117], v250 offset:40960
    ds_read_b64_tr_b16 v[118:119], v250 offset:41472
    v_mfma_f32_32x32x16_bf16 v[72:87], v[128:131], a[28:31], v[72:87]
    ds_read_b64_tr_b16 v[120:121], v251 offset:40960
    ds_read_b64_tr_b16 v[122:123], v251 offset:41472
    v_mfma_f32_16x16x32_bf16 v[88:91], v[132:135], a[28:31], v[88:91]
    ds_read_b128 v[124:127], v252 offset:576
    s_waitcnt lgkmcnt(5)
    s_waitcnt vmcnt(8)
    v_mfma_f32_32x32x16_bf16 v[56:71], v[104:107], a[32:35], v[56:71]
    ds_read_b64_tr_b16 v[128:129], v250 offset:5120
    ds_read_b64_tr_b16 v[130:131], v250 offset:5632
    buffer_load_dwordx4 a[80:83], v1, s[24:27], s10 offen offset:0 sc1
    v_mfma_f32_32x32x16_bf16 v[72:87], v[108:111], a[32:35], v[72:87]
    ds_read_b64_tr_b16 v[132:133], v251 offset:5120
    ds_read_b64_tr_b16 v[134:135], v251 offset:5632
    buffer_load_dwordx4 a[84:87], v1, s[24:27], s10 offen offset:1024 sc1
    v_mfma_f32_16x16x32_bf16 v[88:91], v[112:115], a[32:35], v[88:91]
    ds_read_b128 v[104:107], v252 offset:640
    s_waitcnt lgkmcnt(5)
    v_mfma_f32_32x32x16_bf16 v[56:71], v[116:119], a[36:39], v[56:71]
    ds_read_b64_tr_b16 v[108:109], v250 offset:41984
    ds_read_b64_tr_b16 v[110:111], v250 offset:42496
    buffer_load_dwordx4 a[88:91], v1, s[24:27], s10 offen offset:2048 sc1
    v_mfma_f32_32x32x16_bf16 v[72:87], v[120:123], a[36:39], v[72:87]
    ds_read_b64_tr_b16 v[112:113], v251 offset:41984
    ds_read_b64_tr_b16 v[114:115], v251 offset:42496
    buffer_load_dwordx4 a[92:95], v1, s[24:27], s10 offen offset:3072 sc1
    v_mfma_f32_16x16x32_bf16 v[88:91], v[124:127], a[36:39], v[88:91]
    s_add_u32 s53, s53, 4096
    ds_read_b128 v[116:119], v252 offset:704
    s_cmp_eq_u32 s52, 5
    s_cselect_b32 s55, -8, 0
    s_lshl_b32 s58, s55, 11
    s_lshl_b32 s59, s55, 8
    s_waitcnt lgkmcnt(5)
    v_mfma_f32_32x32x16_bf16 v[56:71], v[128:131], a[40:43], v[56:71]
    s_and_b32 s53, s53, 0x7fff
    v_add_u32 v250, s58, v250
    v_add_u32 v251, s58, v251
    v_add_u32 v252, s59, v252
    ds_read_b64_tr_b16 v[120:121], v250 offset:6144
    ds_read_b64_tr_b16 v[122:123], v250 offset:6656
    s_add_u32 s10, s54, s53
    v_mfma_f32_32x32x16_bf16 v[72:87], v[132:135], a[40:43], v[72:87]
    ds_read_b64_tr_b16 v[124:125], v251 offset:6144
    ds_read_b64_tr_b16 v[126:127], v251 offset:6656
    v_mfma_f32_16x16x32_bf16 v[88:91], v[104:107], a[40:43], v[88:91]
    ds_read_b128 v[128:131], v252 offset:768
    s_waitcnt lgkmcnt(5)
    v_mfma_f32_32x32x16_bf16 v[56:71], v[108:111], a[44:47], v[56:71]
    ds_read_b64_tr_b16 v[132:133], v250 offset:43008
    ds_read_b64_tr_b16 v[134:135], v250 offset:43520
    v_mfma_f32_32x32x16_bf16 v[72:87], v[112:115], a[44:47], v[72:87]
    ds_read_b64_tr_b16 v[104:105], v251 offset:43008
    ds_read_b64_tr_b16 v[106:107], v251 offset:43520
    v_mfma_f32_16x16x32_bf16 v[88:91], v[116:119], a[44:47], v[88:91]
    ds_read_b128 v[108:111], v252 offset:832
    s_waitcnt lgkmcnt(5)
    s_waitcnt vmcnt(8)
    v_mfma_f32_32x32x16_bf16 v[56:71], v[120:123], a[48:51], v[56:71]
    ds_read_b64_tr_b16 v[112:113], v250 offset:7168
    ds_read_b64_tr_b16 v[114:115], v250 offset:7680
    buffer_load_dwordx4 a[96:99], v1, s[24:27], s10 offen offset:0 sc1
    v_mfma_f32_32x32x16_bf16 v[72:87], v[124:127], a[48:51], v[72:87]
    ds_read_b64_tr_b16 v[116:117], v251 offset:7168
    ds_read_b64_tr_b16 v[118:119], v251 offset:7680
    buffer_load_dwordx4 a[100:103], v1, s[24:27], s10 offen offset:1024 sc1
    v_mfma_f32_16x16x32_bf16 v[88:91], v[128:131], a[48:51], v[88:91]
    ds_read_b128 v[120:123], v252 offset:896
    s_waitcnt lgkmcnt(5)
    v_mfma_f32_32x32x16_bf16 v[56:71], v[132:135], a[52:55], v[56:71]
    ds_read_b64_tr_b16 v[124:125], v250 offset:44032
    ds_read_b64_tr_b16 v[126:127], v250 offset:44544
    buffer_load_dwordx4 a[104:107], v1, s[24:27], s10 offen offset:2048 sc1
    v_mfma_f32_32x32x16_bf16 v[72:87], v[104:107], a[52:55], v[72:87]
    ds_read_b64_tr_b16 v[128:129], v251 offset:44032
    ds_read_b64_tr_b16 v[130:131], v251 offset:44544
    buffer_load_dwordx4 a[108:111], v1, s[24:27], s10 offen offset:3072 sc1
    v_mfma_f32_16x16x32_bf16 v[88:91], v[108:111], a[52:55], v[88:91]
    s_add_u32 s53, s53, 4096
    ds_read_b128 v[132:135], v252 offset:960
    s_cmp_eq_u32 s52, 4
    s_cselect_b32 s55, -8, 0
    s_lshl_b32 s58, s55, 11
    s_lshl_b32 s59, s55, 8
    s_waitcnt lgkmcnt(5)
    v_mfma_f32_32x32x16_bf16 v[56:71], v[112:115], a[56:59], v[56:71]
    s_and_b32 s53, s53, 0x7fff
    v_add_u32 v250, s58, v250
    v_add_u32 v251, s58, v251
    v_add_u32 v252, s59, v252
    ds_read_b64_tr_b16 v[104:105], v250 offset:8192
    ds_read_b64_tr_b16 v[106:107], v250 offset:8704
    s_add_u32 s10, s54, s53
    v_mfma_f32_32x32x16_bf16 v[72:87], v[116:119], a[56:59], v[72:87]
    ds_read_b64_tr_b16 v[108:109], v251 offset:8192
    ds_read_b64_tr_b16 v[110:111], v251 offset:8704
    v_mfma_f32_16x16x32_bf16 v[88:91], v[120:123], a[56:59], v[88:91]
    ds_read_b128 v[112:115], v252 offset:1024
    s_waitcnt lgkmcnt(5)
    v_mfma_f32_32x32x16_bf16 v[56:71], v[124:127], a[60:63], v[56:71]
    ds_read_b64_tr_b16 v[116:117], v250 offset:45056
    ds_read_b64_tr_b16 v[118:119], v250 offset:45568
    v_mfma_f32_32x32x16_bf16 v[72:87], v[128:131], a[60:63], v[72:87]
    ds_read_b64_tr_b16 v[120:121], v251 offset:45056
    ds_read_b64_tr_b16 v[122:123], v251 offset:45568
    v_mfma_f32_16x16x32_bf16 v[88:91], v[132:135], a[60:63], v[88:91]
    ds_read_b128 v[124:127], v252 offset:1088
    s_waitcnt lgkmcnt(5)
    s_waitcnt vmcnt(8)
    v_mfma_f32_32x32x16_bf16 v[56:71], v[104:107], a[64:67], v[56:71]
    ds_read_b64_tr_b16 v[128:129], v250 offset:9216
    ds_read_b64_tr_b16 v[130:131], v250 offset:9728
    buffer_load_dwordx4 a[112:115], v1, s[24:27], s10 offen offset:0 sc1
    v_mfma_f32_32x32x16_bf16 v[72:87], v[108:111], a[64:67], v[72:87]
    ds_read_b64_tr_b16 v[132:133], v251 offset:9216
    ds_read_b64_tr_b16 v[134:135], v251 offset:9728
    buffer_load_dwordx4 a[116:119], v1, s[24:27], s10 offen offset:1024 sc1
    v_mfma_f32_16x16x32_bf16 v[88:91], v[112:115], a[64:67], v[88:91]
    ds_read_b128 v[104:107], v252 offset:1152
    s_waitcnt lgkmcnt(5)
    v_mfma_f32_32x32x16_bf16 v[56:71], v[116:119], a[68:71], v[56:71]
    ds_read_b64_tr_b16 v[108:109], v250 offset:46080
    ds_read_b64_tr_b16 v[110:111], v250 offset:46592
    buffer_load_dwordx4 a[120:123], v1, s[24:27], s10 offen offset:2048 sc1
    v_mfma_f32_32x32x16_bf16 v[72:87], v[120:123], a[68:71], v[72:87]
    ds_read_b64_tr_b16 v[112:113], v251 offset:46080
    ds_read_b64_tr_b16 v[114:115], v251 offset:46592
    buffer_load_dwordx4 a[124:127], v1, s[24:27], s10 offen offset:3072 sc1
    v_mfma_f32_16x16x32_bf16 v[88:91], v[124:127], a[68:71], v[88:91]
    s_add_u32 s53, s53, 4096
    ds_read_b128 v[116:119], v252 offset:1216
    s_cmp_eq_u32 s52, 3
    s_cselect_b32 s55, -8, 0
    s_lshl_b32 s58, s55, 11
    s_lshl_b32 s59, s55, 8
    s_waitcnt lgkmcnt(5)
    v_mfma_f32_32x32x16_bf16 v[56:71], v[128:131], a[72:75], v[56:71]
    s_and_b32 s53, s53, 0x7fff
    v_add_u32 v250, s58, v250
    v_add_u32 v251, s58, v251
    v_add_u32 v252, s59, v252
    ds_read_b64_tr_b16 v[120:121], v250 offset:10240
    ds_read_b64_tr_b16 v[122:123], v250 offset:10752
    s_add_u32 s10, s54, s53
    v_mfma_f32_32x32x16_bf16 v[72:87], v[132:135], a[72:75], v[72:87]
    ds_read_b64_tr_b16 v[124:125], v251 offset:10240
    ds_read_b64_tr_b16 v[126:127], v251 offset:10752
    v_mfma_f32_16x16x32_bf16 v[88:91], v[104:107], a[72:75], v[88:91]
    ds_read_b128 v[128:131], v252 offset:1280
    s_waitcnt lgkmcnt(5)
    v_mfma_f32_32x32x16_bf16 v[56:71], v[108:111], a[76:79], v[56:71]
    ds_read_b64_tr_b16 v[132:133], v250 offset:47104
    ds_read_b64_tr_b16 v[134:135], v250 offset:47616
    v_mfma_f32_32x32x16_bf16 v[72:87], v[112:115], a[76:79], v[72:87]
    ds_read_b64_tr_b16 v[104:105], v251 offset:47104
    ds_read_b64_tr_b16 v[106:107], v251 offset:47616
    v_mfma_f32_16x16x32_bf16 v[88:91], v[116:119], a[76:79], v[88:91]
    ds_read_b128 v[108:111], v252 offset:1344
    s_waitcnt lgkmcnt(5)
    s_waitcnt vmcnt(8)
    v_mfma_f32_32x32x16_bf16 v[56:71], v[120:123], a[80:83], v[56:71]
    ds_read_b64_tr_b16 v[112:113], v250 offset:11264
    ds_read_b64_tr_b16 v[114:115], v250 offset:11776
    buffer_load_dword a128, v248, s[24:27], s11 offen offset:0 sc1
    buffer_load_dword a129, v248, s[24:27], s11 offen offset:256 sc1
    v_mfma_f32_32x32x16_bf16 v[72:87], v[124:127], a[80:83], v[72:87]
    ds_read_b64_tr_b16 v[116:117], v251 offset:11264
    ds_read_b64_tr_b16 v[118:119], v251 offset:11776
    buffer_load_dword a130, v248, s[24:27], s11 offen offset:512 sc1
    v_mfma_f32_16x16x32_bf16 v[88:91], v[128:131], a[80:83], v[88:91]
    ds_read_b128 v[120:123], v252 offset:1408
    s_waitcnt lgkmcnt(5)
    v_mfma_f32_32x32x16_bf16 v[56:71], v[132:135], a[84:87], v[56:71]
    ds_read_b64_tr_b16 v[124:125], v250 offset:48128
    ds_read_b64_tr_b16 v[126:127], v250 offset:48640
    buffer_load_dword a131, v248, s[24:27], s11 offen offset:768 sc1
    buffer_load_dword a132, v248, s[24:27], s11 offen offset:1024 sc1
    v_mfma_f32_32x32x16_bf16 v[72:87], v[104:107], a[84:87], v[72:87]
    ds_read_b64_tr_b16 v[128:129], v251 offset:48128
    ds_read_b64_tr_b16 v[130:131], v251 offset:48640
    buffer_load_dword a133, v248, s[24:27], s11 offen offset:1280 sc1
    buffer_load_dword a134, v248, s[24:27], s11 offen offset:1536 sc1
    v_mfma_f32_16x16x32_bf16 v[88:91], v[108:111], a[84:87], v[88:91]
    ds_read_b128 v[132:135], v252 offset:1472
    s_cmp_eq_u32 s52, 2
    s_cselect_b32 s55, -8, 0
    s_lshl_b32 s58, s55, 11
    s_lshl_b32 s59, s55, 8
    s_waitcnt lgkmcnt(5)
    v_mfma_f32_32x32x16_bf16 v[56:71], v[112:115], a[88:91], v[56:71]
    v_add_u32 v250, s58, v250
    v_add_u32 v251, s58, v251
    v_add_u32 v252, s59, v252
    ds_read_b64_tr_b16 v[104:105], v250 offset:12288
    ds_read_b64_tr_b16 v[106:107], v250 offset:12800
    buffer_load_dword a135, v248, s[24:27], s11 offen offset:1792 sc1
    v_mfma_f32_32x32x16_bf16 v[72:87], v[116:119], a[88:91], v[72:87]
    ds_read_b64_tr_b16 v[108:109], v251 offset:12288
    ds_read_b64_tr_b16 v[110:111], v251 offset:12800
    buffer_load_dword a136, v248, s[24:27], s11 offen offset:2048 sc1
    buffer_load_dword a137, v248, s[24:27], s11 offen offset:2304 sc1
    v_mfma_f32_16x16x32_bf16 v[88:91], v[120:123], a[88:91], v[88:91]
    ds_read_b128 v[112:115], v252 offset:1536
    s_waitcnt lgkmcnt(5)
    v_mfma_f32_32x32x16_bf16 v[56:71], v[124:127], a[92:95], v[56:71]
    ds_read_b64_tr_b16 v[116:117], v250 offset:49152
    ds_read_b64_tr_b16 v[118:119], v250 offset:49664
    buffer_load_dword a138, v248, s[24:27], s11 offen offset:2560 sc1
    buffer_load_dword a139, v248, s[24:27], s11 offen offset:2816 sc1
    buffer_load_dword a140, v248, s[24:27], s11 offen offset:3072 sc1
    v_mfma_f32_32x32x16_bf16 v[72:87], v[128:131], a[92:95], v[72:87]
    ds_read_b64_tr_b16 v[120:121], v251 offset:49152
    ds_read_b64_tr_b16 v[122:123], v251 offset:49664
    buffer_load_dword a141, v248, s[24:27], s11 offen offset:3328 sc1
    buffer_load_dword a142, v248, s[24:27], s11 offen offset:3584 sc1
    buffer_load_dword a143, v248, s[24:27], s11 offen offset:3840 sc1
    v_mfma_f32_16x16x32_bf16 v[88:91], v[132:135], a[92:95], v[88:91]
    ds_read_b128 v[124:127], v252 offset:1600
    s_waitcnt lgkmcnt(5)
    s_waitcnt vmcnt(20)
    v_mfma_f32_32x32x16_bf16 v[56:71], v[104:107], a[96:99], v[56:71]
    ds_read_b64_tr_b16 v[128:129], v250 offset:13312
    ds_read_b64_tr_b16 v[130:131], v250 offset:13824
    v_mfma_f32_32x32x16_bf16 v[72:87], v[108:111], a[96:99], v[72:87]
    ds_read_b64_tr_b16 v[132:133], v251 offset:13312
    ds_read_b64_tr_b16 v[134:135], v251 offset:13824
    v_mfma_f32_16x16x32_bf16 v[88:91], v[112:115], a[96:99], v[88:91]
    ds_read_b128 v[104:107], v252 offset:1664
    s_waitcnt lgkmcnt(5)
    v_mfma_f32_32x32x16_bf16 v[56:71], v[116:119], a[100:103], v[56:71]
    ds_read_b64_tr_b16 v[108:109], v250 offset:50176
    ds_read_b64_tr_b16 v[110:111], v250 offset:50688
    v_mfma_f32_32x32x16_bf16 v[72:87], v[120:123], a[100:103], v[72:87]
    s_add_u32 m0, s38, 0
    ds_read_b64_tr_b16 v[112:113], v251 offset:50176
    ds_read_b64_tr_b16 v[114:115], v251 offset:50688
    v_mfma_f32_16x16x32_bf16 v[88:91], v[124:127], a[100:103], v[88:91]
    ds_read_b128 v[116:119], v252 offset:1728
    s_cmp_eq_u32 s52, 1
    s_cselect_b32 s55, -8, 0
    s_lshl_b32 s58, s55, 11
    s_lshl_b32 s59, s55, 8
    s_waitcnt lgkmcnt(5)
    v_mfma_f32_32x32x16_bf16 v[56:71], v[128:131], a[104:107], v[56:71]
    v_add_u32 v250, s58, v250
    v_add_u32 v251, s58, v251
    v_add_u32 v252, s59, v252
    ds_read_b64_tr_b16 v[120:121], v250 offset:14336
    ds_read_b64_tr_b16 v[122:123], v250 offset:14848
    v_mfma_f32_32x32x16_bf16 v[72:87], v[132:135], a[104:107], v[72:87]
    ds_read_b64_tr_b16 v[124:125], v251 offset:14336
    ds_read_b64_tr_b16 v[126:127], v251 offset:14848
    buffer_load_dwordx4 v15, s[16:19], 0 offen offset:0 lds
    v_mfma_f32_16x16x32_bf16 v[88:91], v[104:107], a[104:107], v[88:91]
    ds_read_b128 v[128:131], v252 offset:1792
    s_waitcnt lgkmcnt(5)
    v_mfma_f32_32x32x16_bf16 v[56:71], v[108:111], a[108:111], v[56:71]
    ds_read_b64_tr_b16 v[132:133], v250 offset:51200
    ds_read_b64_tr_b16 v[134:135], v250 offset:51712
    buffer_load_dwordx4 v16, s[16:19], s33 offen offset:1024 lds
    v_mfma_f32_32x32x16_bf16 v[72:87], v[112:115], a[108:111], v[72:87]
    ds_read_b64_tr_b16 v[104:105], v251 offset:51200
    ds_read_b64_tr_b16 v[106:107], v251 offset:51712
    v_mfma_f32_16x16x32_bf16 v[88:91], v[116:119], a[108:111], v[88:91]
    ds_read_b128 v[108:111], v252 offset:1856
    s_waitcnt lgkmcnt(5)
    s_waitcnt vmcnt(18)
    v_mfma_f32_32x32x16_bf16 v[56:71], v[120:123], a[112:115], v[56:71]
    ds_read_b64_tr_b16 v[112:113], v250 offset:15360
    ds_read_b64_tr_b16 v[114:115], v250 offset:15872
    buffer_load_dwordx4 v15, s[16:19], s34 offen offset:2048 lds
    v_mfma_f32_32x32x16_bf16 v[72:87], v[124:127], a[112:115], v[72:87]
    ds_read_b64_tr_b16 v[116:117], v251 offset:15360
    ds_read_b64_tr_b16 v[118:119], v251 offset:15872
    buffer_load_dwordx4 v16, s[16:19], s35 offen offset:3072 lds
    v_mfma_f32_16x16x32_bf16 v[88:91], v[128:131], a[112:115], v[88:91]
    ds_read_b128 v[120:123], v252 offset:1920
    s_waitcnt lgkmcnt(5)
    v_mfma_f32_32x32x16_bf16 v[56:71], v[132:135], a[116:119], v[56:71]
    ds_read_b64_tr_b16 v[124:125], v250 offset:52224
    ds_read_b64_tr_b16 v[126:127], v250 offset:52736
    v_mfma_f32_32x32x16_bf16 v[72:87], v[104:107], a[116:119], v[72:87]
    ds_read_b64_tr_b16 v[128:129], v251 offset:52224
    ds_read_b64_tr_b16 v[130:131], v251 offset:52736
    v_add_u32 v15, 589824, v15
    v_mfma_f32_16x16x32_bf16 v[88:91], v[108:111], a[116:119], v[88:91]
    ds_read_b128 v[132:135], v252 offset:1984
    s_cmp_eq_u32 s52, 0
    s_cselect_b32 s55, 0, 8
    s_sub_u32 s55, s55, s52
    s_lshl_b32 s58, s55, 11
    s_lshl_b32 s59, s55, 8
    s_waitcnt lgkmcnt(5)
    v_mfma_f32_32x32x16_bf16 v[56:71], v[112:115], a[120:123], v[56:71]
    v_add_u32 v250, s58, v250
    v_add_u32 v251, s58, v251
    v_add_u32 v252, s59, v252
    ds_read_b64_tr_b16 v[104:105], v250 offset:16384
    ds_read_b64_tr_b16 v[106:107], v250 offset:16896
    v_add_u32 v16, 589824, v16
    v_mfma_f32_32x32x16_bf16 v[72:87], v[116:119], a[120:123], v[72:87]
    ds_read_b64_tr_b16 v[108:109], v251 offset:16384
    ds_read_b64_tr_b16 v[110:111], v251 offset:16896
    v_mfma_f32_16x16x32_bf16 v[88:91], v[120:123], a[120:123], v[88:91]
    s_add_u32 m0, s38, 16384
    ds_read_b128 v[112:115], v252 offset:2048
    s_waitcnt lgkmcnt(5)
    v_mfma_f32_32x32x16_bf16 v[56:71], v[124:127], a[124:127], v[56:71]
    ds_read_b64_tr_b16 v[116:117], v250 offset:53248
    ds_read_b64_tr_b16 v[118:119], v250 offset:53760
    buffer_load_dwordx4 v15, s[16:19], 0 offen offset:0 lds
    v_mfma_f32_32x32x16_bf16 v[72:87], v[128:131], a[124:127], v[72:87]
    ds_read_b64_tr_b16 v[120:121], v251 offset:53248
    ds_read_b64_tr_b16 v[122:123], v251 offset:53760
    v_mfma_f32_16x16x32_bf16 v[88:91], v[132:135], a[124:127], v[88:91]
    ds_read_b128 v[124:127], v252 offset:2112
    s_waitcnt lgkmcnt(5)
    s_waitcnt vmcnt(5)
    v_mfma_f32_32x32x16_bf16 v[56:71], v[104:107], a[128:131], v[56:71]
    ds_read_b64_tr_b16 v[128:129], v250 offset:17408
    ds_read_b64_tr_b16 v[130:131], v250 offset:17920
    buffer_load_dwordx4 v16, s[16:19], s33 offen offset:1024 lds
    v_mfma_f32_32x32x16_bf16 v[72:87], v[108:111], a[128:131], v[72:87]
    ds_read_b64_tr_b16 v[132:133], v251 offset:17408
    ds_read_b64_tr_b16 v[134:135], v251 offset:17920
    v_mfma_f32_16x16x32_bf16 v[88:91], v[112:115], a[128:131], v[88:91]
    ds_read_b128 v[104:107], v252 offset:2176
    s_waitcnt lgkmcnt(5)
    v_mfma_f32_32x32x16_bf16 v[56:71], v[116:119], a[132:135], v[56:71]
    ds_read_b64_tr_b16 v[108:109], v250 offset:54272
    ds_read_b64_tr_b16 v[110:111], v250 offset:54784
    buffer_load_dwordx4 v15, s[16:19], s34 offen offset:2048 lds
    v_mfma_f32_32x32x16_bf16 v[72:87], v[120:123], a[132:135], v[72:87]
    ds_read_b64_tr_b16 v[112:113], v251 offset:54272
    ds_read_b64_tr_b16 v[114:115], v251 offset:54784
    v_mfma_f32_16x16x32_bf16 v[88:91], v[124:127], a[132:135], v[88:91]
    ds_read_b128 v[116:119], v252 offset:2240
    s_waitcnt lgkmcnt(5)
    v_mfma_f32_32x32x16_bf16 v[56:71], v[128:131], a[136:139], v[56:71]
    buffer_load_dwordx4 v16, s[16:19], s35 offen offset:3072 lds
    v_mfma_f32_32x32x16_bf16 v[72:87], v[132:135], a[136:139], v[72:87]
    v_mfma_f32_16x16x32_bf16 v[88:91], v[104:107], a[136:139], v[88:91]
    v_add_u32 v15, 589824, v15
    s_waitcnt lgkmcnt(0)
    v_mfma_f32_32x32x16_bf16 v[56:71], v[108:111], a[140:143], v[56:71]
    v_add_u32 v16, 589824, v16
    v_mfma_f32_32x32x16_bf16 v[72:87], v[112:115], a[140:143], v[72:87]
    v_mfma_f32_16x16x32_bf16 v[88:91], v[116:119], a[140:143], v[88:91]
    s_mul_i32 s10, s14, 36
    s_lshl_b32 s11, s57, 2
    s_add_u32 s10, s10, s11
    s_lshl_b32 s10, s10, 10
    s_add_u32 s10, s10, 11534336
    s_mul_i32 s11, s14, 9
    s_add_u32 s11, s11, s57
    s_lshl_b32 s11, s11, 7
    s_add_u32 s11, s11, 14680064
    s_lshl_b32 s15, s14, 7
    s_add_u32 s15, s15, 14983168
    s_cmp_eq_u32 s57, 0
    s_cselect_b32 s15, s15, 0x40000000
    v_mov_b32 v2, 0
    v_mov_b32 v3, 0
    v_add_f32 v249, v88, v89
    v_sub_f32 v56, v56, v249
    v_sub_f32 v57, v57, v249
    v_cvt_pk_bf16_f32 v176, v56, v57
    v_sub_f32 v58, v58, v249
    v_sub_f32 v59, v59, v249
    v_cvt_pk_bf16_f32 v177, v58, v59
    v_sub_f32 v60, v60, v249
    v_sub_f32 v61, v61, v249
    v_cvt_pk_bf16_f32 v178, v60, v61
    v_sub_f32 v62, v62, v249
    v_sub_f32 v63, v63, v249
    v_cvt_pk_bf16_f32 v179, v62, v63
    buffer_store_dwordx4 v[176:179], v1, s[24:27], s10 offen offset:0 sc1
    v_sub_f32 v64, v64, v249
    v_sub_f32 v65, v65, v249
    v_cvt_pk_bf16_f32 v180, v64, v65
    v_sub_f32 v66, v66, v249
    v_sub_f32 v67, v67, v249
    v_cvt_pk_bf16_f32 v181, v66, v67
    v_sub_f32 v68, v68, v249
    v_sub_f32 v69, v69, v249
    v_cvt_pk_bf16_f32 v182, v68, v69
    v_sub_f32 v70, v70, v249
    v_sub_f32 v71, v71, v249
    v_cvt_pk_bf16_f32 v183, v70, v71
    buffer_store_dwordx4 v[180:183], v1, s[24:27], s10 offen offset:1024 sc1
    v_sub_f32 v72, v72, v249
    v_sub_f32 v73, v73, v249
    v_cvt_pk_bf16_f32 v184, v72, v73
    v_sub_f32 v74, v74, v249
    v_sub_f32 v75, v75, v249
    v_cvt_pk_bf16_f32 v185, v74, v75
    v_sub_f32 v76, v76, v249
    v_sub_f32 v77, v77, v249
    v_cvt_pk_bf16_f32 v186, v76, v77
    v_sub_f32 v78, v78, v249
    v_sub_f32 v79, v79, v249
    v_cvt_pk_bf16_f32 v187, v78, v79
    buffer_store_dwordx4 v[184:187], v1, s[24:27], s10 offen offset:2048 sc1
    v_sub_f32 v80, v80, v249
    v_sub_f32 v81, v81, v249
    v_cvt_pk_bf16_f32 v188, v80, v81
    v_sub_f32 v82, v82, v249
    v_sub_f32 v83, v83, v249
    v_cvt_pk_bf16_f32 v189, v82, v83
    v_sub_f32 v84, v84, v249
    v_sub_f32 v85, v85, v249
    v_cvt_pk_bf16_f32 v190, v84, v85
    v_sub_f32 v86, v86, v249
    v_sub_f32 v87, v87, v249
    v_cvt_pk_bf16_f32 v191, v86, v87
    buffer_store_dwordx4 v[188:191], v1, s[24:27], s10 offen offset:3072 sc1
    v_fmac_f32 v2, v56, v56
    v_fmac_f32 v3, v57, v57
    v_fmac_f32 v2, v58, v58
    v_fmac_f32 v3, v59, v59
    v_fmac_f32 v2, v60, v60
    v_fmac_f32 v3, v61, v61
    v_fmac_f32 v2, v62, v62
    v_fmac_f32 v3, v63, v63
    v_fmac_f32 v2, v64, v64
    v_fmac_f32 v3, v65, v65
    v_fmac_f32 v2, v66, v66
    v_fmac_f32 v3, v67, v67
    v_fmac_f32 v2, v68, v68
    v_fmac_f32 v3, v69, v69
    v_fmac_f32 v2, v70, v70
    v_fmac_f32 v3, v71, v71
    v_fmac_f32 v2, v72, v72
    v_fmac_f32 v3, v73, v73
    v_fmac_f32 v2, v74, v74
    v_fmac_f32 v3, v75, v75
    v_fmac_f32 v2, v76, v76
    v_fmac_f32 v3, v77, v77
    v_fmac_f32 v2, v78, v78
    v_fmac_f32 v3, v79, v79
    v_fmac_f32 v2, v80, v80
    v_fmac_f32 v3, v81, v81
    v_fmac_f32 v2, v82, v82
    v_fmac_f32 v3, v83, v83
    v_fmac_f32 v2, v84, v84
    v_fmac_f32 v3, v85, v85
    v_fmac_f32 v2, v86, v86
    v_fmac_f32 v3, v87, v87
    v_add_f32 v2, v2, v3
    v_mov_b32 v3, v2
    s_nop 1
    v_permlane32_swap_b32 v2, v3
    v_add_f32 v2, v2, v3
    s_mov_b32 exec_hi, 0
    buffer_store_dword v2, v253, s[24:27], s11 offen sc1
    buffer_store_dword v249, v253, s[24:27], s15 offen sc1
    s_mov_b32 exec_hi, -1
    s_lshl_b32 s62, s56, 4
    s_add_u32 s62, s62, s57
    s_lshl_b32 s62, s62, 7
    s_add_u32 s62, s62, 15925248
    s_branch L_p3_end
L_p3_idle:
    s_add_u32 m0, s38, 0
    s_nop 0
    buffer_load_dwordx4 v15, s[16:19], 0 offen offset:0 lds
    buffer_load_dwordx4 v16, s[16:19], s33 offen offset:1024 lds
    buffer_load_dwordx4 v15, s[16:19], s34 offen offset:2048 lds
    buffer_load_dwordx4 v16, s[16:19], s35 offen offset:3072 lds
    v_add_u32 v15, 589824, v15
    v_add_u32 v16, 589824, v16
    s_add_u32 m0, s38, 16384
    s_nop 0
    buffer_load_dwordx4 v15, s[16:19], 0 offen offset:0 lds
    buffer_load_dwordx4 v16, s[16:19], s33 offen offset:1024 lds
    buffer_load_dwordx4 v15, s[16:19], s34 offen offset:2048 lds
    buffer_load_dwordx4 v16, s[16:19], s35 offen offset:3072 lds
    v_add_u32 v15, 589824, v15
    v_add_u32 v16, 589824, v16
    s_mov_b32 s59, s61
    s_sub_u32 s70, s2, 144
    s_lshr_b32 s71, s70, 3
    s_and_b32 s70, s70, 1
    s_mul_i32 s70, s70, 14
    s_add_u32 s70, s70, s71
    s_lshl_b32 s70, s70, 2
    s_add_u32 s70, s70, s3
    s_and_b32 s71, s70, 1
    s_cmp_eq_u32 s71, 0
    s_cselect_b32 s60, s72, s74
    s_cselect_b32 s61, s73, s75
    s_mov_b32 s62, 5308416
    s_mov_b32 s63, 0x20000
    s_lshr_b32 s70, s70, 1
    s_mul_i32 s70, s70, 11
    v_lshrrev_b32 v40, 2, v0
    v_add_u32 v40, s70, v40
    v_mul_u32_u24 v40, 9216, v40
    v_and_b32 v41, 1, v0
    v_mul_u32_u24 v41, 640, v41
    v_bfe_u32 v42, v0, 1, 1
    v_mul_u32_u24 v42, 1152, v42
    v_add3_u32 v40, v40, v41, v42
    s_bfe_u32 s70, s2, 0x20001
    s_mul_i32 s70, s70, 2304
    v_add_u32 v40, s70, v40
    s_mov_b32 exec_hi, 0xfff
    s_mov_b32 s70, 0
    buffer_load_dword v41, v40, s[60:63], s70 offen offset:128
    s_mov_b64 exec, -1
    s_mov_b32 exec_hi, 0xfff
    s_mov_b32 s70, 0
    buffer_load_dword v41, v40, s[60:63], s70 offen offset:256
    s_mov_b64 exec, -1
    s_mov_b32 exec_hi, 0xfff
    s_mov_b32 s70, 0
    buffer_load_dword v41, v40, s[60:63], s70 offen offset:384
    s_mov_b64 exec, -1
    v_and_b32 v41, 1, v0
    v_mul_u32_u24 v41, 640, v41
    v_sub_u32 v42, v40, v41
    s_mov_b32 exec_hi, 0xfff
    s_mov_b32 s70, 0
    buffer_load_dword v41, v42, s[60:63], s70 offen offset:512
    s_mov_b64 exec, -1
    s_mov_b32 s60, s76
    s_mov_b32 s61, s77
    s_mov_b32 s62, 5308416
    s_mov_b32 s63, 0x20000
    s_sub_u32 s70, s2, 144
    s_lshl_b32 s70, s70, 2
    s_add_u32 s70, s70, s3
    s_mul_i32 s70, s70, 11904
    v_min_u32 v45, 46, v0
    v_lshlrev_b32 v44, 7, v45
    s_add_u32 s71, s70, 6016
    buffer_load_dword v45, v44, s[60:63], s70 offen
    buffer_load_dword v45, v44, s[60:63], s71 offen
    s_mov_b32 s61, s59
    s_mov_b32 s62, 0x40000000
L_p3_end:
    s_lshl_b32 s39, s3, 11
    s_mul_i32 s40, s3, 9216
    v_lshlrev_b32 v1, 4, v0
    s_lshl_b32 s14, s28, 2
    s_add_u32 s14, s14, s3
    s_mul_i32 s37, s14, 36864
    s_add_u32 s37, s37, 11534336
    s_sub_u32 s14, 8, s8
    s_lshl_b32 s14, s14, 12
    s_add_u32 s37, s37, s14
    s_mov_b32 s36, 146432
    s_mov_b32 s53, s61
    s_sub_u32 s20, s76, 4096
    s_subb_u32 s21, s77, 0
    s_mov_b32 s22, 5312512
    s_mov_b32 s23, 0x20000
    v_lshrrev_b32 v37, 4, v0
    v_lshrrev_b32 v38, 2, v0
    v_and_b32 v38, 3, v38
    v_lshlrev_b32 v8, 10, v37
    v_lshl_add_u32 v8, v38, 7, v8
    v_and_b32 v39, 1, v0
    v_lshl_add_u32 v8, v39, 3, v8
    v_lshrrev_b32 v9, 1, v38
    v_and_b32 v10, 1, v37
    v_lshl_or_b32 v9, v10, 1, v9
    v_lshlrev_b32 v9, 1, v9
    v_bfe_u32 v11, v0, 1, 1
    v_or_b32 v23, v9, v11
    s_lshl_b32 s15, s32, 2
    v_xor_b32 v2, s15, v23
    v_xor_b32 v3, 2, v2
    v_lshl_add_u32 v2, v2, 4, v8
    v_lshl_add_u32 v3, v3, 4, v8
    v_lshrrev_b32 v9, 1, v37
    v_lshlrev_b32 v8, 9, v10
    v_lshl_add_u32 v8, v38, 6, v8
    v_lshl_add_u32 v8, v39, 3, v8
    v_lshl_add_u32 v8, v11, 4, v8
    v_xor_b32 v23, s32, v10
    v_lshl_add_u32 v8, v23, 5, v8
    v_lshl_add_u32 v6, v9, 10, v8
    v_lshlrev_b32 v8, 4, v9
    v_lshl_add_u32 v8, v10, 2, v8
    v_add_u32 v8, v8, v38
    v_mul_u32_u24 v8, 288, v8
    v_and_b32 v9, 3, v0
    v_lshl_add_u32 v8, v9, 3, v8
    s_mul_i32 s15, s32, 18432
    v_add_u32 v7, s15, v8
    v_lshrrev_b32 v4, 1, v37
    v_lshlrev_b32 v4, 10, v4
    v_and_b32 v5, 1, v37
    v_lshl_add_u32 v4, v5, 9, v4
    v_and_b32 v5, 15, v0
    v_lshl_add_u32 v4, v5, 4, v4
    s_lshl_b32 s14, s31, 1
    s_add_u32 s14, s14, s32
    s_lshl_b32 s14, s14, 12
    s_xor_b32 s15, s14, 4096
    v_add_u32 v5, s15, v4
    v_add_u32 v4, s14, v4
    s_waitcnt vmcnt(0) lgkmcnt(0)
    s_barrier
    s_cmp_lg_u32 s3, 0
    s_cbranch_scc1 L_sig6
    v_mov_b32 v28, 1
    s_mov_b64 exec, 1
    buffer_store_dword v28, off, s[24:27], s62 sc1
    s_mov_b64 exec, -1
L_sig6:
    s_add_u32 m0, s38, 32768
    s_nop 0
    buffer_load_dwordx4 v15, s[16:19], 0 offen offset:0 lds
    buffer_load_dwordx4 v16, s[16:19], s33 offen offset:1024 lds
    buffer_load_dwordx4 v15, s[16:19], s34 offen offset:2048 lds
    buffer_load_dwordx4 v16, s[16:19], s35 offen offset:3072 lds
    v_add_u32 v15, 589824, v15
    v_add_u32 v16, 589824, v16
    s_add_u32 m0, s38, 49152
    s_nop 0
    buffer_load_dwordx4 v15, s[16:19], 0 offen offset:0 lds
    buffer_load_dwordx4 v16, s[16:19], s33 offen offset:1024 lds
    buffer_load_dwordx4 v15, s[16:19], s34 offen offset:2048 lds
    buffer_load_dwordx4 v16, s[16:19], s35 offen offset:3072 lds
    v_add_u32 v15, 589824, v15
    v_add_u32 v16, 589824, v16
    s_add_u32 m0, s38, 65536
    s_nop 0
    buffer_load_dwordx4 v15, s[16:19], 0 offen offset:0 lds
    buffer_load_dwordx4 v16, s[16:19], s33 offen offset:1024 lds
    buffer_load_dwordx4 v15, s[16:19], s34 offen offset:2048 lds
    buffer_load_dwordx4 v16, s[16:19], s35 offen offset:3072 lds
    v_add_u32 v15, 589824, v15
    v_add_u32 v16, 589824, v16
    s_and_b32 s10, s29, 3
    s_lshr_b32 s11, s29, 2
    s_mul_i32 s11, s11, 1152
    s_mul_i32 s55, s10, 288
    s_xor_b32 s14, s10, 0
    s_lshr_b32 s15, s14, 1
    s_mul_i32 s15, s15, 576
    s_and_b32 s14, s14, 1
    s_mul_i32 s14, s14, 320
    s_add_u32 s14, s14, s15
    s_add_u32 s14, s14, s11
    s_lshl_b32 s15, s32, 5
    s_add_u32 s14, s14, s15
    s_mul_i32 s14, s14, 1152
    s_add_u32 s41, s14, s55
    s_xor_b32 s14, s10, 1
    s_lshr_b32 s15, s14, 1
    s_mul_i32 s15, s15, 576
    s_and_b32 s14, s14, 1
    s_mul_i32 s14, s14, 320
    s_add_u32 s14, s14, s15
    s_add_u32 s14, s14, s11
    s_lshl_b32 s15, s32, 5
    s_add_u32 s14, s14, s15
    s_mul_i32 s14, s14, 1152
    s_add_u32 s42, s14, s55
    s_xor_b32 s14, s10, 2
    s_lshr_b32 s15, s14, 1
    s_mul_i32 s15, s15, 576
    s_and_b32 s14, s14, 1
    s_mul_i32 s14, s14, 320
    s_add_u32 s14, s14, s15
    s_add_u32 s14, s14, s11
    s_lshl_b32 s15, s32, 5
    s_add_u32 s14, s14, s15
    s_mul_i32 s14, s14, 1152
    s_add_u32 s43, s14, s55
    s_xor_b32 s14, s10, 3
    s_lshr_b32 s15, s14, 1
    s_mul_i32 s15, s15, 576
    s_and_b32 s14, s14, 1
    s_mul_i32 s14, s14, 320
    s_add_u32 s14, s14, s15
    s_add_u32 s14, s14, s11
    s_lshl_b32 s15, s32, 5
    s_add_u32 s14, s14, s15
    s_mul_i32 s14, s14, 1152
    s_add_u32 s44, s14, s55
    s_lshr_b32 s14, s10, 1
    s_xor_b32 s14, s14, 0
    s_mul_i32 s14, s14, 576
    s_add_u32 s14, s14, s11
    s_lshl_b32 s15, s32, 4
    s_add_u32 s14, s14, s15
    s_add_u32 s14, s14, 256
    s_mul_i32 s14, s14, 1152
    s_add_u32 s45, s14, s55
    s_lshr_b32 s14, s10, 1
    s_xor_b32 s14, s14, 1
    s_mul_i32 s14, s14, 576
    s_add_u32 s14, s14, s11
    s_lshl_b32 s15, s32, 4
    s_add_u32 s14, s14, s15
    s_add_u32 s14, s14, 256
    s_mul_i32 s14, s14, 1152
    s_add_u32 s46, s14, s55
    s_lshl_b32 s14, s2, 2
    s_add_u32 s14, s14, s3
    s_mul_i32 s47, s14, 18432
    s_add_u32 s47, s47, 16777216
    s_lshl_b32 s49, s14, 7
    s_add_u32 s49, s49, 15728640
    s_mul_i32 s58, s14, 9216
    s_add_u32 s58, s58, 41943040
    v_min_u32 v21, 2, v0
    v_add_u32 v21, 1, v21
    v_lshlrev_b32 v21, 8, v21
    v_xor_b32 v21, s14, v21
    v_lshlrev_b32 v21, 7, v21
    v_add_u32 v21, 15728640, v21
    s_xor_b32 s15, s14, 256
    s_mul_i32 s48, s15, 18432
    s_add_u32 s48, s48, 16777216
    s_xor_b32 s15, s14, 512
    s_mul_i32 s50, s15, 18432
    s_add_u32 s50, s50, 16777216
    s_xor_b32 s15, s14, 768
    s_mul_i32 s51, s15, 18432
    s_add_u32 s51, s51, 16777216
    s_lshr_b32 s14, s29, 3
    s_bfe_u32 s15, s29, 0x10002
    s_lshl_b32 s15, s15, 1
    s_add_u32 s14, s14, s15
    s_cmp_eq_u32 s14, s3
    s_cselect_b32 s56, 1, 0
    s_cselect_b32 s58, 0x40000000, s58
    s_lshl_b32 s14, s3, 13
    s_add_u32 s14, s14, 36864
    v_add_u32 v19, s14, v1
    s_lshl_b32 s14, s3, 13
    s_xor_b32 s14, s14, 16384
    s_add_u32 s14, s14, 36864
    v_add_u32 v20, s14, v1
    s_lshl_b32 s14, s28, 11
    s_add_u32 s14, s14, 15925248
    v_lshl_add_u32 v28, v0, 7, s14
    v_mov_b32 v29, 1
    s_lshl_b32 s14, s28, 1
    s_add_u32 s14, s14, s31
    s_mul_i32 s14, s14, 2304
    s_add_u32 s54, s14, 14680064
    v_lshrrev_b32 v38, 5, v0
    v_mul_u32_u24 v38, 1152, v38
    v_and_b32 v39, 31, v0
    v_lshl_add_u32 v38, v39, 2, v38
    s_cmp_lg_u32 s3, 0
    s_cbranch_scc1 L_pdone7
    s_mov_b32 s15, 0
    s_mov_b32 exec_lo, 511
    s_mov_b32 exec_hi, 0
L_poll7:
    buffer_load_dword v30, v28, s[24:27], 0 offen sc1
    s_add_u32 s15, s15, 1
    s_waitcnt vmcnt(0)
    v_cmp_lt_u32 vcc, v30, v29
    s_cmp_gt_u32 s15, 1048576
    s_cbranch_scc1 L_pexit7
    s_nop 2
    s_cbranch_vccz L_pexit7
    s_sleep 1
    s_branch L_poll7
L_pexit7:
    s_mov_b64 exec, -1
L_pdone7:
    s_waitcnt vmcnt(0)
    s_barrier
    s_add_u32 m0, s38, 81920
    s_nop 0
    buffer_load_dwordx4 v1, s[24:27], s37 offen offset:0 lds
    buffer_load_dwordx4 v1, s[24:27], s37 offen offset:1024 lds
    buffer_load_dwordx4 v1, s[24:27], s37 offen offset:2048 lds
    buffer_load_dwordx4 v1, s[24:27], s37 offen offset:3072 lds
    s_add_u32 s37, s37, 4096
    s_add_u32 m0, s38, 98304
    s_nop 0
    buffer_load_dwordx4 v1, s[24:27], s37 offen offset:0 lds
    buffer_load_dwordx4 v1, s[24:27], s37 offen offset:1024 lds
    buffer_load_dwordx4 v1, s[24:27], s37 offen offset:2048 lds
    buffer_load_dwordx4 v1, s[24:27], s37 offen offset:3072 lds
    s_add_u32 s37, s37, 4096
    s_add_u32 m0, s38, 114688
    s_nop 0
    buffer_load_dwordx4 v1, s[24:27], s37 offen offset:0 lds
    buffer_load_dwordx4 v1, s[24:27], s37 offen offset:1024 lds
    buffer_load_dwordx4 v1, s[24:27], s37 offen offset:2048 lds
    buffer_load_dwordx4 v1, s[24:27], s37 offen offset:3072 lds
    s_add_u32 s37, s37, 4096
    s_waitcnt vmcnt(8)
    s_barrier
    ds_read_b64_tr_b16 v[40:41], v2 offset:0
    ds_read_b64_tr_b16 v[42:43], v2 offset:512
    ds_read_b64_tr_b16 v[44:45], v2 offset:4096
    ds_read_b64_tr_b16 v[46:47], v2 offset:4608
    v_add_u32 v4, 81920, v4
    ds_read_b128 a[0:3], v4 offset:0
    ds_read_b128 a[4:7], v4 offset:256
    v_add_u32 v5, 81920, v5
    ds_read_b128 a[8:11], v5 offset:0
    ds_read_b128 a[12:15], v5 offset:256
    ds_read_b128 a[16:19], v4 offset:2048
    ds_read_b128 a[20:23], v4 offset:2304
    ds_read_b128 a[24:27], v5 offset:2048
    ds_read_b128 a[28:31], v5 offset:2304
    ds_read_b64_tr_b16 v[48:49], v2 offset:8192
    ds_read_b64_tr_b16 v[50:51], v2 offset:8704
    ds_read_b64_tr_b16 v[52:53], v2 offset:12288
    ds_read_b64_tr_b16 v[54:55], v2 offset:12800
    s_waitcnt lgkmcnt(4)
    v_mfma_f32_16x16x32_bf16 v[96:99], v[40:43], a[0:3], 0
    s_waitcnt vmcnt(4)
    s_barrier
    v_mfma_f32_16x16x32_bf16 v[96:99], v[44:47], a[16:19], v[96:99]
    s_add_u32 m0, s38, 131072
    ds_read_b64_tr_b16 v[56:57], v3 offset:0
    v_mfma_f32_16x16x32_bf16 v[112:115], v[40:43], a[4:7], 0
    ds_read_b128 a[32:35], v4 offset:16384
    v_mfma_f32_16x16x32_bf16 v[112:115], v[44:47], a[20:23], v[112:115]
    ds_read_b64_tr_b16 v[58:59], v3 offset:512
    v_mfma_f32_16x16x32_bf16 v[128:131], v[40:43], a[8:11], 0
    buffer_load_dwordx4 v1, s[24:27], s37 offen offset:0 lds
    v_mfma_f32_16x16x32_bf16 v[128:131], v[44:47], a[24:27], v[128:131]
    ds_read_b64_tr_b16 v[60:61], v3 offset:4096
    ds_read_b128 a[36:39], v4 offset:16640
    v_mfma_f32_16x16x32_bf16 v[144:147], v[40:43], a[12:15], 0
    buffer_load_dwordx4 v1, s[24:27], s37 offen offset:1024 lds
    v_mfma_f32_16x16x32_bf16 v[144:147], v[44:47], a[28:31], v[144:147]
    ds_read_b64_tr_b16 v[62:63], v3 offset:4608
    s_waitcnt lgkmcnt(6)
    v_mfma_f32_16x16x32_bf16 v[100:103], v[48:51], a[0:3], 0
    ds_read_b128 a[40:43], v5 offset:16384
    buffer_load_dwordx4 v1, s[24:27], s37 offen offset:2048 lds
    v_mfma_f32_16x16x32_bf16 v[100:103], v[52:55], a[16:19], v[100:103]
    ds_read_b64_tr_b16 v[40:41], v3 offset:8192
    v_mfma_f32_16x16x32_bf16 v[116:119], v[48:51], a[4:7], 0
    buffer_load_dwordx4 v1, s[24:27], s37 offen offset:3072 lds
    v_mfma_f32_16x16x32_bf16 v[116:119], v[52:55], a[20:23], v[116:119]
    s_add_u32 s37, s37, 4096
    ds_read_b64_tr_b16 v[42:43], v3 offset:8704
    ds_read_b128 a[44:47], v5 offset:16640
    v_mfma_f32_16x16x32_bf16 v[132:135], v[48:51], a[8:11], 0
    s_add_u32 m0, s38, 147456
    v_mfma_f32_16x16x32_bf16 v[132:135], v[52:55], a[24:27], v[132:135]
    ds_read_b64_tr_b16 v[44:45], v3 offset:12288
    v_mfma_f32_16x16x32_bf16 v[148:151], v[48:51], a[12:15], 0
    buffer_load_dwordx4 v1, s[24:27], s37 offen offset:0 lds
    v_mfma_f32_16x16x32_bf16 v[148:151], v[52:55], a[28:31], v[148:151]
    ds_read_b64_tr_b16 v[46:47], v3 offset:12800
    s_waitcnt lgkmcnt(6)
    v_mfma_f32_16x16x32_bf16 v[104:107], v[56:59], a[0:3], 0
    ds_read_b128 a[48:51], v4 offset:18432
    buffer_load_dwordx4 v1, s[24:27], s37 offen offset:1024 lds
    v_mfma_f32_16x16x32_bf16 v[104:107], v[60:63], a[16:19], v[104:107]
    ds_read_b64_tr_b16 v[48:49], v2 offset:16384
    v_mfma_f32_16x16x32_bf16 v[120:123], v[56:59], a[4:7], 0
    ds_read_b128 a[52:55], v4 offset:18688
    buffer_load_dwordx4 v1, s[24:27], s37 offen offset:2048 lds
    v_mfma_f32_16x16x32_bf16 v[120:123], v[60:63], a[20:23], v[120:123]
    ds_read_b64_tr_b16 v[50:51], v2 offset:16896
    buffer_load_dwordx4 v1, s[24:27], s37 offen offset:3072 lds
    v_mfma_f32_16x16x32_bf16 v[136:139], v[56:59], a[8:11], 0
    s_add_u32 s37, s37, 4096
    v_mfma_f32_16x16x32_bf16 v[136:139], v[60:63], a[24:27], v[136:139]
    ds_read_b64_tr_b16 v[52:53], v2 offset:20480
    ds_read_b128 a[56:59], v5 offset:18432
    v_mfma_f32_16x16x32_bf16 v[152:155], v[56:59], a[12:15], 0
    v_mfma_f32_16x16x32_bf16 v[152:155], v[60:63], a[28:31], v[152:155]
    ds_read_b64_tr_b16 v[54:55], v2 offset:20992
    s_waitcnt lgkmcnt(7)
    v_mfma_f32_16x16x32_bf16 v[108:111], v[40:43], a[0:3], 0
    ds_read_b128 a[60:63], v5 offset:18688
    v_mfma_f32_16x16x32_bf16 v[108:111], v[44:47], a[16:19], v[108:111]
    ds_read_b64_tr_b16 v[56:57], v2 offset:24576
    v_mfma_f32_16x16x32_bf16 v[124:127], v[40:43], a[4:7], 0
    v_mfma_f32_16x16x32_bf16 v[124:127], v[44:47], a[20:23], v[124:127]
    ds_read_b64_tr_b16 v[58:59], v2 offset:25088
    v_mfma_f32_16x16x32_bf16 v[140:143], v[40:43], a[8:11], 0
    v_mfma_f32_16x16x32_bf16 v[140:143], v[44:47], a[24:27], v[140:143]
    ds_read_b64_tr_b16 v[60:61], v2 offset:28672
    v_mfma_f32_16x16x32_bf16 v[156:159], v[40:43], a[12:15], 0
    v_mfma_f32_16x16x32_bf16 v[156:159], v[44:47], a[28:31], v[156:159]
    ds_read_b64_tr_b16 v[62:63], v2 offset:29184
    s_waitcnt lgkmcnt(4)
    v_mfma_f32_16x16x32_bf16 v[96:99], v[48:51], a[32:35], v[96:99]
    s_waitcnt vmcnt(8)
    s_barrier
    v_add_u32 v240, 0, v0
    v_mfma_f32_16x16x32_bf16 v[96:99], v[52:55], a[48:51], v[96:99]
    s_add_u32 m0, s38, 81920
    ds_read_b64_tr_b16 v[40:41], v3 offset:16384
    v_mfma_f32_16x16x32_bf16 v[112:115], v[48:51], a[36:39], v[112:115]
    ds_read_b128 a[64:67], v4 offset:32768
    v_mul_u32_u24 v241, 3641, v240
    v_mfma_f32_16x16x32_bf16 v[112:115], v[52:55], a[52:55], v[112:115]
    ds_read_b64_tr_b16 v[42:43], v3 offset:16896
    v_mfma_f32_16x16x32_bf16 v[128:131], v[48:51], a[40:43], v[128:131]
    buffer_load_dwordx4 v1, s[24:27], s37 offen offset:0 lds
    v_mfma_f32_16x16x32_bf16 v[128:131], v[52:55], a[56:59], v[128:131]
    ds_read_b64_tr_b16 v[44:45], v3 offset:20480
    ds_read_b128 a[68:71], v4 offset:33024
    v_mfma_f32_16x16x32_bf16 v[144:147], v[48:51], a[44:47], v[144:147]
    buffer_load_dwordx4 v1, s[24:27], s37 offen offset:1024 lds
    v_mfma_f32_16x16x32_bf16 v[144:147], v[52:55], a[60:63], v[144:147]
    ds_read_b64_tr_b16 v[46:47], v3 offset:20992
    s_waitcnt lgkmcnt(6)
    v_mfma_f32_16x16x32_bf16 v[100:103], v[56:59], a[32:35], v[100:103]
    ds_read_b128 a[72:75], v5 offset:32768
    buffer_load_dwordx4 v1, s[24:27], s37 offen offset:2048 lds
    v_mfma_f32_16x16x32_bf16 v[100:103], v[60:63], a[48:51], v[100:103]
    ds_read_b64_tr_b16 v[48:49], v3 offset:24576
    buffer_load_dwordx4 v1, s[24:27], s37 offen offset:3072 lds
    v_mfma_f32_16x16x32_bf16 v[116:119], v[56:59], a[36:39], v[116:119]
    s_add_u32 s37, s37, 4096
    s_add_u32 m0, s38, 0
    v_lshrrev_b32 v241, 16, v241
    v_mfma_f32_16x16x32_bf16 v[116:119], v[60:63], a[52:55], v[116:119]
    ds_read_b64_tr_b16 v[50:51], v3 offset:25088
    ds_read_b128 a[76:79], v5 offset:33024
    v_mfma_f32_16x16x32_bf16 v[132:135], v[56:59], a[40:43], v[132:135]
    buffer_load_dwordx4 v15, s[16:19], 0 offen offset:0 lds
    v_mfma_f32_16x16x32_bf16 v[132:135], v[60:63], a[56:59], v[132:135]
    ds_read_b64_tr_b16 v[52:53], v3 offset:28672
    v_mul_u32_u24 v242, 18, v241
    v_mfma_f32_16x16x32_bf16 v[148:151], v[56:59], a[44:47], v[148:151]
    buffer_load_dwordx4 v16, s[16:19], s33 offen offset:1024 lds
    v_mfma_f32_16x16x32_bf16 v[148:151], v[60:63], a[60:63], v[148:151]
    ds_read_b64_tr_b16 v[54:55], v3 offset:29184
    s_waitcnt lgkmcnt(6)
    v_mfma_f32_16x16x32_bf16 v[104:107], v[40:43], a[32:35], v[104:107]
    ds_read_b128 a[80:83], v4 offset:34816
    v_sub_u32 v240, v240, v242
    v_mfma_f32_16x16x32_bf16 v[104:107], v[44:47], a[48:51], v[104:107]
    ds_read_b64_tr_b16 v[56:57], v2 offset:32768
    buffer_load_dwordx4 v15, s[16:19], s34 offen offset:2048 lds
    v_mfma_f32_16x16x32_bf16 v[120:123], v[40:43], a[36:39], v[120:123]
    ds_read_b128 a[84:87], v4 offset:35072
    buffer_load_dwordx4 v16, s[16:19], s35 offen offset:3072 lds
    v_mfma_f32_16x16x32_bf16 v[120:123], v[44:47], a[52:55], v[120:123]
    ds_read_b64_tr_b16 v[58:59], v2 offset:33280
    v_add_u32 v15, 589824, v15
    v_add_u32 v16, 589824, v16
    v_mfma_f32_16x16x32_bf16 v[136:139], v[40:43], a[40:43], v[136:139]
    v_and_b32 v242, 7, v241
    v_bfe_u32 v243, v241, 3, 1
    v_mfma_f32_16x16x32_bf16 v[136:139], v[44:47], a[56:59], v[136:139]
    ds_read_b64_tr_b16 v[60:61], v2 offset:36864
    ds_read_b128 a[88:91], v5 offset:34816
    v_mfma_f32_16x16x32_bf16 v[152:155], v[40:43], a[44:47], v[152:155]
    v_lshl_add_u32 v242, v243, 4, v242
    v_lshrrev_b32 v243, 4, v241
    v_mfma_f32_16x16x32_bf16 v[152:155], v[44:47], a[60:63], v[152:155]
    ds_read_b64_tr_b16 v[62:63], v2 offset:37376
    s_waitcnt lgkmcnt(7)
    v_mfma_f32_16x16x32_bf16 v[108:111], v[48:51], a[32:35], v[108:111]
    ds_read_b128 a[92:95], v5 offset:35072
    v_lshl_add_u32 v242, v243, 3, v242
    v_mfma_f32_16x16x32_bf16 v[108:111], v[52:55], a[48:51], v[108:111]
    ds_read_b64_tr_b16 v[40:41], v2 offset:40960
    v_mul_u32_u24 v242, 1152, v242
    v_mfma_f32_16x16x32_bf16 v[124:127], v[48:51], a[36:39], v[124:127]
    v_lshl_add_u32 v242, v240, 4, v242
    v_add_u32 v8, 4096, v242
    v_mfma_f32_16x16x32_bf16 v[124:127], v[52:55], a[52:55], v[124:127]
    ds_read_b64_tr_b16 v[42:43], v2 offset:41472
    v_mfma_f32_16x16x32_bf16 v[140:143], v[48:51], a[40:43], v[140:143]
    v_add_u32 v240, 64, v0
    v_mfma_f32_16x16x32_bf16 v[140:143], v[52:55], a[56:59], v[140:143]
    ds_read_b64_tr_b16 v[44:45], v2 offset:45056
    v_mfma_f32_16x16x32_bf16 v[156:159], v[48:51], a[44:47], v[156:159]
    v_mul_u32_u24 v241, 3641, v240
    v_mfma_f32_16x16x32_bf16 v[156:159], v[52:55], a[60:63], v[156:159]
    ds_read_b64_tr_b16 v[46:47], v2 offset:45568
    s_waitcnt lgkmcnt(4)
    v_mfma_f32_16x16x32_bf16 v[96:99], v[56:59], a[64:67], v[96:99]
    s_waitcnt vmcnt(12)
    s_barrier
    v_lshrrev_b32 v241, 16, v241
    v_mfma_f32_16x16x32_bf16 v[96:99], v[60:63], a[80:83], v[96:99]
    s_add_u32 m0, s38, 98304
    ds_read_b64_tr_b16 v[48:49], v3 offset:32768
    v_mfma_f32_16x16x32_bf16 v[112:115], v[56:59], a[68:71], v[112:115]
    ds_read_b128 a[96:99], v4 offset:49152
    v_mfma_f32_16x16x32_bf16 v[112:115], v[60:63], a[84:87], v[112:115]
    ds_read_b64_tr_b16 v[50:51], v3 offset:33280
    v_mul_u32_u24 v242, 18, v241
    v_mfma_f32_16x16x32_bf16 v[128:131], v[56:59], a[72:75], v[128:131]
    buffer_load_dwordx4 v1, s[24:27], s37 offen offset:0 lds
    v_mfma_f32_16x16x32_bf16 v[128:131], v[60:63], a[88:91], v[128:131]
    ds_read_b64_tr_b16 v[52:53], v3 offset:36864
    ds_read_b128 a[100:103], v4 offset:49408
    v_mfma_f32_16x16x32_bf16 v[144:147], v[56:59], a[76:79], v[144:147]
    buffer_load_dwordx4 v1, s[24:27], s37 offen offset:1024 lds
    v_mfma_f32_16x16x32_bf16 v[144:147], v[60:63], a[92:95], v[144:147]
    ds_read_b64_tr_b16 v[54:55], v3 offset:37376
    s_waitcnt lgkmcnt(6)
    v_mfma_f32_16x16x32_bf16 v[100:103], v[40:43], a[64:67], v[100:103]
    ds_read_b128 a[104:107], v5 offset:49152
    buffer_load_dwordx4 v1, s[24:27], s37 offen offset:2048 lds
    v_mfma_f32_16x16x32_bf16 v[100:103], v[44:47], a[80:83], v[100:103]
    ds_read_b64_tr_b16 v[56:57], v3 offset:40960
    buffer_load_dwordx4 v1, s[24:27], s37 offen offset:3072 lds
    v_mfma_f32_16x16x32_bf16 v[116:119], v[40:43], a[68:71], v[116:119]
    s_add_u32 s37, s37, 4096
    s_add_u32 m0, s38, 16384
    v_sub_u32 v240, v240, v242
    v_mfma_f32_16x16x32_bf16 v[116:119], v[44:47], a[84:87], v[116:119]
    ds_read_b64_tr_b16 v[58:59], v3 offset:41472
    ds_read_b128 a[108:111], v5 offset:49408
    v_mfma_f32_16x16x32_bf16 v[132:135], v[40:43], a[72:75], v[132:135]
    buffer_load_dwordx4 v15, s[16:19], 0 offen offset:0 lds
    v_mfma_f32_16x16x32_bf16 v[132:135], v[44:47], a[88:91], v[132:135]
    ds_read_b64_tr_b16 v[60:61], v3 offset:45056
    v_and_b32 v242, 7, v241
    v_mfma_f32_16x16x32_bf16 v[148:151], v[40:43], a[76:79], v[148:151]
    buffer_load_dwordx4 v16, s[16:19], s33 offen offset:1024 lds
    v_mfma_f32_16x16x32_bf16 v[148:151], v[44:47], a[92:95], v[148:151]
    ds_read_b64_tr_b16 v[62:63], v3 offset:45568
    s_waitcnt lgkmcnt(6)
    v_mfma_f32_16x16x32_bf16 v[104:107], v[48:51], a[64:67], v[104:107]
    ds_read_b128 a[112:115], v4 offset:51200
    v_bfe_u32 v243, v241, 3, 1
    v_mfma_f32_16x16x32_bf16 v[104:107], v[52:55], a[80:83], v[104:107]
    ds_read_b64_tr_b16 v[40:41], v2 offset:49152
    buffer_load_dwordx4 v15, s[16:19], s34 offen offset:2048 lds
    v_mfma_f32_16x16x32_bf16 v[120:123], v[48:51], a[68:71], v[120:123]
    ds_read_b128 a[116:119], v4 offset:51456
    buffer_load_dwordx4 v16, s[16:19], s35 offen offset:3072 lds
    v_mfma_f32_16x16x32_bf16 v[120:123], v[52:55], a[84:87], v[120:123]
    ds_read_b64_tr_b16 v[42:43], v2 offset:49664
    v_add_u32 v15, 589824, v15
    v_add_u32 v16, 589824, v16
    v_mfma_f32_16x16x32_bf16 v[136:139], v[48:51], a[72:75], v[136:139]
    v_lshl_add_u32 v242, v243, 4, v242
    v_lshrrev_b32 v243, 4, v241
    v_mfma_f32_16x16x32_bf16 v[136:139], v[52:55], a[88:91], v[136:139]
    ds_read_b64_tr_b16 v[44:45], v2 offset:53248
    ds_read_b128 a[120:123], v5 offset:51200
    v_mfma_f32_16x16x32_bf16 v[152:155], v[48:51], a[76:79], v[152:155]
    v_lshl_add_u32 v242, v243, 3, v242
    v_mul_u32_u24 v242, 1152, v242
    v_mfma_f32_16x16x32_bf16 v[152:155], v[52:55], a[92:95], v[152:155]
    ds_read_b64_tr_b16 v[46:47], v2 offset:53760
    s_waitcnt lgkmcnt(7)
    v_mfma_f32_16x16x32_bf16 v[108:111], v[56:59], a[64:67], v[108:111]
    ds_read_b128 a[124:127], v5 offset:51456
    v_lshl_add_u32 v242, v240, 4, v242
    v_mfma_f32_16x16x32_bf16 v[108:111], v[60:63], a[80:83], v[108:111]
    ds_read_b64_tr_b16 v[48:49], v2 offset:57344
    v_add_u32 v9, 3072, v242
    v_mfma_f32_16x16x32_bf16 v[124:127], v[56:59], a[68:71], v[124:127]
    v_add_u32 v240, 128, v0
    v_mfma_f32_16x16x32_bf16 v[124:127], v[60:63], a[84:87], v[124:127]
    ds_read_b64_tr_b16 v[50:51], v2 offset:57856
    v_mul_u32_u24 v241, 3641, v240
    v_mfma_f32_16x16x32_bf16 v[140:143], v[56:59], a[72:75], v[140:143]
    v_mfma_f32_16x16x32_bf16 v[140:143], v[60:63], a[88:91], v[140:143]
    ds_read_b64_tr_b16 v[52:53], v2 offset:61440
    v_lshrrev_b32 v241, 16, v241
    v_mfma_f32_16x16x32_bf16 v[156:159], v[56:59], a[76:79], v[156:159]
    v_mfma_f32_16x16x32_bf16 v[156:159], v[60:63], a[92:95], v[156:159]
    ds_read_b64_tr_b16 v[54:55], v2 offset:61952
    s_waitcnt lgkmcnt(4)
    v_mfma_f32_16x16x32_bf16 v[96:99], v[40:43], a[96:99], v[96:99]
    s_waitcnt vmcnt(16)
    s_barrier
    v_mul_u32_u24 v242, 18, v241
    v_mfma_f32_16x16x32_bf16 v[96:99], v[44:47], a[112:115], v[96:99]
    s_add_u32 m0, s38, 114688
    ds_read_b64_tr_b16 v[56:57], v3 offset:49152
    v_sub_u32 v240, v240, v242
    v_mfma_f32_16x16x32_bf16 v[112:115], v[40:43], a[100:103], v[112:115]
    v_add_u32 v4, 65536, v4
    ds_read_b128 a[128:131], v4 offset:0
    v_mfma_f32_16x16x32_bf16 v[112:115], v[44:47], a[116:119], v[112:115]
    ds_read_b64_tr_b16 v[58:59], v3 offset:49664
    v_and_b32 v242, 7, v241
    v_mfma_f32_16x16x32_bf16 v[128:131], v[40:43], a[104:107], v[128:131]
    buffer_load_dwordx4 v1, s[24:27], s37 offen offset:0 lds
    v_mfma_f32_16x16x32_bf16 v[128:131], v[44:47], a[120:123], v[128:131]
    ds_read_b64_tr_b16 v[60:61], v3 offset:53248
    v_mfma_f32_16x16x32_bf16 v[144:147], v[40:43], a[108:111], v[144:147]
    buffer_load_dwordx4 v1, s[24:27], s37 offen offset:1024 lds
    v_mfma_f32_16x16x32_bf16 v[144:147], v[44:47], a[124:127], v[144:147]
    ds_read_b64_tr_b16 v[62:63], v3 offset:53760
    s_waitcnt lgkmcnt(5)
    v_mfma_f32_16x16x32_bf16 v[100:103], v[48:51], a[96:99], v[100:103]
    ds_read_b128 a[132:135], v4 offset:256
    buffer_load_dwordx4 v1, s[24:27], s37 offen offset:2048 lds
    v_mfma_f32_16x16x32_bf16 v[100:103], v[52:55], a[112:115], v[100:103]
    ds_read_b64_tr_b16 v[40:41], v3 offset:57344
    buffer_load_dwordx4 v1, s[24:27], s37 offen offset:3072 lds
    v_mfma_f32_16x16x32_bf16 v[116:119], v[48:51], a[100:103], v[116:119]
    s_add_u32 s37, s37, 4096
    v_add_u32 v5, 65536, v5
    ds_read_b128 a[136:139], v5 offset:0
    v_mfma_f32_16x16x32_bf16 v[116:119], v[52:55], a[116:119], v[116:119]
    s_add_u32 m0, s38, 32768
    ds_read_b64_tr_b16 v[42:43], v3 offset:57856
    v_bfe_u32 v243, v241, 3, 1
    v_mfma_f32_16x16x32_bf16 v[132:135], v[48:51], a[104:107], v[132:135]
    buffer_load_dwordx4 v15, s[16:19], 0 offen offset:0 lds
    v_mfma_f32_16x16x32_bf16 v[132:135], v[52:55], a[120:123], v[132:135]
    ds_read_b64_tr_b16 v[44:45], v3 offset:61440
    v_lshl_add_u32 v242, v243, 4, v242
    v_mfma_f32_16x16x32_bf16 v[148:151], v[48:51], a[108:111], v[148:151]
    buffer_load_dwordx4 v16, s[16:19], s33 offen offset:1024 lds
    v_mfma_f32_16x16x32_bf16 v[148:151], v[52:55], a[124:127], v[148:151]
    ds_read_b64_tr_b16 v[46:47], v3 offset:61952
    s_waitcnt lgkmcnt(6)
    v_mfma_f32_16x16x32_bf16 v[104:107], v[56:59], a[96:99], v[104:107]
    ds_read_b128 a[140:143], v5 offset:256
    v_lshrrev_b32 v243, 4, v241
    v_mfma_f32_16x16x32_bf16 v[104:107], v[60:63], a[112:115], v[104:107]
    v_add_u32 v2, 65536, v2
    ds_read_b64_tr_b16 v[48:49], v2 offset:0
    v_mfma_f32_16x16x32_bf16 v[120:123], v[56:59], a[100:103], v[120:123]
    ds_read_b128 a[144:147], v4 offset:2048
    buffer_load_dwordx4 v15, s[16:19], s34 offen offset:2048 lds
    v_mfma_f32_16x16x32_bf16 v[120:123], v[60:63], a[116:119], v[120:123]
    ds_read_b64_tr_b16 v[50:51], v2 offset:512
    buffer_load_dwordx4 v16, s[16:19], s35 offen offset:3072 lds
    v_mfma_f32_16x16x32_bf16 v[136:139], v[56:59], a[104:107], v[136:139]
    ds_read_b128 a[148:151], v4 offset:2304
    v_add_u32 v15, 589824, v15
    v_add_u32 v16, 589824, v16
    v_mfma_f32_16x16x32_bf16 v[136:139], v[60:63], a[120:123], v[136:139]
    ds_read_b64_tr_b16 v[52:53], v2 offset:4096
    v_lshl_add_u32 v242, v243, 3, v242
    v_mfma_f32_16x16x32_bf16 v[152:155], v[56:59], a[108:111], v[152:155]
    ds_read_b128 a[152:155], v5 offset:2048
    v_mul_u32_u24 v242, 1152, v242
    v_mfma_f32_16x16x32_bf16 v[152:155], v[60:63], a[124:127], v[152:155]
    ds_read_b64_tr_b16 v[54:55], v2 offset:4608
    s_waitcnt lgkmcnt(8)
    v_mfma_f32_16x16x32_bf16 v[108:111], v[40:43], a[96:99], v[108:111]
    v_lshl_add_u32 v242, v240, 4, v242
    v_add_u32 v10, 2048, v242
    v_mfma_f32_16x16x32_bf16 v[108:111], v[44:47], a[112:115], v[108:111]
    ds_read_b64_tr_b16 v[56:57], v2 offset:8192
    ds_read_b128 a[156:159], v5 offset:2304
    v_mfma_f32_16x16x32_bf16 v[124:127], v[40:43], a[100:103], v[124:127]
    v_add_u32 v240, 192, v0
    v_mul_u32_u24 v241, 3641, v240
    v_mfma_f32_16x16x32_bf16 v[124:127], v[44:47], a[116:119], v[124:127]
    ds_read_b64_tr_b16 v[58:59], v2 offset:8704
    v_lshrrev_b32 v241, 16, v241
    v_mfma_f32_16x16x32_bf16 v[140:143], v[40:43], a[104:107], v[140:143]
    v_mul_u32_u24 v242, 18, v241
    v_mfma_f32_16x16x32_bf16 v[140:143], v[44:47], a[120:123], v[140:143]
    ds_read_b64_tr_b16 v[60:61], v2 offset:12288
    v_mfma_f32_16x16x32_bf16 v[156:159], v[40:43], a[108:111], v[156:159]
    v_sub_u32 v240, v240, v242
    v_mfma_f32_16x16x32_bf16 v[156:159], v[44:47], a[124:127], v[156:159]
    ds_read_b64_tr_b16 v[62:63], v2 offset:12800
    s_waitcnt lgkmcnt(3)
    v_mfma_f32_16x16x32_bf16 v[96:99], v[48:51], a[128:131], v[96:99]
    s_waitcnt vmcnt(16)
    s_barrier
    v_and_b32 v242, 7, v241
    v_mfma_f32_16x16x32_bf16 v[96:99], v[52:55], a[144:147], v[96:99]
    s_add_u32 m0, s38, 131072
    v_add_u32 v3, 65536, v3
    ds_read_b64_tr_b16 v[40:41], v3 offset:0
    v_mfma_f32_16x16x32_bf16 v[112:115], v[48:51], a[132:135], v[112:115]
    v_add_u32 v4, 4294901760, v4
    ds_read_b128 a[160:163], v4 offset:0
    v_mfma_f32_16x16x32_bf16 v[112:115], v[52:55], a[148:151], v[112:115]
    ds_read_b64_tr_b16 v[42:43], v3 offset:512
    buffer_load_dwordx4 v1, s[24:27], s37 offen offset:0 lds
    v_mfma_f32_16x16x32_bf16 v[128:131], v[48:51], a[136:139], v[128:131]
    buffer_load_dwordx4 v1, s[24:27], s37 offen offset:1024 lds
    v_mfma_f32_16x16x32_bf16 v[128:131], v[52:55], a[152:155], v[128:131]
    ds_read_b64_tr_b16 v[44:45], v3 offset:4096
    v_bfe_u32 v243, v241, 3, 1
    v_mfma_f32_16x16x32_bf16 v[144:147], v[48:51], a[140:143], v[144:147]
    buffer_load_dwordx4 v1, s[24:27], s37 offen offset:2048 lds
    v_mfma_f32_16x16x32_bf16 v[144:147], v[52:55], a[156:159], v[144:147]
    ds_read_b64_tr_b16 v[46:47], v3 offset:4608
    s_waitcnt lgkmcnt(5)
    v_mfma_f32_16x16x32_bf16 v[100:103], v[56:59], a[128:131], v[100:103]
    ds_read_b128 a[164:167], v4 offset:256
    buffer_load_dwordx4 v1, s[24:27], s37 offen offset:3072 lds
    v_mfma_f32_16x16x32_bf16 v[100:103], v[60:63], a[144:147], v[100:103]
    s_add_u32 s37, s37, 4096
    ds_read_b64_tr_b16 v[48:49], v3 offset:8192
    s_add_u32 m0, s38, 49152
    v_mfma_f32_16x16x32_bf16 v[116:119], v[56:59], a[132:135], v[116:119]
    v_add_u32 v5, 4294901760, v5
    ds_read_b128 a[168:171], v5 offset:0
    v_mfma_f32_16x16x32_bf16 v[116:119], v[60:63], a[148:151], v[116:119]
    s_cmp_eq_u32 s8, 8
    s_cselect_b32 s60, 36864, 0
    s_sub_u32 s37, s37, s60
    ds_read_b64_tr_b16 v[50:51], v3 offset:8704
    v_mfma_f32_16x16x32_bf16 v[132:135], v[56:59], a[136:139], v[132:135]
    buffer_load_dwordx4 v15, s[16:19], 0 offen offset:0 lds
    v_mfma_f32_16x16x32_bf16 v[132:135], v[60:63], a[152:155], v[132:135]
    ds_read_b64_tr_b16 v[52:53], v3 offset:12288
    v_lshl_add_u32 v242, v243, 4, v242
    v_mfma_f32_16x16x32_bf16 v[148:151], v[56:59], a[140:143], v[148:151]
    buffer_load_dwordx4 v16, s[16:19], s33 offen offset:1024 lds
    v_mfma_f32_16x16x32_bf16 v[148:151], v[60:63], a[156:159], v[148:151]
    s_cmp_eq_u32 s8, 8
    s_cselect_b32 s13, s12, s9
    ds_read_b64_tr_b16 v[54:55], v3 offset:12800
    s_waitcnt lgkmcnt(6)
    v_mfma_f32_16x16x32_bf16 v[104:107], v[40:43], a[128:131], v[104:107]
    s_add_u32 s13, s13, 128
    ds_read_b128 a[172:175], v5 offset:256
    v_lshrrev_b32 v243, 4, v241
    v_mfma_f32_16x16x32_bf16 v[104:107], v[44:47], a[144:147], v[104:107]
    v_add_u32 v2, 4294901760, v2
    ds_read_b64_tr_b16 v[56:57], v2 offset:0
    v_mfma_f32_16x16x32_bf16 v[120:123], v[40:43], a[132:135], v[120:123]
    ds_read_b128 a[176:179], v4 offset:2048
    buffer_load_dwordx4 v15, s[16:19], s34 offen offset:2048 lds
    v_mfma_f32_16x16x32_bf16 v[120:123], v[44:47], a[148:151], v[120:123]
    ds_read_b64_tr_b16 v[58:59], v2 offset:512
    buffer_load_dwordx4 v16, s[16:19], s35 offen offset:3072 lds
    v_mfma_f32_16x16x32_bf16 v[136:139], v[40:43], a[136:139], v[136:139]
    ds_read_b128 a[180:183], v4 offset:2304
    v_add_u32 v15, s13, v15
    v_add_u32 v16, s13, v16
    v_mfma_f32_16x16x32_bf16 v[136:139], v[44:47], a[152:155], v[136:139]
    ds_read_b64_tr_b16 v[60:61], v2 offset:4096
    v_lshl_add_u32 v242, v243, 3, v242
    v_mfma_f32_16x16x32_bf16 v[152:155], v[40:43], a[140:143], v[152:155]
    ds_read_b128 a[184:187], v5 offset:2048
    v_mul_u32_u24 v242, 1152, v242
    v_mfma_f32_16x16x32_bf16 v[152:155], v[44:47], a[156:159], v[152:155]
    ds_read_b64_tr_b16 v[62:63], v2 offset:4608
    s_waitcnt lgkmcnt(8)
    v_mfma_f32_16x16x32_bf16 v[108:111], v[48:51], a[128:131], v[108:111]
    v_lshl_add_u32 v242, v240, 4, v242
    v_add_u32 v11, 1024, v242
    v_mfma_f32_16x16x32_bf16 v[108:111], v[52:55], a[144:147], v[108:111]
    ds_read_b64_tr_b16 v[40:41], v2 offset:8192
    ds_read_b128 a[188:191], v5 offset:2304
    buffer_load_dword v28, v38, s[24:27], s54 offen offset:0 sc1
    v_mfma_f32_16x16x32_bf16 v[124:127], v[48:51], a[132:135], v[124:127]
    v_add_u32 v240, 256, v0
    v_mul_u32_u24 v241, 3641, v240
    v_mfma_f32_16x16x32_bf16 v[124:127], v[52:55], a[148:151], v[124:127]
    ds_read_b64_tr_b16 v[42:43], v2 offset:8704
    v_lshrrev_b32 v241, 16, v241
    v_mfma_f32_16x16x32_bf16 v[140:143], v[48:51], a[136:139], v[140:143]
    v_mul_u32_u24 v242, 18, v241
    v_sub_u32 v240, v240, v242
    v_mfma_f32_16x16x32_bf16 v[140:143], v[52:55], a[152:155], v[140:143]
    ds_read_b64_tr_b16 v[44:45], v2 offset:12288
    v_and_b32 v242, 7, v241
    buffer_load_dword v29, v38, s[24:27], s54 offen offset:128 sc1
    v_mfma_f32_16x16x32_bf16 v[156:159], v[48:51], a[140:143], v[156:159]
    v_bfe_u32 v243, v241, 3, 1
    v_mfma_f32_16x16x32_bf16 v[156:159], v[52:55], a[156:159], v[156:159]
    ds_read_b64_tr_b16 v[46:47], v2 offset:12800
    s_waitcnt lgkmcnt(3)
    v_mfma_f32_16x16x32_bf16 v[96:99], v[56:59], a[160:163], v[96:99]
    s_waitcnt vmcnt(18)
    s_barrier
    buffer_load_dword v30, v38, s[24:27], s54 offen offset:256 sc1
    v_mfma_f32_16x16x32_bf16 v[96:99], v[60:63], a[176:179], v[96:99]
    s_add_u32 m0, s38, 147456
    v_add_u32 v3, 4294901760, v3
    ds_read_b64_tr_b16 v[48:49], v3 offset:0
    v_mfma_f32_16x16x32_bf16 v[112:115], v[56:59], a[164:167], v[112:115]
    ds_read_b128 a[192:195], v4 offset:16384
    v_lshl_add_u32 v242, v243, 4, v242
    v_mfma_f32_16x16x32_bf16 v[112:115], v[60:63], a[180:183], v[112:115]
    ds_read_b64_tr_b16 v[50:51], v3 offset:512
    v_lshrrev_b32 v243, 4, v241
    buffer_load_dword v31, v38, s[24:27], s54 offen offset:384 sc1
    v_mfma_f32_16x16x32_bf16 v[128:131], v[56:59], a[168:171], v[128:131]
    buffer_load_dwordx4 v15, s[16:19], 0 offen offset:0 lds
    v_mfma_f32_16x16x32_bf16 v[128:131], v[60:63], a[184:187], v[128:131]
    ds_read_b64_tr_b16 v[52:53], v3 offset:4096
    ds_read_b128 a[196:199], v4 offset:16640
    v_mfma_f32_16x16x32_bf16 v[144:147], v[56:59], a[172:175], v[144:147]
    buffer_load_dwordx4 v16, s[16:19], s33 offen offset:1024 lds
    v_mfma_f32_16x16x32_bf16 v[144:147], v[60:63], a[188:191], v[144:147]
    ds_read_b64_tr_b16 v[54:55], v3 offset:4608
    buffer_load_dword v32, v38, s[24:27], s54 offen offset:512 sc1
    s_waitcnt lgkmcnt(6)
    v_mfma_f32_16x16x32_bf16 v[100:103], v[40:43], a[160:163], v[100:103]
    ds_read_b128 a[200:203], v5 offset:16384
    buffer_load_dwordx4 v15, s[16:19], s34 offen offset:2048 lds
    v_mfma_f32_16x16x32_bf16 v[100:103], v[44:47], a[176:179], v[100:103]
    ds_read_b64_tr_b16 v[56:57], v3 offset:8192
    buffer_load_dwordx4 v16, s[16:19], s35 offen offset:3072 lds
    v_mfma_f32_16x16x32_bf16 v[116:119], v[40:43], a[164:167], v[116:119]
    v_add_u32 v15, 589824, v15
    v_add_u32 v16, 589824, v16
    buffer_load_dword v33, v38, s[24:27], s54 offen offset:640 sc1
    v_mfma_f32_16x16x32_bf16 v[116:119], v[44:47], a[180:183], v[116:119]
    s_add_u32 m0, s38, 65536
    ds_read_b64_tr_b16 v[58:59], v3 offset:8704
    ds_read_b128 a[204:207], v5 offset:16640
    v_mfma_f32_16x16x32_bf16 v[132:135], v[40:43], a[168:171], v[132:135]
    buffer_load_dwordx4 v15, s[16:19], 0 offen offset:0 lds
    v_mfma_f32_16x16x32_bf16 v[132:135], v[44:47], a[184:187], v[132:135]
    ds_read_b64_tr_b16 v[60:61], v3 offset:12288
    v_lshl_add_u32 v242, v243, 3, v242
    v_mfma_f32_16x16x32_bf16 v[148:151], v[40:43], a[172:175], v[148:151]
    buffer_load_dwordx4 v16, s[16:19], s33 offen offset:1024 lds
    buffer_load_dword v34, v38, s[24:27], s54 offen offset:768 sc1
    v_mfma_f32_16x16x32_bf16 v[148:151], v[44:47], a[188:191], v[148:151]
    ds_read_b64_tr_b16 v[62:63], v3 offset:12800
    s_waitcnt lgkmcnt(6)
    v_mfma_f32_16x16x32_bf16 v[104:107], v[48:51], a[160:163], v[104:107]
    ds_read_b128 a[208:211], v4 offset:18432
    v_mul_u32_u24 v242, 1152, v242
    v_mfma_f32_16x16x32_bf16 v[104:107], v[52:55], a[176:179], v[104:107]
    ds_read_b64_tr_b16 v[40:41], v2 offset:16384
    buffer_load_dwordx4 v15, s[16:19], s34 offen offset:2048 lds
    buffer_load_dword v35, v38, s[24:27], s54 offen offset:896 sc1
    v_mfma_f32_16x16x32_bf16 v[120:123], v[48:51], a[164:167], v[120:123]
    ds_read_b128 a[212:215], v4 offset:18688
    buffer_load_dwordx4 v16, s[16:19], s35 offen offset:3072 lds
    buffer_load_dword v36, v38, s[24:27], s54 offen offset:1024 sc1
    v_mfma_f32_16x16x32_bf16 v[120:123], v[52:55], a[180:183], v[120:123]
    ds_read_b64_tr_b16 v[42:43], v2 offset:16896
    v_add_u32 v15, 589824, v15
    v_add_u32 v16, 589824, v16
    v_mfma_f32_16x16x32_bf16 v[136:139], v[48:51], a[168:171], v[136:139]
    v_lshl_add_u32 v242, v240, 4, v242
    v_add_u32 v12, 4096, v242
    v_mfma_f32_16x16x32_bf16 v[136:139], v[52:55], a[184:187], v[136:139]
    ds_read_b64_tr_b16 v[44:45], v2 offset:20480
    ds_read_b128 a[216:219], v5 offset:18432
    v_mfma_f32_16x16x32_bf16 v[152:155], v[48:51], a[172:175], v[152:155]
    v_add_u32 v240, 320, v0
    v_mul_u32_u24 v241, 3641, v240
    v_mfma_f32_16x16x32_bf16 v[152:155], v[52:55], a[188:191], v[152:155]
    ds_read_b64_tr_b16 v[46:47], v2 offset:20992
    s_waitcnt lgkmcnt(7)
    v_mfma_f32_16x16x32_bf16 v[108:111], v[56:59], a[160:163], v[108:111]
    ds_read_b128 a[220:223], v5 offset:18688
    v_lshrrev_b32 v241, 16, v241
    v_mfma_f32_16x16x32_bf16 v[108:111], v[60:63], a[176:179], v[108:111]
    ds_read_b64_tr_b16 v[48:49], v2 offset:24576
    v_mul_u32_u24 v242, 18, v241
    v_mfma_f32_16x16x32_bf16 v[124:127], v[56:59], a[164:167], v[124:127]
    v_sub_u32 v240, v240, v242
    v_and_b32 v242, 7, v241
    v_mfma_f32_16x16x32_bf16 v[124:127], v[60:63], a[180:183], v[124:127]
    ds_read_b64_tr_b16 v[50:51], v2 offset:25088
    v_bfe_u32 v243, v241, 3, 1
    v_mfma_f32_16x16x32_bf16 v[140:143], v[56:59], a[168:171], v[140:143]
    v_mfma_f32_16x16x32_bf16 v[140:143], v[60:63], a[184:187], v[140:143]
    ds_read_b64_tr_b16 v[52:53], v2 offset:28672
    v_lshl_add_u32 v242, v243, 4, v242
    v_mfma_f32_16x16x32_bf16 v[156:159], v[56:59], a[172:175], v[156:159]
    v_mfma_f32_16x16x32_bf16 v[156:159], v[60:63], a[188:191], v[156:159]
    ds_read_b64_tr_b16 v[54:55], v2 offset:29184
    s_waitcnt lgkmcnt(4)
    v_mfma_f32_16x16x32_bf16 v[96:99], v[40:43], a[192:195], v[96:99]
    s_waitcnt vmcnt(25)
    s_barrier
    v_lshrrev_b32 v243, 4, v241
    v_mfma_f32_16x16x32_bf16 v[96:99], v[44:47], a[208:211], v[96:99]
    s_add_u32 m0, s38, 81920
    ds_read_b64_tr_b16 v[56:57], v3 offset:16384
    v_lshl_add_u32 v242, v243, 3, v242
    v_mfma_f32_16x16x32_bf16 v[112:115], v[40:43], a[196:199], v[112:115]
    ds_read_b128 a[224:227], v4 offset:32768
    v_mfma_f32_16x16x32_bf16 v[112:115], v[44:47], a[212:215], v[112:115]
    ds_read_b64_tr_b16 v[58:59], v3 offset:16896
    v_mfma_f32_16x16x32_bf16 v[128:131], v[40:43], a[200:203], v[128:131]
    buffer_load_dwordx4 v15, s[16:19], 0 offen offset:0 lds
    v_mfma_f32_16x16x32_bf16 v[128:131], v[44:47], a[216:219], v[128:131]
    ds_read_b64_tr_b16 v[60:61], v3 offset:20480
    ds_read_b128 a[228:231], v4 offset:33024
    v_mfma_f32_16x16x32_bf16 v[144:147], v[40:43], a[204:207], v[144:147]
    buffer_load_dwordx4 v16, s[16:19], s33 offen offset:1024 lds
    v_mfma_f32_16x16x32_bf16 v[144:147], v[44:47], a[220:223], v[144:147]
    ds_read_b64_tr_b16 v[62:63], v3 offset:20992
    s_waitcnt lgkmcnt(6)
    v_mfma_f32_16x16x32_bf16 v[100:103], v[48:51], a[192:195], v[100:103]
    ds_read_b128 a[232:235], v5 offset:32768
    buffer_load_dwordx4 v15, s[16:19], s34 offen offset:2048 lds
    v_mfma_f32_16x16x32_bf16 v[100:103], v[52:55], a[208:211], v[100:103]
    ds_read_b64_tr_b16 v[40:41], v3 offset:24576
    buffer_load_dwordx4 v16, s[16:19], s35 offen offset:3072 lds
    v_mfma_f32_16x16x32_bf16 v[116:119], v[48:51], a[196:199], v[116:119]
    v_add_u32 v15, 589824, v15
    v_add_u32 v16, 589824, v16
    v_mfma_f32_16x16x32_bf16 v[116:119], v[52:55], a[212:215], v[116:119]
    s_add_u32 m0, s38, 0
    ds_read_b64_tr_b16 v[42:43], v3 offset:25088
    ds_read_b128 a[236:239], v5 offset:33024
    v_mfma_f32_16x16x32_bf16 v[132:135], v[48:51], a[200:203], v[132:135]
    buffer_load_dwordx4 v15, s[16:19], 0 offen offset:0 lds
    v_mfma_f32_16x16x32_bf16 v[132:135], v[52:55], a[216:219], v[132:135]
    ds_read_b64_tr_b16 v[44:45], v3 offset:28672
    v_mul_u32_u24 v242, 1152, v242
    v_mfma_f32_16x16x32_bf16 v[148:151], v[48:51], a[204:207], v[148:151]
    buffer_load_dwordx4 v16, s[16:19], s33 offen offset:1024 lds
    v_mfma_f32_16x16x32_bf16 v[148:151], v[52:55], a[220:223], v[148:151]
    ds_read_b64_tr_b16 v[46:47], v3 offset:29184
    s_waitcnt lgkmcnt(6)
    v_mfma_f32_16x16x32_bf16 v[104:107], v[56:59], a[192:195], v[104:107]
    ds_read_b128 a[240:243], v4 offset:34816
    v_lshl_add_u32 v242, v240, 4, v242
    v_mfma_f32_16x16x32_bf16 v[104:107], v[60:63], a[208:211], v[104:107]
    ds_read_b64_tr_b16 v[48:49], v2 offset:32768
    buffer_load_dwordx4 v15, s[16:19], s34 offen offset:2048 lds
    v_mfma_f32_16x16x32_bf16 v[120:123], v[56:59], a[196:199], v[120:123]
    ds_read_b128 a[244:247], v4 offset:35072
    buffer_load_dwordx4 v16, s[16:19], s35 offen offset:3072 lds
    v_mfma_f32_16x16x32_bf16 v[120:123], v[60:63], a[212:215], v[120:123]
    ds_read_b64_tr_b16 v[50:51], v2 offset:33280
    v_add_u32 v15, 589824, v15
    v_add_u32 v16, 589824, v16
    v_mfma_f32_16x16x32_bf16 v[136:139], v[56:59], a[200:203], v[136:139]
    v_add_u32 v13, 3072, v242
    v_add_u32 v240, 384, v0
    v_mfma_f32_16x16x32_bf16 v[136:139], v[60:63], a[216:219], v[136:139]
    ds_read_b64_tr_b16 v[52:53], v2 offset:36864
    ds_read_b128 a[248:251], v5 offset:34816
    v_mfma_f32_16x16x32_bf16 v[152:155], v[56:59], a[204:207], v[152:155]
    v_mul_u32_u24 v241, 3641, v240
    v_lshrrev_b32 v241, 16, v241
    v_mfma_f32_16x16x32_bf16 v[152:155], v[60:63], a[220:223], v[152:155]
    ds_read_b64_tr_b16 v[54:55], v2 offset:37376
    s_waitcnt lgkmcnt(7)
    v_mfma_f32_16x16x32_bf16 v[108:111], v[40:43], a[192:195], v[108:111]
    ds_read_b128 a[252:255], v5 offset:35072
    v_mul_u32_u24 v242, 18, v241
    v_mfma_f32_16x16x32_bf16 v[108:111], v[44:47], a[208:211], v[108:111]
    ds_read_b64_tr_b16 v[56:57], v2 offset:40960
    v_sub_u32 v240, v240, v242
    v_mfma_f32_16x16x32_bf16 v[124:127], v[40:43], a[196:199], v[124:127]
    v_and_b32 v242, 7, v241
    v_bfe_u32 v243, v241, 3, 1
    v_mfma_f32_16x16x32_bf16 v[124:127], v[44:47], a[212:215], v[124:127]
    ds_read_b64_tr_b16 v[58:59], v2 offset:41472
    v_lshl_add_u32 v242, v243, 4, v242
    v_mfma_f32_16x16x32_bf16 v[140:143], v[40:43], a[200:203], v[140:143]
    v_lshrrev_b32 v243, 4, v241
    v_mfma_f32_16x16x32_bf16 v[140:143], v[44:47], a[216:219], v[140:143]
    ds_read_b64_tr_b16 v[60:61], v2 offset:45056
    v_mfma_f32_16x16x32_bf16 v[156:159], v[40:43], a[204:207], v[156:159]
    v_lshl_add_u32 v242, v243, 3, v242
    v_mfma_f32_16x16x32_bf16 v[156:159], v[44:47], a[220:223], v[156:159]
    ds_read_b64_tr_b16 v[62:63], v2 offset:45568
    s_waitcnt lgkmcnt(4)
    v_mfma_f32_16x16x32_bf16 v[96:99], v[48:51], a[224:227], v[96:99]
    s_waitcnt vmcnt(25)
    s_barrier
    v_mul_u32_u24 v242, 1152, v242
    v_mfma_f32_16x16x32_bf16 v[96:99], v[52:55], a[240:243], v[96:99]
    s_add_u32 m0, s38, 98304
    ds_read_b64_tr_b16 v[40:41], v3 offset:32768
    v_mfma_f32_16x16x32_bf16 v[112:115], v[48:51], a[228:231], v[112:115]
    ds_read_b128 v[64:67], v4 offset:49152
    v_lshl_add_u32 v242, v240, 4, v242
    v_mfma_f32_16x16x32_bf16 v[112:115], v[52:55], a[244:247], v[112:115]
    ds_read_b64_tr_b16 v[42:43], v3 offset:33280
    v_mfma_f32_16x16x32_bf16 v[128:131], v[48:51], a[232:235], v[128:131]
    buffer_load_dwordx4 v15, s[16:19], 0 offen offset:0 lds
    v_mfma_f32_16x16x32_bf16 v[128:131], v[52:55], a[248:251], v[128:131]
    ds_read_b64_tr_b16 v[44:45], v3 offset:36864
    ds_read_b128 v[68:71], v4 offset:49408
    v_mfma_f32_16x16x32_bf16 v[144:147], v[48:51], a[236:239], v[144:147]
    buffer_load_dwordx4 v16, s[16:19], s33 offen offset:1024 lds
    v_mfma_f32_16x16x32_bf16 v[144:147], v[52:55], a[252:255], v[144:147]
    ds_read_b64_tr_b16 v[46:47], v3 offset:37376
    s_waitcnt vmcnt(10)
    s_waitcnt lgkmcnt(6)
    v_mfma_f32_16x16x32_bf16 v[100:103], v[56:59], a[224:227], v[100:103]
    ds_read_b128 v[72:75], v5 offset:49152
    buffer_load_dwordx4 v15, s[16:19], s34 offen offset:2048 lds
    v_mfma_f32_16x16x32_bf16 v[100:103], v[60:63], a[240:243], v[100:103]
    ds_read_b64_tr_b16 v[48:49], v3 offset:40960
    buffer_load_dwordx4 v16, s[16:19], s35 offen offset:3072 lds
    v_mfma_f32_16x16x32_bf16 v[116:119], v[56:59], a[228:231], v[116:119]
    v_add_u32 v15, 589824, v15
    v_add_u32 v16, 589824, v16
    v_add_f32 v28, v28, v29
    v_mfma_f32_16x16x32_bf16 v[116:119], v[60:63], a[244:247], v[116:119]
    s_add_u32 m0, s38, 16384
    ds_read_b64_tr_b16 v[50:51], v3 offset:41472
    ds_read_b128 v[76:79], v5 offset:49408
    v_add_f32 v28, v28, v30
    v_mfma_f32_16x16x32_bf16 v[132:135], v[56:59], a[232:235], v[132:135]
    buffer_load_dwordx4 v15, s[16:19], 0 offen offset:0 lds
    v_add_f32 v28, v28, v31
    v_mfma_f32_16x16x32_bf16 v[132:135], v[60:63], a[248:251], v[132:135]
    ds_read_b64_tr_b16 v[52:53], v3 offset:45056
    v_add_u32 v14, 2048, v242
    v_add_f32 v28, v28, v32
    v_mfma_f32_16x16x32_bf16 v[148:151], v[56:59], a[236:239], v[148:151]
    buffer_load_dwordx4 v16, s[16:19], s33 offen offset:1024 lds
    v_add_f32 v28, v28, v33
    v_mfma_f32_16x16x32_bf16 v[148:151], v[60:63], a[252:255], v[148:151]
    ds_read_b64_tr_b16 v[54:55], v3 offset:45568
    s_waitcnt lgkmcnt(6)
    v_mfma_f32_16x16x32_bf16 v[104:107], v[40:43], a[224:227], v[104:107]
    ds_read_b128 v[80:83], v4 offset:51200
    v_add_u32 v240, 448, v0
    v_add_f32 v28, v28, v34
    v_mfma_f32_16x16x32_bf16 v[104:107], v[44:47], a[240:243], v[104:107]
    ds_read_b64_tr_b16 v[56:57], v2 offset:49152
    buffer_load_dwordx4 v15, s[16:19], s34 offen offset:2048 lds
    v_mfma_f32_16x16x32_bf16 v[120:123], v[40:43], a[228:231], v[120:123]
    ds_read_b128 v[84:87], v4 offset:51456
    buffer_load_dwordx4 v16, s[16:19], s35 offen offset:3072 lds
    v_mfma_f32_16x16x32_bf16 v[120:123], v[44:47], a[244:247], v[120:123]
    ds_read_b64_tr_b16 v[58:59], v2 offset:49664
    v_add_u32 v15, 589824, v15
    v_add_u32 v16, 589824, v16
    v_mfma_f32_16x16x32_bf16 v[136:139], v[40:43], a[232:235], v[136:139]
    v_mul_u32_u24 v241, 3641, v240
    v_lshrrev_b32 v241, 16, v241
    v_add_f32 v28, v28, v35
    v_mfma_f32_16x16x32_bf16 v[136:139], v[44:47], a[248:251], v[136:139]
    ds_read_b64_tr_b16 v[60:61], v2 offset:53248
    ds_read_b128 v[88:91], v5 offset:51200
    v_add_f32 v28, v28, v36
    v_mfma_f32_16x16x32_bf16 v[152:155], v[40:43], a[236:239], v[152:155]
    v_mul_u32_u24 v242, 18, v241
    v_sub_u32 v240, v240, v242
    v_mov_b32 v29, 0x3727c5ac
    v_mfma_f32_16x16x32_bf16 v[152:155], v[44:47], a[252:255], v[152:155]
    s_lshl_b32 s54, s32, 5
    ds_read_b64_tr_b16 v[62:63], v2 offset:53760
    v_fmac_f32 v29, 0x3ae38e39, v28
    s_waitcnt lgkmcnt(7)
    v_mfma_f32_16x16x32_bf16 v[108:111], v[48:51], a[224:227], v[108:111]
    ds_read_b128 v[92:95], v5 offset:51456
    v_and_b32 v242, 7, v241
    v_mfma_f32_16x16x32_bf16 v[108:111], v[52:55], a[240:243], v[108:111]
    ds_read_b64_tr_b16 v[40:41], v2 offset:57344
    v_bfe_u32 v243, v241, 3, 1
    v_and_b32 v32, 15, v0
    v_mfma_f32_16x16x32_bf16 v[124:127], v[48:51], a[228:231], v[124:127]
    v_lshl_add_u32 v242, v243, 4, v242
    v_lshrrev_b32 v243, 4, v241
    v_mfma_f32_16x16x32_bf16 v[124:127], v[52:55], a[244:247], v[124:127]
    ds_read_b64_tr_b16 v[42:43], v2 offset:57856
    v_lshl_add_u32 v242, v243, 3, v242
    v_add_u32 v32, s54, v32
    v_mfma_f32_16x16x32_bf16 v[140:143], v[48:51], a[232:235], v[140:143]
    v_mul_u32_u24 v242, 1152, v242
    v_rsq_f32 v30, v29
    v_mfma_f32_16x16x32_bf16 v[140:143], v[52:55], a[248:251], v[140:143]
    ds_read_b64_tr_b16 v[44:45], v2 offset:61440
    v_lshlrev_b32 v32, 2, v32
    v_mfma_f32_16x16x32_bf16 v[156:159], v[48:51], a[236:239], v[156:159]
    v_rcp_f32 v31, v29
    v_mfma_f32_16x16x32_bf16 v[156:159], v[52:55], a[252:255], v[156:159]
    ds_read_b64_tr_b16 v[46:47], v2 offset:61952
    s_waitcnt lgkmcnt(4)
    v_mfma_f32_16x16x32_bf16 v[96:99], v[56:59], v[64:67], v[96:99]
    s_waitcnt vmcnt(24)
    s_barrier
    v_lshl_add_u32 v242, v240, 4, v242
    v_mfma_f32_16x16x32_bf16 v[96:99], v[60:63], v[80:83], v[96:99]
    s_add_u32 m0, s38, 114688
    ds_read_b64_tr_b16 v[48:49], v3 offset:49152
    v_add_u32 v17, 1024, v242
    v_mfma_f32_16x16x32_bf16 v[112:115], v[56:59], v[68:71], v[112:115]
    buffer_load_dwordx4 v15, s[16:19], 0 offen offset:0 lds
    v_mfma_f32_16x16x32_bf16 v[112:115], v[60:63], v[84:87], v[112:115]
    ds_read_b64_tr_b16 v[50:51], v3 offset:49664
    v_add_u32 v240, 512, v0
    s_getpc_b64 s[4:5]
L_p4_pc:
    s_mov_b32 s6, L_code_end-L_p4_pc
    s_mov_b32 s7, 0x20000
    v_mfma_f32_16x16x32_bf16 v[128:131], v[56:59], v[72:75], v[128:131]
    buffer_load_dwordx4 v16, s[16:19], s33 offen offset:1024 lds
    v_mul_f32 v30, 0xbfb8aa3b, v30
    v_mfma_f32_16x16x32_bf16 v[128:131], v[60:63], v[88:91], v[128:131]
    ds_read_b64_tr_b16 v[52:53], v3 offset:53248
    v_mul_u32_u24 v241, 3641, v240
    v_mfma_f32_16x16x32_bf16 v[144:147], v[56:59], v[76:79], v[144:147]
    buffer_load_dwordx4 v15, s[16:19], s34 offen offset:2048 lds
    v_xor_b32 v33, 128, v32
    v_mfma_f32_16x16x32_bf16 v[144:147], v[60:63], v[92:95], v[144:147]
    s_lshl_b32 s54, s2, 1
    ds_read_b64_tr_b16 v[54:55], v3 offset:53760
    ds_bpermute_b32 v24, v32, v30
    s_waitcnt lgkmcnt(5)
    v_mfma_f32_16x16x32_bf16 v[100:103], v[40:43], v[64:67], v[100:103]
    s_add_u32 s54, s54, s31
    buffer_load_dwordx4 v16, s[16:19], s35 offen offset:3072 lds
    v_mfma_f32_16x16x32_bf16 v[100:103], v[44:47], v[80:83], v[100:103]
    s_add_u32 m0, s38, 32768
    ds_read_b64_tr_b16 v[56:57], v3 offset:57344
    v_add_u32 v15, 589824, v15
    v_mfma_f32_16x16x32_bf16 v[116:119], v[40:43], v[68:71], v[116:119]
    s_lshl_b32 s54, s54, 8
    v_lshrrev_b32 v241, 16, v241
    v_mul_u32_u24 v242, 18, v241
    v_mfma_f32_16x16x32_bf16 v[116:119], v[44:47], v[84:87], v[116:119]
    s_add_u32 s54, s54, 15204352
    ds_read_b64_tr_b16 v[58:59], v3 offset:57856
    v_add_u32 v16, 589824, v16
    v_mfma_f32_16x16x32_bf16 v[132:135], v[40:43], v[72:75], v[132:135]
    s_mov_b32 s55, s32
    buffer_load_dwordx4 v15, s[16:19], 0 offen offset:0 lds
    v_mfma_f32_16x16x32_bf16 v[132:135], v[44:47], v[88:91], v[132:135]
    ds_read_b64_tr_b16 v[60:61], v3 offset:61440
    v_sub_u32 v240, v240, v242
    v_mfma_f32_16x16x32_bf16 v[148:151], v[40:43], v[76:79], v[148:151]
    buffer_load_dwordx4 v16, s[16:19], s33 offen offset:1024 lds
    v_mfma_f32_16x16x32_bf16 v[148:151], v[44:47], v[92:95], v[148:151]
    ds_read_b64_tr_b16 v[62:63], v3 offset:61952
    s_waitcnt lgkmcnt(5)
    v_mfma_f32_16x16x32_bf16 v[104:107], v[48:51], v[64:67], v[104:107]
    buffer_load_dwordx4 v15, s[16:19], s34 offen offset:2048 lds
    v_mfma_f32_16x16x32_bf16 v[104:107], v[52:55], v[80:83], v[104:107]
    v_add_u32 v2, 147456, v2
    ds_read_b64_tr_b16 v[40:41], v2 offset:0
    ds_bpermute_b32 v25, v32, v30 offset:64
    v_mfma_f32_16x16x32_bf16 v[120:123], v[48:51], v[68:71], v[120:123]
    buffer_load_dwordx4 v16, s[16:19], s35 offen offset:3072 lds
    ds_bpermute_b32 v26, v33, v30
    v_mfma_f32_16x16x32_bf16 v[120:123], v[52:55], v[84:87], v[120:123]
    ds_read_b64_tr_b16 v[42:43], v2 offset:512
    v_add_u32 v15, 589824, v15
    v_mfma_f32_16x16x32_bf16 v[136:139], v[48:51], v[72:75], v[136:139]
    v_add_u32 v16, 589824, v16
    v_and_b32 v242, 7, v241
    ds_bpermute_b32 v27, v33, v30 offset:64
    v_mfma_f32_16x16x32_bf16 v[136:139], v[52:55], v[88:91], v[136:139]
    ds_read_b64_tr_b16 v[44:45], v2 offset:4096
    v_bfe_u32 v243, v241, 3, 1
    v_lshlrev_b32 v34, 2, v0
    v_mfma_f32_16x16x32_bf16 v[152:155], v[48:51], v[76:79], v[152:155]
    v_lshl_add_u32 v242, v243, 4, v242
    v_lshrrev_b32 v243, 4, v241
    v_mfma_f32_16x16x32_bf16 v[152:155], v[52:55], v[92:95], v[152:155]
    s_cmp_eq_u32 s55, 0
    s_cselect_b32 s54, s54, 0x40000000
    ds_read_b64_tr_b16 v[46:47], v2 offset:4608
    s_waitcnt lgkmcnt(7)
    v_mfma_f32_16x16x32_bf16 v[108:111], v[56:59], v[64:67], v[108:111]
    v_lshl_add_u32 v242, v243, 3, v242
    v_and_b32 v39, 15, v0
    v_mfma_f32_16x16x32_bf16 v[108:111], v[60:63], v[80:83], v[108:111]
    ds_read_b64_tr_b16 v[48:49], v2 offset:8192
    v_mul_u32_u24 v242, 1152, v242
    v_mfma_f32_16x16x32_bf16 v[124:127], v[56:59], v[68:71], v[124:127]
    buffer_store_dword v31, v34, s[24:27], s54 offen sc1
    v_mfma_f32_16x16x32_bf16 v[124:127], v[60:63], v[84:87], v[124:127]
    ds_read_b64_tr_b16 v[50:51], v2 offset:8704
    v_lshl_add_u32 v242, v240, 4, v242
    v_mfma_f32_16x16x32_bf16 v[140:143], v[56:59], v[72:75], v[140:143]
    v_lshlrev_b32 v39, 7, v39
    v_add_u32 v39, s39, v39
    v_mfma_f32_16x16x32_bf16 v[140:143], v[60:63], v[88:91], v[140:143]
    ds_read_b64_tr_b16 v[52:53], v2 offset:12288
    v_add_u32 v18, 4096, v242
    v_mfma_f32_16x16x32_bf16 v[156:159], v[56:59], v[76:79], v[156:159]
    v_mfma_f32_16x16x32_bf16 v[156:159], v[60:63], v[92:95], v[156:159]
    ds_read_b64_tr_b16 v[54:55], v2 offset:12800
    s_waitcnt lgkmcnt(4)
    v_mfma_f32_16x16x32_bf16 v[160:163], v[40:43], a[0:3], 0
    s_waitcnt vmcnt(26)
    s_barrier
    v_mfma_f32_16x16x32_bf16 v[160:163], v[44:47], a[16:19], v[160:163]
    s_add_u32 m0, s38, 131072
    v_add_u32 v3, 147456, v3
    ds_read_b64_tr_b16 v[56:57], v3 offset:0
    v_mfma_f32_16x16x32_bf16 v[176:179], v[40:43], a[4:7], 0
    v_mfma_f32_16x16x32_bf16 v[176:179], v[44:47], a[20:23], v[176:179]
    ds_read_b64_tr_b16 v[58:59], v3 offset:512
    v_mfma_f32_16x16x32_bf16 v[192:195], v[40:43], a[8:11], 0
    buffer_load_dwordx4 v15, s[16:19], 0 offen offset:0 lds
    v_mfma_f32_16x16x32_bf16 v[192:195], v[44:47], a[24:27], v[192:195]
    ds_read_b64_tr_b16 v[60:61], v3 offset:4096
    v_mfma_f32_16x16x32_bf16 v[208:211], v[40:43], a[12:15], 0
    v_mfma_f32_16x16x32_bf16 v[208:211], v[44:47], a[28:31], v[208:211]
    ds_read_b64_tr_b16 v[62:63], v3 offset:4608
    s_waitcnt lgkmcnt(4)
    v_mfma_f32_16x16x32_bf16 v[164:167], v[48:51], a[0:3], 0
    buffer_load_dwordx4 v16, s[16:19], s33 offen offset:1024 lds
    v_mfma_f32_16x16x32_bf16 v[164:167], v[52:55], a[16:19], v[164:167]
    ds_read_b64_tr_b16 v[40:41], v3 offset:8192
    v_mul_f32 v28, v24, v96
    v_mfma_f32_16x16x32_bf16 v[180:183], v[48:51], a[4:7], 0
    v_mul_f32 v29, v24, v97
    v_mul_f32 v30, v96, v100
    v_mfma_f32_16x16x32_bf16 v[180:183], v[52:55], a[20:23], v[180:183]
    s_cmp_eq_u32 s8, 8
    s_cselect_b32 s13, s12, s9
    ds_read_b64_tr_b16 v[42:43], v3 offset:8704
    v_mfma_f32_16x16x32_bf16 v[196:199], v[48:51], a[8:11], 0
    v_exp_f32 v28, v28
    v_mfma_f32_16x16x32_bf16 v[196:199], v[52:55], a[24:27], v[196:199]
    ds_read_b64_tr_b16 v[44:45], v3 offset:12288
    v_mul_f32 v31, v97, v101
    v_mfma_f32_16x16x32_bf16 v[212:215], v[48:51], a[12:15], 0
    v_exp_f32 v29, v29
    v_mfma_f32_16x16x32_bf16 v[212:215], v[52:55], a[28:31], v[212:215]
    ds_read_b64_tr_b16 v[46:47], v3 offset:12800
    s_waitcnt lgkmcnt(4)
    v_mfma_f32_16x16x32_bf16 v[168:171], v[56:59], a[0:3], 0
    buffer_load_dwordx4 v15, s[16:19], s34 offen offset:2048 lds
    v_mfma_f32_16x16x32_bf16 v[168:171], v[60:63], a[16:19], v[168:171]
    v_add_u32 v2, 4294885376, v2
    ds_read_b64_tr_b16 v[48:49], v2 offset:0
    v_add_f32 v28, 1.0, v28
    v_mfma_f32_16x16x32_bf16 v[184:187], v[56:59], a[4:7], 0
    v_add_f32 v29, 1.0, v29
    v_mul_f32 v32, v24, v98
    v_mfma_f32_16x16x32_bf16 v[184:187], v[60:63], a[20:23], v[184:187]
    ds_read_b64_tr_b16 v[50:51], v2 offset:512
    v_mul_f32 v33, v24, v99
    v_mfma_f32_16x16x32_bf16 v[200:203], v[56:59], a[8:11], 0
    buffer_load_dwordx4 v16, s[16:19], s35 offen offset:3072 lds
    v_mfma_f32_16x16x32_bf16 v[200:203], v[60:63], a[24:27], v[200:203]
    ds_read_b64_tr_b16 v[52:53], v2 offset:4096
    v_rcp_f32 v28, v28
    v_mfma_f32_16x16x32_bf16 v[216:219], v[56:59], a[12:15], 0
    v_rcp_f32 v29, v29
    v_mfma_f32_16x16x32_bf16 v[216:219], v[60:63], a[28:31], v[216:219]
    ds_read_b64_tr_b16 v[54:55], v2 offset:4608
    s_waitcnt lgkmcnt(4)
    v_mfma_f32_16x16x32_bf16 v[172:175], v[40:43], a[0:3], 0
    s_add_u32 s13, s13, 128
    v_mul_f32 v30, v30, v28
    v_mul_f32 v31, v31, v29
    v_mfma_f32_16x16x32_bf16 v[172:175], v[44:47], a[16:19], v[172:175]
    ds_read_b64_tr_b16 v[56:57], v2 offset:8192
    v_cvt_pk_bf16_f32 v224, v30, v31
    v_mfma_f32_16x16x32_bf16 v[188:191], v[40:43], a[4:7], 0
    v_add_u32 v15, s13, v15
    v_mul_f32 v34, v98, v102
    v_mfma_f32_16x16x32_bf16 v[188:191], v[44:47], a[20:23], v[188:191]
    ds_read_b64_tr_b16 v[58:59], v2 offset:8704
    v_mul_f32 v35, v99, v103
    v_mfma_f32_16x16x32_bf16 v[204:207], v[40:43], a[8:11], 0
    v_exp_f32 v32, v32
    v_mfma_f32_16x16x32_bf16 v[204:207], v[44:47], a[24:27], v[204:207]
    ds_read_b64_tr_b16 v[60:61], v2 offset:12288
    v_add_u32 v16, s13, v16
    v_mfma_f32_16x16x32_bf16 v[220:223], v[40:43], a[12:15], 0
    v_exp_f32 v33, v33
    v_mfma_f32_16x16x32_bf16 v[220:223], v[44:47], a[28:31], v[220:223]
    ds_read_b64_tr_b16 v[62:63], v2 offset:12800
    s_waitcnt lgkmcnt(4)
    v_mfma_f32_16x16x32_bf16 v[160:163], v[48:51], a[32:35], v[160:163]
    s_waitcnt vmcnt(25)
    s_barrier
    v_add_f32 v32, 1.0, v32
    v_mfma_f32_16x16x32_bf16 v[160:163], v[52:55], a[48:51], v[160:163]
    s_add_u32 m0, s38, 49152
    v_add_u32 v3, 4294885376, v3
    ds_read_b64_tr_b16 v[40:41], v3 offset:0
    v_mfma_f32_16x16x32_bf16 v[176:179], v[48:51], a[36:39], v[176:179]
    buffer_load_dwordx4 v15, s[16:19], 0 offen offset:0 lds
    v_add_f32 v33, 1.0, v33
    v_mfma_f32_16x16x32_bf16 v[176:179], v[52:55], a[52:55], v[176:179]
    ds_read_b64_tr_b16 v[42:43], v3 offset:512
    v_rcp_f32 v32, v32
    v_mfma_f32_16x16x32_bf16 v[192:195], v[48:51], a[40:43], v[192:195]
    v_rcp_f32 v33, v33
    v_mfma_f32_16x16x32_bf16 v[192:195], v[52:55], a[56:59], v[192:195]
    ds_read_b64_tr_b16 v[44:45], v3 offset:4096
    v_mul_f32 v34, v34, v32
    v_mfma_f32_16x16x32_bf16 v[208:211], v[48:51], a[44:47], v[208:211]
    buffer_load_dwordx4 v16, s[16:19], s33 offen offset:1024 lds
    v_mfma_f32_16x16x32_bf16 v[208:211], v[52:55], a[60:63], v[208:211]
    ds_read_b64_tr_b16 v[46:47], v3 offset:4608
    s_waitcnt lgkmcnt(4)
    v_mfma_f32_16x16x32_bf16 v[164:167], v[56:59], a[32:35], v[164:167]
    buffer_load_dwordx4 v15, s[16:19], s34 offen offset:2048 lds
    v_mul_f32 v35, v35, v33
    v_mfma_f32_16x16x32_bf16 v[164:167], v[60:63], a[48:51], v[164:167]
    ds_read_b64_tr_b16 v[48:49], v3 offset:8192
    v_cvt_pk_bf16_f32 v225, v34, v35
    v_mul_f32 v28, v24, v104
    v_mfma_f32_16x16x32_bf16 v[180:183], v[56:59], a[36:39], v[180:183]
    buffer_load_dwordx4 v16, s[16:19], s35 offen offset:3072 lds
    v_mul_f32 v29, v24, v105
    v_mfma_f32_16x16x32_bf16 v[180:183], v[60:63], a[52:55], v[180:183]
    ds_read_b64_tr_b16 v[50:51], v3 offset:8704
    v_exp_f32 v28, v28
    v_mfma_f32_16x16x32_bf16 v[196:199], v[56:59], a[40:43], v[196:199]
    v_exp_f32 v29, v29
    v_mfma_f32_16x16x32_bf16 v[196:199], v[60:63], a[56:59], v[196:199]
    ds_read_b64_tr_b16 v[52:53], v3 offset:12288
    v_add_u32 v15, 589824, v15
    v_mfma_f32_16x16x32_bf16 v[212:215], v[56:59], a[44:47], v[212:215]
    v_add_u32 v16, 589824, v16
    v_mul_f32 v30, v104, v108
    v_mfma_f32_16x16x32_bf16 v[212:215], v[60:63], a[60:63], v[212:215]
    ds_read_b64_tr_b16 v[54:55], v3 offset:12800
    s_waitcnt lgkmcnt(4)
    v_mfma_f32_16x16x32_bf16 v[168:171], v[40:43], a[32:35], v[168:171]
    s_add_u32 m0, s38, 147456
    v_mul_f32 v31, v105, v109
    v_add_f32 v28, 1.0, v28
    v_mfma_f32_16x16x32_bf16 v[168:171], v[44:47], a[48:51], v[168:171]
    ds_read_b64_tr_b16 v[56:57], v2 offset:16384
    v_add_f32 v29, 1.0, v29
    v_mfma_f32_16x16x32_bf16 v[184:187], v[40:43], a[36:39], v[184:187]
    buffer_load_dwordx4 v15, s[16:19], 0 offen offset:0 lds
    v_mfma_f32_16x16x32_bf16 v[184:187], v[44:47], a[52:55], v[184:187]
    ds_read_b64_tr_b16 v[58:59], v2 offset:16896
    v_rcp_f32 v28, v28
    v_mfma_f32_16x16x32_bf16 v[200:203], v[40:43], a[40:43], v[200:203]
    buffer_load_dwordx4 v16, s[16:19], s33 offen offset:1024 lds
    v_mfma_f32_16x16x32_bf16 v[200:203], v[44:47], a[56:59], v[200:203]
    ds_read_b64_tr_b16 v[60:61], v2 offset:20480
    v_rcp_f32 v29, v29
    v_mfma_f32_16x16x32_bf16 v[216:219], v[40:43], a[44:47], v[216:219]
    v_mul_f32 v30, v30, v28
    v_mul_f32 v31, v31, v29
    v_mfma_f32_16x16x32_bf16 v[216:219], v[44:47], a[60:63], v[216:219]
    ds_read_b64_tr_b16 v[62:63], v2 offset:20992
    s_waitcnt lgkmcnt(4)
    v_mfma_f32_16x16x32_bf16 v[172:175], v[48:51], a[32:35], v[172:175]
    buffer_load_dwordx4 v15, s[16:19], s34 offen offset:2048 lds
    v_mfma_f32_16x16x32_bf16 v[172:175], v[52:55], a[48:51], v[172:175]
    ds_read_b64_tr_b16 v[40:41], v2 offset:24576
    v_add_u32 v15, 589824, v15
    v_cvt_pk_bf16_f32 v226, v30, v31
    v_mfma_f32_16x16x32_bf16 v[188:191], v[48:51], a[36:39], v[188:191]
    v_mul_f32 v32, v24, v106
    v_mul_f32 v33, v24, v107
    v_mfma_f32_16x16x32_bf16 v[188:191], v[52:55], a[52:55], v[188:191]
    ds_read_b64_tr_b16 v[42:43], v2 offset:25088
    v_exp_f32 v32, v32
    v_mfma_f32_16x16x32_bf16 v[204:207], v[48:51], a[40:43], v[204:207]
    buffer_load_dwordx4 v16, s[16:19], s35 offen offset:3072 lds
    v_mfma_f32_16x16x32_bf16 v[204:207], v[52:55], a[56:59], v[204:207]
    ds_read_b64_tr_b16 v[44:45], v2 offset:28672
    v_add_u32 v16, 589824, v16
    v_mul_f32 v34, v106, v110
    v_mfma_f32_16x16x32_bf16 v[220:223], v[48:51], a[44:47], v[220:223]
    v_exp_f32 v33, v33
    v_mfma_f32_16x16x32_bf16 v[220:223], v[52:55], a[60:63], v[220:223]
    ds_read_b64_tr_b16 v[46:47], v2 offset:29184
    s_waitcnt lgkmcnt(4)
    v_mfma_f32_16x16x32_bf16 v[160:163], v[56:59], a[64:67], v[160:163]
    s_waitcnt vmcnt(29)
    s_barrier
    v_mul_f32 v35, v107, v111
    v_mfma_f32_16x16x32_bf16 v[160:163], v[60:63], a[80:83], v[160:163]
    s_add_u32 m0, s38, 65536
    ds_read_b64_tr_b16 v[48:49], v3 offset:16384
    v_add_f32 v32, 1.0, v32
    v_mfma_f32_16x16x32_bf16 v[176:179], v[56:59], a[68:71], v[176:179]
    v_add_f32 v33, 1.0, v33
    v_mul_f32 v28, v25, v112
    v_mfma_f32_16x16x32_bf16 v[176:179], v[60:63], a[84:87], v[176:179]
    ds_read_b64_tr_b16 v[50:51], v3 offset:16896
    v_mul_f32 v29, v25, v113
    v_mfma_f32_16x16x32_bf16 v[192:195], v[56:59], a[72:75], v[192:195]
    buffer_load_dwordx4 v15, s[16:19], 0 offen offset:0 lds
    v_mfma_f32_16x16x32_bf16 v[192:195], v[60:63], a[88:91], v[192:195]
    ds_read_b64_tr_b16 v[52:53], v3 offset:20480
    v_rcp_f32 v32, v32
    v_mfma_f32_16x16x32_bf16 v[208:211], v[56:59], a[76:79], v[208:211]
    v_rcp_f32 v33, v33
    v_mfma_f32_16x16x32_bf16 v[208:211], v[60:63], a[92:95], v[208:211]
    ds_read_b64_tr_b16 v[54:55], v3 offset:20992
    s_waitcnt lgkmcnt(4)
    v_mfma_f32_16x16x32_bf16 v[164:167], v[40:43], a[64:67], v[164:167]
    v_mul_f32 v34, v34, v32
    v_mul_f32 v35, v35, v33
    v_mfma_f32_16x16x32_bf16 v[164:167], v[44:47], a[80:83], v[164:167]
    ds_read_b64_tr_b16 v[56:57], v3 offset:24576
    v_cvt_pk_bf16_f32 v227, v34, v35
    v_mfma_f32_16x16x32_bf16 v[180:183], v[40:43], a[68:71], v[180:183]
    buffer_load_dwordx4 v16, s[16:19], s33 offen offset:1024 lds
    v_mfma_f32_16x16x32_bf16 v[180:183], v[44:47], a[84:87], v[180:183]
    ds_read_b64_tr_b16 v[58:59], v3 offset:25088
    v_exp_f32 v28, v28
    v_mfma_f32_16x16x32_bf16 v[196:199], v[40:43], a[72:75], v[196:199]
    buffer_store_dwordx4 v[224:227], v1, s[24:27], s47 offen offset:0 sc1
    v_mfma_f32_16x16x32_bf16 v[196:199], v[44:47], a[88:91], v[196:199]
    ds_read_b64_tr_b16 v[60:61], v3 offset:28672
    v_mul_f32 v30, v112, v116
    v_mfma_f32_16x16x32_bf16 v[212:215], v[40:43], a[76:79], v[212:215]
    buffer_load_dwordx4 v15, s[16:19], s34 offen offset:2048 lds
    v_mfma_f32_16x16x32_bf16 v[212:215], v[44:47], a[92:95], v[212:215]
    ds_read_b64_tr_b16 v[62:63], v3 offset:29184
    s_waitcnt lgkmcnt(4)
    v_mfma_f32_16x16x32_bf16 v[168:171], v[48:51], a[64:67], v[168:171]
    v_exp_f32 v29, v29
    v_mfma_f32_16x16x32_bf16 v[168:171], v[52:55], a[80:83], v[168:171]
    v_add_u32 v2, 4294901760, v2
    ds_read_b64_tr_b16 v[40:41], v2 offset:0
    v_mfma_f32_16x16x32_bf16 v[184:187], v[48:51], a[68:71], v[184:187]
    v_mul_f32 v31, v113, v117
    v_add_f32 v28, 1.0, v28
    v_mfma_f32_16x16x32_bf16 v[184:187], v[52:55], a[84:87], v[184:187]
    ds_read_b64_tr_b16 v[42:43], v2 offset:512
    v_add_u32 v15, 589824, v15
    v_mfma_f32_16x16x32_bf16 v[200:203], v[48:51], a[72:75], v[200:203]
    v_add_f32 v29, 1.0, v29
    v_mul_f32 v32, v25, v114
    v_mfma_f32_16x16x32_bf16 v[200:203], v[52:55], a[88:91], v[200:203]
    ds_read_b64_tr_b16 v[44:45], v2 offset:4096
    v_mul_f32 v33, v25, v115
    v_mfma_f32_16x16x32_bf16 v[216:219], v[48:51], a[76:79], v[216:219]
    v_rcp_f32 v28, v28
    v_mfma_f32_16x16x32_bf16 v[216:219], v[52:55], a[92:95], v[216:219]
    ds_read_b64_tr_b16 v[46:47], v2 offset:4608
    s_waitcnt lgkmcnt(4)
    v_mfma_f32_16x16x32_bf16 v[172:175], v[56:59], a[64:67], v[172:175]
    buffer_load_dwordx4 v16, s[16:19], s35 offen offset:3072 lds
    v_mfma_f32_16x16x32_bf16 v[172:175], v[60:63], a[80:83], v[172:175]
    ds_read_b64_tr_b16 v[48:49], v2 offset:8192
    v_mul_f32 v30, v30, v28
    v_mfma_f32_16x16x32_bf16 v[188:191], v[56:59], a[68:71], v[188:191]
    v_rcp_f32 v29, v29
    v_mfma_f32_16x16x32_bf16 v[188:191], v[60:63], a[84:87], v[188:191]
    ds_read_b64_tr_b16 v[50:51], v2 offset:8704
    v_mul_f32 v31, v31, v29
    v_mfma_f32_16x16x32_bf16 v[204:207], v[56:59], a[72:75], v[204:207]
    v_add_u32 v16, 589824, v16
    v_cvt_pk_bf16_f32 v228, v30, v31
    v_mfma_f32_16x16x32_bf16 v[204:207], v[60:63], a[88:91], v[204:207]
    ds_read_b64_tr_b16 v[52:53], v2 offset:12288
    v_mul_f32 v34, v114, v118
    v_mfma_f32_16x16x32_bf16 v[220:223], v[56:59], a[76:79], v[220:223]
    v_exp_f32 v32, v32
    v_mfma_f32_16x16x32_bf16 v[220:223], v[60:63], a[92:95], v[220:223]
    ds_read_b64_tr_b16 v[54:55], v2 offset:12800
    s_waitcnt lgkmcnt(4)
    v_mfma_f32_16x16x32_bf16 v[160:163], v[40:43], a[96:99], v[160:163]
    s_waitcnt vmcnt(30)
    s_barrier
    v_mul_f32 v35, v115, v119
    v_mfma_f32_16x16x32_bf16 v[160:163], v[44:47], a[112:115], v[160:163]
    s_add_u32 m0, s38, 81920
    v_add_u32 v3, 4294901760, v3
    ds_read_b64_tr_b16 v[56:57], v3 offset:0
    v_mfma_f32_16x16x32_bf16 v[176:179], v[40:43], a[100:103], v[176:179]
    v_exp_f32 v33, v33
    v_mfma_f32_16x16x32_bf16 v[176:179], v[44:47], a[116:119], v[176:179]
    ds_read_b64_tr_b16 v[58:59], v3 offset:512
    v_add_f32 v32, 1.0, v32
    v_mfma_f32_16x16x32_bf16 v[192:195], v[40:43], a[104:107], v[192:195]
    buffer_load_dwordx4 v15, s[16:19], 0 offen offset:0 lds
    v_mfma_f32_16x16x32_bf16 v[192:195], v[44:47], a[120:123], v[192:195]
    ds_read_b64_tr_b16 v[60:61], v3 offset:4096
    v_add_f32 v33, 1.0, v33
    v_mfma_f32_16x16x32_bf16 v[208:211], v[40:43], a[108:111], v[208:211]
    v_rcp_f32 v32, v32
    v_mfma_f32_16x16x32_bf16 v[208:211], v[44:47], a[124:127], v[208:211]
    ds_read_b64_tr_b16 v[62:63], v3 offset:4608
    s_waitcnt lgkmcnt(4)
    v_mfma_f32_16x16x32_bf16 v[164:167], v[48:51], a[96:99], v[164:167]
    v_rcp_f32 v33, v33
    v_mfma_f32_16x16x32_bf16 v[164:167], v[52:55], a[112:115], v[164:167]
    ds_read_b64_tr_b16 v[40:41], v3 offset:8192
    v_mul_f32 v34, v34, v32
    v_mfma_f32_16x16x32_bf16 v[180:183], v[48:51], a[100:103], v[180:183]
    buffer_load_dwordx4 v16, s[16:19], s33 offen offset:1024 lds
    v_mfma_f32_16x16x32_bf16 v[180:183], v[52:55], a[116:119], v[180:183]
    ds_read_b64_tr_b16 v[42:43], v3 offset:8704
    v_mul_f32 v35, v35, v33
    v_mfma_f32_16x16x32_bf16 v[196:199], v[48:51], a[104:107], v[196:199]
    v_cvt_pk_bf16_f32 v229, v34, v35
    v_mul_f32 v28, v25, v120
    v_mfma_f32_16x16x32_bf16 v[196:199], v[52:55], a[120:123], v[196:199]
    ds_read_b64_tr_b16 v[44:45], v3 offset:12288
    v_mul_f32 v29, v25, v121
    v_mfma_f32_16x16x32_bf16 v[212:215], v[48:51], a[108:111], v[212:215]
    buffer_load_dwordx4 v15, s[16:19], s34 offen offset:2048 lds
    v_mfma_f32_16x16x32_bf16 v[212:215], v[52:55], a[124:127], v[212:215]
    ds_read_b64_tr_b16 v[46:47], v3 offset:12800
    s_waitcnt lgkmcnt(4)
    v_mfma_f32_16x16x32_bf16 v[168:171], v[56:59], a[96:99], v[168:171]
    v_exp_f32 v28, v28
    v_mfma_f32_16x16x32_bf16 v[168:171], v[60:63], a[112:115], v[168:171]
    v_add_u32 v2, 98304, v2
    ds_read_b64_tr_b16 v[48:49], v2 offset:0
    v_mfma_f32_16x16x32_bf16 v[184:187], v[56:59], a[100:103], v[184:187]
    v_exp_f32 v29, v29
    v_mfma_f32_16x16x32_bf16 v[184:187], v[60:63], a[116:119], v[184:187]
    ds_read_b64_tr_b16 v[50:51], v2 offset:512
    v_add_u32 v15, 589824, v15
    v_mfma_f32_16x16x32_bf16 v[200:203], v[56:59], a[104:107], v[200:203]
    v_mul_f32 v30, v120, v124
    v_mul_f32 v31, v121, v125
    v_mfma_f32_16x16x32_bf16 v[200:203], v[60:63], a[120:123], v[200:203]
    ds_read_b64_tr_b16 v[52:53], v2 offset:4096
    v_add_f32 v28, 1.0, v28
    v_mfma_f32_16x16x32_bf16 v[216:219], v[56:59], a[108:111], v[216:219]
    v_add_f32 v29, 1.0, v29
    v_mul_f32 v32, v25, v122
    v_mfma_f32_16x16x32_bf16 v[216:219], v[60:63], a[124:127], v[216:219]
    ds_read_b64_tr_b16 v[54:55], v2 offset:4608
    s_waitcnt lgkmcnt(4)
    v_mfma_f32_16x16x32_bf16 v[172:175], v[40:43], a[96:99], v[172:175]
    buffer_load_dwordx4 v16, s[16:19], s35 offen offset:3072 lds
    v_mfma_f32_16x16x32_bf16 v[172:175], v[44:47], a[112:115], v[172:175]
    ds_read_b64_tr_b16 v[56:57], v2 offset:8192
    v_mul_f32 v33, v25, v123
    v_mfma_f32_16x16x32_bf16 v[188:191], v[40:43], a[100:103], v[188:191]
    v_rcp_f32 v28, v28
    v_mfma_f32_16x16x32_bf16 v[188:191], v[44:47], a[116:119], v[188:191]
    ds_read_b64_tr_b16 v[58:59], v2 offset:8704
    v_mul_f32 v30, v30, v28
    v_mfma_f32_16x16x32_bf16 v[204:207], v[40:43], a[104:107], v[204:207]
    v_add_u32 v16, 589824, v16
    v_mul_f32 v34, v122, v126
    v_mfma_f32_16x16x32_bf16 v[204:207], v[44:47], a[120:123], v[204:207]
    ds_read_b64_tr_b16 v[60:61], v2 offset:12288
    v_mul_f32 v35, v123, v127
    v_mfma_f32_16x16x32_bf16 v[220:223], v[40:43], a[108:111], v[220:223]
    v_rcp_f32 v29, v29
    v_mfma_f32_16x16x32_bf16 v[220:223], v[44:47], a[124:127], v[220:223]
    ds_read_b64_tr_b16 v[62:63], v2 offset:12800
    s_waitcnt lgkmcnt(4)
    v_mfma_f32_16x16x32_bf16 v[160:163], v[48:51], a[128:131], v[160:163]
    s_waitcnt vmcnt(30)
    s_barrier
    v_mul_f32 v31, v31, v29
    v_mfma_f32_16x16x32_bf16 v[160:163], v[52:55], a[144:147], v[160:163]
    s_add_u32 m0, s38, 0
    v_add_u32 v3, 98304, v3
    ds_read_b64_tr_b16 v[40:41], v3 offset:0
    v_mfma_f32_16x16x32_bf16 v[176:179], v[48:51], a[132:135], v[176:179]
    v_cvt_pk_bf16_f32 v230, v30, v31
    v_mul_f32 v28, v26, v128
    v_mfma_f32_16x16x32_bf16 v[176:179], v[52:55], a[148:151], v[176:179]
    ds_read_b64_tr_b16 v[42:43], v3 offset:512
    v_mul_f32 v29, v26, v129
    v_mfma_f32_16x16x32_bf16 v[192:195], v[48:51], a[136:139], v[192:195]
    buffer_load_dwordx4 v15, s[16:19], 0 offen offset:0 lds
    v_mfma_f32_16x16x32_bf16 v[192:195], v[52:55], a[152:155], v[192:195]
    ds_read_b64_tr_b16 v[44:45], v3 offset:4096
    v_exp_f32 v32, v32
    v_mfma_f32_16x16x32_bf16 v[208:211], v[48:51], a[140:143], v[208:211]
    v_exp_f32 v33, v33
    v_mfma_f32_16x16x32_bf16 v[208:211], v[52:55], a[156:159], v[208:211]
    ds_read_b64_tr_b16 v[46:47], v3 offset:4608
    s_waitcnt lgkmcnt(4)
    v_mfma_f32_16x16x32_bf16 v[164:167], v[56:59], a[128:131], v[164:167]
    v_add_f32 v32, 1.0, v32
    v_add_f32 v33, 1.0, v33
    v_mfma_f32_16x16x32_bf16 v[164:167], v[60:63], a[144:147], v[164:167]
    ds_read_b64_tr_b16 v[48:49], v3 offset:8192
    v_mul_f32 v30, v128, v132
    v_mfma_f32_16x16x32_bf16 v[180:183], v[56:59], a[132:135], v[180:183]
    buffer_load_dwordx4 v16, s[16:19], s33 offen offset:1024 lds
    v_mfma_f32_16x16x32_bf16 v[180:183], v[60:63], a[148:151], v[180:183]
    ds_read_b64_tr_b16 v[50:51], v3 offset:8704
    v_rcp_f32 v32, v32
    v_mfma_f32_16x16x32_bf16 v[196:199], v[56:59], a[136:139], v[196:199]
    v_rcp_f32 v33, v33
    v_mfma_f32_16x16x32_bf16 v[196:199], v[60:63], a[152:155], v[196:199]
    ds_read_b64_tr_b16 v[52:53], v3 offset:12288
    v_mul_f32 v34, v34, v32
    v_mfma_f32_16x16x32_bf16 v[212:215], v[56:59], a[140:143], v[212:215]
    buffer_load_dwordx4 v15, s[16:19], s34 offen offset:2048 lds
    v_mfma_f32_16x16x32_bf16 v[212:215], v[60:63], a[156:159], v[212:215]
    ds_read_b64_tr_b16 v[54:55], v3 offset:12800
    s_waitcnt lgkmcnt(4)
    v_mfma_f32_16x16x32_bf16 v[168:171], v[40:43], a[128:131], v[168:171]
    v_mul_f32 v35, v35, v33
    v_cvt_pk_bf16_f32 v231, v34, v35
    v_mfma_f32_16x16x32_bf16 v[168:171], v[44:47], a[144:147], v[168:171]
    v_add_u32 v2, 4294885376, v2
    ds_read_b64_tr_b16 v[56:57], v2 offset:0
    v_mfma_f32_16x16x32_bf16 v[184:187], v[40:43], a[132:135], v[184:187]
    buffer_store_dwordx4 v[228:231], v1, s[24:27], s47 offen offset:1024 sc1
    v_mfma_f32_16x16x32_bf16 v[184:187], v[44:47], a[148:151], v[184:187]
    ds_read_b64_tr_b16 v[58:59], v2 offset:512
    v_add_u32 v15, 589824, v15
    v_mfma_f32_16x16x32_bf16 v[200:203], v[40:43], a[136:139], v[200:203]
    v_exp_f32 v28, v28
    v_mfma_f32_16x16x32_bf16 v[200:203], v[44:47], a[152:155], v[200:203]
    ds_read_b64_tr_b16 v[60:61], v2 offset:4096
    v_mul_f32 v31, v129, v133
    v_mfma_f32_16x16x32_bf16 v[216:219], v[40:43], a[140:143], v[216:219]
    v_exp_f32 v29, v29
    v_mfma_f32_16x16x32_bf16 v[216:219], v[44:47], a[156:159], v[216:219]
    ds_read_b64_tr_b16 v[62:63], v2 offset:4608
    s_waitcnt lgkmcnt(4)
    v_mfma_f32_16x16x32_bf16 v[172:175], v[48:51], a[128:131], v[172:175]
    buffer_load_dwordx4 v16, s[16:19], s35 offen offset:3072 lds
    v_mfma_f32_16x16x32_bf16 v[172:175], v[52:55], a[144:147], v[172:175]
    ds_read_b64_tr_b16 v[40:41], v2 offset:8192
    v_add_f32 v28, 1.0, v28
    v_mfma_f32_16x16x32_bf16 v[188:191], v[48:51], a[132:135], v[188:191]
    v_add_f32 v29, 1.0, v29
    v_mul_f32 v32, v26, v130
    v_mfma_f32_16x16x32_bf16 v[188:191], v[52:55], a[148:151], v[188:191]
    ds_read_b64_tr_b16 v[42:43], v2 offset:8704
    v_mul_f32 v33, v26, v131
    v_mfma_f32_16x16x32_bf16 v[204:207], v[48:51], a[136:139], v[204:207]
    v_add_u32 v16, 589824, v16
    v_mul_f32 v34, v130, v134
    v_mfma_f32_16x16x32_bf16 v[204:207], v[52:55], a[152:155], v[204:207]
    ds_read_b64_tr_b16 v[44:45], v2 offset:12288
    v_mul_f32 v35, v131, v135
    v_mfma_f32_16x16x32_bf16 v[220:223], v[48:51], a[140:143], v[220:223]
    v_rcp_f32 v28, v28
    v_mfma_f32_16x16x32_bf16 v[220:223], v[52:55], a[156:159], v[220:223]
    ds_read_b64_tr_b16 v[46:47], v2 offset:12800
    s_waitcnt lgkmcnt(4)
    v_mfma_f32_16x16x32_bf16 v[160:163], v[56:59], a[160:163], v[160:163]
    s_waitcnt vmcnt(31)
    s_barrier
    v_mul_f32 v30, v30, v28
    v_mfma_f32_16x16x32_bf16 v[160:163], v[60:63], a[176:179], v[160:163]
    s_add_u32 m0, s38, 98304
    v_add_u32 v3, 4294885376, v3
    ds_read_b64_tr_b16 v[48:49], v3 offset:0
    v_mfma_f32_16x16x32_bf16 v[176:179], v[56:59], a[164:167], v[176:179]
    v_rcp_f32 v29, v29
    v_mfma_f32_16x16x32_bf16 v[176:179], v[60:63], a[180:183], v[176:179]
    ds_read_b64_tr_b16 v[50:51], v3 offset:512
    v_mul_f32 v31, v31, v29
    v_mfma_f32_16x16x32_bf16 v[192:195], v[56:59], a[168:171], v[192:195]
    buffer_load_dwordx4 v15, s[16:19], 0 offen offset:0 lds
    v_mfma_f32_16x16x32_bf16 v[192:195], v[60:63], a[184:187], v[192:195]
    ds_read_b64_tr_b16 v[52:53], v3 offset:4096
    v_cvt_pk_bf16_f32 v232, v30, v31
    v_mfma_f32_16x16x32_bf16 v[208:211], v[56:59], a[172:175], v[208:211]
    v_exp_f32 v32, v32
    v_mfma_f32_16x16x32_bf16 v[208:211], v[60:63], a[188:191], v[208:211]
    ds_read_b64_tr_b16 v[54:55], v3 offset:4608
    s_waitcnt lgkmcnt(4)
    v_mfma_f32_16x16x32_bf16 v[164:167], v[40:43], a[160:163], v[164:167]
    v_exp_f32 v33, v33
    v_mfma_f32_16x16x32_bf16 v[164:167], v[44:47], a[176:179], v[164:167]
    ds_read_b64_tr_b16 v[56:57], v3 offset:8192
    v_add_f32 v32, 1.0, v32
    v_mfma_f32_16x16x32_bf16 v[180:183], v[40:43], a[164:167], v[180:183]
    buffer_load_dwordx4 v16, s[16:19], s33 offen offset:1024 lds
    v_mfma_f32_16x16x32_bf16 v[180:183], v[44:47], a[180:183], v[180:183]
    ds_read_b64_tr_b16 v[58:59], v3 offset:8704
    v_add_f32 v33, 1.0, v33
    v_mfma_f32_16x16x32_bf16 v[196:199], v[40:43], a[168:171], v[196:199]
    v_rcp_f32 v32, v32
    v_mfma_f32_16x16x32_bf16 v[196:199], v[44:47], a[184:187], v[196:199]
    ds_read_b64_tr_b16 v[60:61], v3 offset:12288
    v_mul_f32 v34, v34, v32
    v_mfma_f32_16x16x32_bf16 v[212:215], v[40:43], a[172:175], v[212:215]
    buffer_load_dwordx4 v15, s[16:19], s34 offen offset:2048 lds
    v_mfma_f32_16x16x32_bf16 v[212:215], v[44:47], a[188:191], v[212:215]
    ds_read_b64_tr_b16 v[62:63], v3 offset:12800
    s_waitcnt lgkmcnt(4)
    v_mfma_f32_16x16x32_bf16 v[168:171], v[48:51], a[160:163], v[168:171]
    v_rcp_f32 v33, v33
    v_mfma_f32_16x16x32_bf16 v[168:171], v[52:55], a[176:179], v[168:171]
    v_add_u32 v2, 98304, v2
    ds_read_b64_tr_b16 v[40:41], v2 offset:0
    v_mfma_f32_16x16x32_bf16 v[184:187], v[48:51], a[164:167], v[184:187]
    v_mul_f32 v35, v35, v33
    v_cvt_pk_bf16_f32 v233, v34, v35
    v_mfma_f32_16x16x32_bf16 v[184:187], v[52:55], a[180:183], v[184:187]
    ds_read_b64_tr_b16 v[42:43], v2 offset:512
    v_add_u32 v15, 589824, v15
    v_mfma_f32_16x16x32_bf16 v[200:203], v[48:51], a[168:171], v[200:203]
    v_mul_f32 v28, v26, v136
    v_mul_f32 v29, v26, v137
    v_mfma_f32_16x16x32_bf16 v[200:203], v[52:55], a[184:187], v[200:203]
    ds_read_b64_tr_b16 v[44:45], v2 offset:4096
    v_mul_f32 v30, v136, v140
    v_mfma_f32_16x16x32_bf16 v[216:219], v[48:51], a[172:175], v[216:219]
    v_exp_f32 v28, v28
    v_mfma_f32_16x16x32_bf16 v[216:219], v[52:55], a[188:191], v[216:219]
    ds_read_b64_tr_b16 v[46:47], v2 offset:4608
    s_waitcnt lgkmcnt(4)
    v_mfma_f32_16x16x32_bf16 v[172:175], v[56:59], a[160:163], v[172:175]
    buffer_load_dwordx4 v16, s[16:19], s35 offen offset:3072 lds
    v_mfma_f32_16x16x32_bf16 v[172:175], v[60:63], a[176:179], v[172:175]
    ds_read_b64_tr_b16 v[48:49], v2 offset:8192
    v_mul_f32 v31, v137, v141
    v_mfma_f32_16x16x32_bf16 v[188:191], v[56:59], a[164:167], v[188:191]
    v_exp_f32 v29, v29
    v_mfma_f32_16x16x32_bf16 v[188:191], v[60:63], a[180:183], v[188:191]
    ds_read_b64_tr_b16 v[50:51], v2 offset:8704
    v_add_f32 v28, 1.0, v28
    v_mfma_f32_16x16x32_bf16 v[204:207], v[56:59], a[168:171], v[204:207]
    v_add_u32 v16, 589824, v16
    v_add_f32 v29, 1.0, v29
    v_mfma_f32_16x16x32_bf16 v[204:207], v[60:63], a[184:187], v[204:207]
    ds_read_b64_tr_b16 v[52:53], v2 offset:12288
    v_mul_f32 v32, v26, v138
    v_mfma_f32_16x16x32_bf16 v[220:223], v[56:59], a[172:175], v[220:223]
    v_rcp_f32 v28, v28
    v_mfma_f32_16x16x32_bf16 v[220:223], v[60:63], a[188:191], v[220:223]
    ds_read_b64_tr_b16 v[54:55], v2 offset:12800
    s_waitcnt lgkmcnt(4)
    v_mfma_f32_16x16x32_bf16 v[160:163], v[40:43], a[192:195], v[160:163]
    s_waitcnt vmcnt(31)
    s_barrier
    v_mul_f32 v30, v30, v28
    v_mfma_f32_16x16x32_bf16 v[160:163], v[44:47], a[208:211], v[160:163]
    s_add_u32 m0, s38, 16384
    v_add_u32 v3, 98304, v3
    ds_read_b64_tr_b16 v[56:57], v3 offset:0
    v_mfma_f32_16x16x32_bf16 v[176:179], v[40:43], a[196:199], v[176:179]
    v_rcp_f32 v29, v29
    v_mfma_f32_16x16x32_bf16 v[176:179], v[44:47], a[212:215], v[176:179]
    ds_read_b64_tr_b16 v[58:59], v3 offset:512
    v_mul_f32 v31, v31, v29
    v_mfma_f32_16x16x32_bf16 v[192:195], v[40:43], a[200:203], v[192:195]
    buffer_load_dwordx4 v15, s[16:19], 0 offen offset:0 lds
    v_mfma_f32_16x16x32_bf16 v[192:195], v[44:47], a[216:219], v[192:195]
    ds_read_b64_tr_b16 v[60:61], v3 offset:4096
    v_cvt_pk_bf16_f32 v234, v30, v31
    v_mfma_f32_16x16x32_bf16 v[208:211], v[40:43], a[204:207], v[208:211]
    v_mul_f32 v33, v26, v139
    v_mul_f32 v34, v138, v142
    v_mfma_f32_16x16x32_bf16 v[208:211], v[44:47], a[220:223], v[208:211]
    ds_read_b64_tr_b16 v[62:63], v3 offset:4608
    s_waitcnt lgkmcnt(4)
    v_mfma_f32_16x16x32_bf16 v[164:167], v[48:51], a[192:195], v[164:167]
    v_exp_f32 v32, v32
    v_mfma_f32_16x16x32_bf16 v[164:167], v[52:55], a[208:211], v[164:167]
    ds_read_b64_tr_b16 v[40:41], v3 offset:8192
    v_mul_f32 v35, v139, v143
    v_mfma_f32_16x16x32_bf16 v[180:183], v[48:51], a[196:199], v[180:183]
    buffer_load_dwordx4 v16, s[16:19], s33 offen offset:1024 lds
    v_mfma_f32_16x16x32_bf16 v[180:183], v[52:55], a[212:215], v[180:183]
    ds_read_b64_tr_b16 v[42:43], v3 offset:8704
    v_exp_f32 v33, v33
    v_mfma_f32_16x16x32_bf16 v[196:199], v[48:51], a[200:203], v[196:199]
    v_add_f32 v32, 1.0, v32
    v_add_f32 v33, 1.0, v33
    v_mfma_f32_16x16x32_bf16 v[196:199], v[52:55], a[216:219], v[196:199]
    ds_read_b64_tr_b16 v[44:45], v3 offset:12288
    v_mul_f32 v28, v27, v144
    v_mfma_f32_16x16x32_bf16 v[212:215], v[48:51], a[204:207], v[212:215]
    buffer_load_dwordx4 v15, s[16:19], s34 offen offset:2048 lds
    v_mfma_f32_16x16x32_bf16 v[212:215], v[52:55], a[220:223], v[212:215]
    ds_read_b64_tr_b16 v[46:47], v3 offset:12800
    v_mul_f32 v29, v27, v145
    s_waitcnt lgkmcnt(4)
    v_mfma_f32_16x16x32_bf16 v[168:171], v[56:59], a[192:195], v[168:171]
    v_rcp_f32 v32, v32
    v_mfma_f32_16x16x32_bf16 v[168:171], v[60:63], a[208:211], v[168:171]
    v_add_u32 v2, 4294885376, v2
    ds_read_b64_tr_b16 v[48:49], v2 offset:0
    v_mfma_f32_16x16x32_bf16 v[184:187], v[56:59], a[196:199], v[184:187]
    v_rcp_f32 v33, v33
    v_mfma_f32_16x16x32_bf16 v[184:187], v[60:63], a[212:215], v[184:187]
    ds_read_b64_tr_b16 v[50:51], v2 offset:512
    v_add_u32 v15, 589824, v15
    v_mfma_f32_16x16x32_bf16 v[200:203], v[56:59], a[200:203], v[200:203]
    v_mul_f32 v34, v34, v32
    v_mul_f32 v35, v35, v33
    v_mfma_f32_16x16x32_bf16 v[200:203], v[60:63], a[216:219], v[200:203]
    ds_read_b64_tr_b16 v[52:53], v2 offset:4096
    v_cvt_pk_bf16_f32 v235, v34, v35
    v_mfma_f32_16x16x32_bf16 v[216:219], v[56:59], a[204:207], v[216:219]
    buffer_store_dwordx4 v[232:235], v1, s[24:27], s47 offen offset:2048 sc1
    v_mfma_f32_16x16x32_bf16 v[216:219], v[60:63], a[220:223], v[216:219]
    ds_read_b64_tr_b16 v[54:55], v2 offset:4608
    s_waitcnt lgkmcnt(4)
    v_mfma_f32_16x16x32_bf16 v[172:175], v[40:43], a[192:195], v[172:175]
    buffer_load_dwordx4 v16, s[16:19], s35 offen offset:3072 lds
    v_mfma_f32_16x16x32_bf16 v[172:175], v[44:47], a[208:211], v[172:175]
    ds_read_b64_tr_b16 v[56:57], v2 offset:8192
    v_mul_f32 v30, v144, v148
    v_mfma_f32_16x16x32_bf16 v[188:191], v[40:43], a[196:199], v[188:191]
    v_exp_f32 v28, v28
    v_mfma_f32_16x16x32_bf16 v[188:191], v[44:47], a[212:215], v[188:191]
    ds_read_b64_tr_b16 v[58:59], v2 offset:8704
    v_mul_f32 v31, v145, v149
    v_mfma_f32_16x16x32_bf16 v[204:207], v[40:43], a[200:203], v[204:207]
    v_add_u32 v16, 589824, v16
    v_add_f32 v28, 1.0, v28
    v_mfma_f32_16x16x32_bf16 v[204:207], v[44:47], a[216:219], v[204:207]
    ds_read_b64_tr_b16 v[60:61], v2 offset:12288
    v_mul_f32 v32, v27, v146
    v_mfma_f32_16x16x32_bf16 v[220:223], v[40:43], a[204:207], v[220:223]
    v_exp_f32 v29, v29
    v_mfma_f32_16x16x32_bf16 v[220:223], v[44:47], a[220:223], v[220:223]
    ds_read_b64_tr_b16 v[62:63], v2 offset:12800
    s_waitcnt lgkmcnt(4)
    v_mfma_f32_16x16x32_bf16 v[160:163], v[48:51], a[224:227], v[160:163]
    s_waitcnt vmcnt(31)
    s_barrier
    v_add_f32 v29, 1.0, v29
    v_mfma_f32_16x16x32_bf16 v[160:163], v[52:55], a[240:243], v[160:163]
    s_add_u32 m0, s38, 114688
    v_add_u32 v3, 4294885376, v3
    ds_read_b64_tr_b16 v[40:41], v3 offset:0
    v_mfma_f32_16x16x32_bf16 v[176:179], v[48:51], a[228:231], v[176:179]
    v_rcp_f32 v28, v28
    v_mfma_f32_16x16x32_bf16 v[176:179], v[52:55], a[244:247], v[176:179]
    ds_read_b64_tr_b16 v[42:43], v3 offset:512
    v_mul_f32 v30, v30, v28
    v_mfma_f32_16x16x32_bf16 v[192:195], v[48:51], a[232:235], v[192:195]
    buffer_load_dwordx4 v15, s[16:19], 0 offen offset:0 lds
    v_mfma_f32_16x16x32_bf16 v[192:195], v[52:55], a[248:251], v[192:195]
    ds_read_b64_tr_b16 v[44:45], v3 offset:4096
    v_mul_f32 v33, v27, v147
    v_mfma_f32_16x16x32_bf16 v[208:211], v[48:51], a[236:239], v[208:211]
    v_rcp_f32 v29, v29
    v_mfma_f32_16x16x32_bf16 v[208:211], v[52:55], a[252:255], v[208:211]
    ds_read_b64_tr_b16 v[46:47], v3 offset:4608
    s_waitcnt lgkmcnt(4)
    v_mfma_f32_16x16x32_bf16 v[164:167], v[56:59], a[224:227], v[164:167]
    v_mul_f32 v31, v31, v29
    v_cvt_pk_bf16_f32 v236, v30, v31
    v_mfma_f32_16x16x32_bf16 v[164:167], v[60:63], a[240:243], v[164:167]
    ds_read_b64_tr_b16 v[48:49], v3 offset:8192
    v_mul_f32 v34, v146, v150
    v_mfma_f32_16x16x32_bf16 v[180:183], v[56:59], a[228:231], v[180:183]
    buffer_load_dwordx4 v16, s[16:19], s33 offen offset:1024 lds
    v_mfma_f32_16x16x32_bf16 v[180:183], v[60:63], a[244:247], v[180:183]
    ds_read_b64_tr_b16 v[50:51], v3 offset:8704
    v_mul_f32 v35, v147, v151
    v_mfma_f32_16x16x32_bf16 v[196:199], v[56:59], a[232:235], v[196:199]
    v_exp_f32 v32, v32
    v_mfma_f32_16x16x32_bf16 v[196:199], v[60:63], a[248:251], v[196:199]
    ds_read_b64_tr_b16 v[52:53], v3 offset:12288
    v_add_f32 v32, 1.0, v32
    v_mfma_f32_16x16x32_bf16 v[212:215], v[56:59], a[236:239], v[212:215]
    buffer_load_dwordx4 v15, s[16:19], s34 offen offset:2048 lds
    v_mfma_f32_16x16x32_bf16 v[212:215], v[60:63], a[252:255], v[212:215]
    ds_read_b64_tr_b16 v[54:55], v3 offset:12800
    s_waitcnt lgkmcnt(4)
    v_mfma_f32_16x16x32_bf16 v[168:171], v[40:43], a[224:227], v[168:171]
    v_exp_f32 v33, v33
    v_mfma_f32_16x16x32_bf16 v[168:171], v[44:47], a[240:243], v[168:171]
    v_add_u32 v2, 98304, v2
    ds_read_b64_tr_b16 v[56:57], v2 offset:0
    v_mfma_f32_16x16x32_bf16 v[184:187], v[40:43], a[228:231], v[184:187]
    v_add_f32 v33, 1.0, v33
    v_mul_f32 v28, v27, v152
    v_mfma_f32_16x16x32_bf16 v[184:187], v[44:47], a[244:247], v[184:187]
    ds_read_b64_tr_b16 v[58:59], v2 offset:512
    v_add_u32 v15, 589824, v15
    v_mfma_f32_16x16x32_bf16 v[200:203], v[40:43], a[232:235], v[200:203]
    v_rcp_f32 v32, v32
    v_mfma_f32_16x16x32_bf16 v[200:203], v[44:47], a[248:251], v[200:203]
    ds_read_b64_tr_b16 v[60:61], v2 offset:4096
    v_mul_f32 v34, v34, v32
    v_mfma_f32_16x16x32_bf16 v[216:219], v[40:43], a[236:239], v[216:219]
    v_rcp_f32 v33, v33
    v_mfma_f32_16x16x32_bf16 v[216:219], v[44:47], a[252:255], v[216:219]
    ds_read_b64_tr_b16 v[62:63], v2 offset:4608
    s_waitcnt lgkmcnt(4)
    v_mfma_f32_16x16x32_bf16 v[172:175], v[48:51], a[224:227], v[172:175]
    buffer_load_dwordx4 v16, s[16:19], s35 offen offset:3072 lds
    v_mfma_f32_16x16x32_bf16 v[172:175], v[52:55], a[240:243], v[172:175]
    ds_read_b64_tr_b16 v[40:41], v2 offset:8192
    v_mul_f32 v35, v35, v33
    v_mfma_f32_16x16x32_bf16 v[188:191], v[48:51], a[228:231], v[188:191]
    v_cvt_pk_bf16_f32 v237, v34, v35
    v_mul_f32 v29, v27, v153
    v_mfma_f32_16x16x32_bf16 v[188:191], v[52:55], a[244:247], v[188:191]
    ds_read_b64_tr_b16 v[42:43], v2 offset:8704
    v_mul_f32 v30, v152, v156
    v_mfma_f32_16x16x32_bf16 v[204:207], v[48:51], a[232:235], v[204:207]
    v_add_u32 v16, 589824, v16
    v_mul_f32 v31, v153, v157
    v_mfma_f32_16x16x32_bf16 v[204:207], v[52:55], a[248:251], v[204:207]
    ds_read_b64_tr_b16 v[44:45], v2 offset:12288
    v_mul_f32 v32, v27, v154
    v_mfma_f32_16x16x32_bf16 v[220:223], v[48:51], a[236:239], v[220:223]
    v_exp_f32 v28, v28
    v_mfma_f32_16x16x32_bf16 v[220:223], v[52:55], a[252:255], v[220:223]
    ds_read_b64_tr_b16 v[46:47], v2 offset:12800
    s_waitcnt lgkmcnt(4)
    v_mfma_f32_16x16x32_bf16 v[160:163], v[56:59], v[64:67], v[160:163]
    s_waitcnt vmcnt(31)
    s_barrier
    v_add_f32 v28, 1.0, v28
    v_mfma_f32_16x16x32_bf16 v[160:163], v[60:63], v[80:83], v[160:163]
    s_add_u32 m0, s38, 32768
    v_add_u32 v3, 98304, v3
    ds_read_b64_tr_b16 v[48:49], v3 offset:0
    v_mfma_f32_16x16x32_bf16 v[176:179], v[56:59], v[68:71], v[176:179]
    v_exp_f32 v29, v29
    v_mfma_f32_16x16x32_bf16 v[176:179], v[60:63], v[84:87], v[176:179]
    ds_read_b64_tr_b16 v[50:51], v3 offset:512
    v_add_f32 v29, 1.0, v29
    v_mfma_f32_16x16x32_bf16 v[192:195], v[56:59], v[72:75], v[192:195]
    buffer_load_dwordx4 v15, s[16:19], 0 offen offset:0 lds
    v_mfma_f32_16x16x32_bf16 v[192:195], v[60:63], v[88:91], v[192:195]
    ds_read_b64_tr_b16 v[52:53], v3 offset:4096
    v_rcp_f32 v28, v28
    v_mfma_f32_16x16x32_bf16 v[208:211], v[56:59], v[76:79], v[208:211]
    v_rcp_f32 v29, v29
    v_mfma_f32_16x16x32_bf16 v[208:211], v[60:63], v[92:95], v[208:211]
    ds_read_b64_tr_b16 v[54:55], v3 offset:4608
    s_waitcnt lgkmcnt(4)
    v_mfma_f32_16x16x32_bf16 v[164:167], v[40:43], v[64:67], v[164:167]
    buffer_load_dwordx4 v16, s[16:19], s33 offen offset:1024 lds
    v_mfma_f32_16x16x32_bf16 v[164:167], v[44:47], v[80:83], v[164:167]
    ds_read_b64_tr_b16 v[56:57], v3 offset:8192
    v_mul_f32 v30, v30, v28
    v_mfma_f32_16x16x32_bf16 v[180:183], v[40:43], v[68:71], v[180:183]
    v_mul_f32 v31, v31, v29
    v_cvt_pk_bf16_f32 v238, v30, v31
    v_mfma_f32_16x16x32_bf16 v[180:183], v[44:47], v[84:87], v[180:183]
    s_cmp_eq_u32 s8, 8
    s_cselect_b32 s13, s12, s9
    ds_read_b64_tr_b16 v[58:59], v3 offset:8704
    v_mfma_f32_16x16x32_bf16 v[196:199], v[40:43], v[72:75], v[196:199]
    v_mul_f32 v33, v27, v155
    v_mul_f32 v34, v154, v158
    v_mfma_f32_16x16x32_bf16 v[196:199], v[44:47], v[88:91], v[196:199]
    ds_read_b64_tr_b16 v[60:61], v3 offset:12288
    v_mul_f32 v35, v155, v159
    v_mfma_f32_16x16x32_bf16 v[212:215], v[40:43], v[76:79], v[212:215]
    v_exp_f32 v32, v32
    v_mfma_f32_16x16x32_bf16 v[212:215], v[44:47], v[92:95], v[212:215]
    ds_read_b64_tr_b16 v[62:63], v3 offset:12800
    s_waitcnt lgkmcnt(4)
    v_mfma_f32_16x16x32_bf16 v[168:171], v[48:51], v[64:67], v[168:171]
    buffer_load_dwordx4 v15, s[16:19], s34 offen offset:2048 lds
    v_add_f32 v32, 1.0, v32
    v_mfma_f32_16x16x32_bf16 v[168:171], v[52:55], v[80:83], v[168:171]
    v_add_u32 v2, 4294885376, v2
    ds_read_b64_tr_b16 v[40:41], v2 offset:0
    v_mfma_f32_16x16x32_bf16 v[184:187], v[48:51], v[68:71], v[184:187]
    v_exp_f32 v33, v33
    v_mfma_f32_16x16x32_bf16 v[184:187], v[52:55], v[84:87], v[184:187]
    ds_read_b64_tr_b16 v[42:43], v2 offset:512
    v_add_f32 v33, 1.0, v33
    v_mfma_f32_16x16x32_bf16 v[200:203], v[48:51], v[72:75], v[200:203]
    buffer_load_dwordx4 v16, s[16:19], s35 offen offset:3072 lds
    v_mfma_f32_16x16x32_bf16 v[200:203], v[52:55], v[88:91], v[200:203]
    ds_read_b64_tr_b16 v[44:45], v2 offset:4096
    v_rcp_f32 v32, v32
    v_mfma_f32_16x16x32_bf16 v[216:219], v[48:51], v[76:79], v[216:219]
    v_rcp_f32 v33, v33
    v_mfma_f32_16x16x32_bf16 v[216:219], v[52:55], v[92:95], v[216:219]
    ds_read_b64_tr_b16 v[46:47], v2 offset:4608
    s_waitcnt lgkmcnt(4)
    v_mfma_f32_16x16x32_bf16 v[172:175], v[56:59], v[64:67], v[172:175]
    s_add_u32 s13, s13, 128
    v_mul_f32 v34, v34, v32
    v_mul_f32 v35, v35, v33
    v_mfma_f32_16x16x32_bf16 v[172:175], v[60:63], v[80:83], v[172:175]
    ds_read_b64_tr_b16 v[48:49], v2 offset:8192
    v_cvt_pk_bf16_f32 v239, v34, v35
    v_mfma_f32_16x16x32_bf16 v[188:191], v[56:59], v[68:71], v[188:191]
    v_add_u32 v15, s13, v15
    v_mfma_f32_16x16x32_bf16 v[188:191], v[60:63], v[84:87], v[188:191]
    ds_read_b64_tr_b16 v[50:51], v2 offset:8704
    v_mfma_f32_16x16x32_bf16 v[204:207], v[56:59], v[72:75], v[204:207]
    buffer_store_dwordx4 v[236:239], v1, s[24:27], s47 offen offset:3072 sc1
    v_mfma_f32_16x16x32_bf16 v[204:207], v[60:63], v[88:91], v[204:207]
    s_add_u32 s47, s47, 4096
    ds_read_b64_tr_b16 v[52:53], v2 offset:12288
    v_add_u32 v16, s13, v16
    v_mfma_f32_16x16x32_bf16 v[220:223], v[56:59], v[76:79], v[220:223]
    v_mfma_f32_16x16x32_bf16 v[220:223], v[60:63], v[92:95], v[220:223]
    ds_read_b64_tr_b16 v[54:55], v2 offset:12800
    s_waitcnt lgkmcnt(4)
    v_mfma_f32_16x16x32_bf16 v[96:99], v[40:43], a[0:3], 0
    s_waitcnt vmcnt(32)
    s_barrier
    v_mfma_f32_16x16x32_bf16 v[96:99], v[44:47], a[16:19], v[96:99]
    s_add_u32 m0, s38, 131072
    v_add_u32 v3, 4294885376, v3
    ds_read_b64_tr_b16 v[56:57], v3 offset:0
    v_mfma_f32_16x16x32_bf16 v[112:115], v[40:43], a[4:7], 0
    v_mfma_f32_16x16x32_bf16 v[112:115], v[44:47], a[20:23], v[112:115]
    ds_read_b64_tr_b16 v[58:59], v3 offset:512
    v_mfma_f32_16x16x32_bf16 v[128:131], v[40:43], a[8:11], 0
    buffer_load_dwordx4 v15, s[16:19], 0 offen offset:0 lds
    v_mfma_f32_16x16x32_bf16 v[128:131], v[44:47], a[24:27], v[128:131]
    ds_read_b64_tr_b16 v[60:61], v3 offset:4096
    s_mov_b32 s60, 10240
    buffer_load_dword v38, v39, s[4:7], s60 offen sc0 sc1
    v_mfma_f32_16x16x32_bf16 v[144:147], v[40:43], a[12:15], 0
    v_mfma_f32_16x16x32_bf16 v[144:147], v[44:47], a[28:31], v[144:147]
    ds_read_b64_tr_b16 v[62:63], v3 offset:4608
    s_waitcnt lgkmcnt(4)
    v_mfma_f32_16x16x32_bf16 v[100:103], v[48:51], a[0:3], 0
    v_mul_f32 v28, v24, v160
    v_mul_f32 v29, v24, v161
    v_mfma_f32_16x16x32_bf16 v[100:103], v[52:55], a[16:19], v[100:103]
    ds_read_b64_tr_b16 v[40:41], v3 offset:8192
    v_mul_f32 v30, v160, v164
    v_mfma_f32_16x16x32_bf16 v[116:119], v[48:51], a[4:7], 0
    buffer_load_dwordx4 v16, s[16:19], s33 offen offset:1024 lds
    v_mfma_f32_16x16x32_bf16 v[116:119], v[52:55], a[20:23], v[116:119]
    ds_read_b64_tr_b16 v[42:43], v3 offset:8704
    v_mul_f32 v31, v161, v165
    v_mfma_f32_16x16x32_bf16 v[132:135], v[48:51], a[8:11], 0
    v_exp_f32 v28, v28
    v_mfma_f32_16x16x32_bf16 v[132:135], v[52:55], a[24:27], v[132:135]
    ds_read_b64_tr_b16 v[44:45], v3 offset:12288
    v_add_f32 v28, 1.0, v28
    v_mfma_f32_16x16x32_bf16 v[148:151], v[48:51], a[12:15], 0
    buffer_load_dwordx4 v15, s[16:19], s34 offen offset:2048 lds
    v_mfma_f32_16x16x32_bf16 v[148:151], v[52:55], a[28:31], v[148:151]
    ds_read_b64_tr_b16 v[46:47], v3 offset:12800
    s_waitcnt lgkmcnt(4)
    v_mfma_f32_16x16x32_bf16 v[104:107], v[56:59], a[0:3], 0
    v_exp_f32 v29, v29
    v_mfma_f32_16x16x32_bf16 v[104:107], v[60:63], a[16:19], v[104:107]
    v_add_u32 v2, 98304, v2
    ds_read_b64_tr_b16 v[48:49], v2 offset:0
    v_mfma_f32_16x16x32_bf16 v[120:123], v[56:59], a[4:7], 0
    v_add_f32 v29, 1.0, v29
    v_mul_f32 v32, v24, v162
    v_mfma_f32_16x16x32_bf16 v[120:123], v[60:63], a[20:23], v[120:123]
    ds_read_b64_tr_b16 v[50:51], v2 offset:512
    v_add_u32 v15, 589824, v15
    v_mfma_f32_16x16x32_bf16 v[136:139], v[56:59], a[8:11], 0
    v_rcp_f32 v28, v28
    v_mfma_f32_16x16x32_bf16 v[136:139], v[60:63], a[24:27], v[136:139]
    ds_read_b64_tr_b16 v[52:53], v2 offset:4096
    v_mul_f32 v30, v30, v28
    v_mfma_f32_16x16x32_bf16 v[152:155], v[56:59], a[12:15], 0
    v_rcp_f32 v29, v29
    v_mfma_f32_16x16x32_bf16 v[152:155], v[60:63], a[28:31], v[152:155]
    ds_read_b64_tr_b16 v[54:55], v2 offset:4608
    s_waitcnt lgkmcnt(4)
    v_mfma_f32_16x16x32_bf16 v[108:111], v[40:43], a[0:3], 0
    buffer_load_dwordx4 v16, s[16:19], s35 offen offset:3072 lds
    v_mul_f32 v31, v31, v29
    v_mfma_f32_16x16x32_bf16 v[108:111], v[44:47], a[16:19], v[108:111]
    ds_read_b64_tr_b16 v[56:57], v2 offset:8192
    v_cvt_pk_bf16_f32 v240, v30, v31
    v_mfma_f32_16x16x32_bf16 v[124:127], v[40:43], a[4:7], 0
    v_mul_f32 v33, v24, v163
    v_mul_f32 v34, v162, v166
    v_mfma_f32_16x16x32_bf16 v[124:127], v[44:47], a[20:23], v[124:127]
    ds_read_b64_tr_b16 v[58:59], v2 offset:8704
    v_mul_f32 v35, v163, v167
    v_mfma_f32_16x16x32_bf16 v[140:143], v[40:43], a[8:11], 0
    v_add_u32 v16, 589824, v16
    v_mul_f32 v28, v24, v168
    v_mfma_f32_16x16x32_bf16 v[140:143], v[44:47], a[24:27], v[140:143]
    ds_read_b64_tr_b16 v[60:61], v2 offset:12288
    v_mul_f32 v29, v24, v169
    v_mfma_f32_16x16x32_bf16 v[156:159], v[40:43], a[12:15], 0
    v_exp_f32 v32, v32
    v_mfma_f32_16x16x32_bf16 v[156:159], v[44:47], a[28:31], v[156:159]
    ds_read_b64_tr_b16 v[62:63], v2 offset:12800
    s_waitcnt lgkmcnt(4)
    v_mfma_f32_16x16x32_bf16 v[96:99], v[48:51], a[32:35], v[96:99]
    s_waitcnt vmcnt(32)
    s_barrier
    v_add_f32 v32, 1.0, v32
    v_mfma_f32_16x16x32_bf16 v[96:99], v[52:55], a[48:51], v[96:99]
    s_add_u32 m0, s38, 49152
    v_add_u32 v3, 98304, v3
    ds_read_b64_tr_b16 v[40:41], v3 offset:0
    v_mfma_f32_16x16x32_bf16 v[112:115], v[48:51], a[36:39], v[112:115]
    v_exp_f32 v33, v33
    v_mfma_f32_16x16x32_bf16 v[112:115], v[52:55], a[52:55], v[112:115]
    ds_read_b64_tr_b16 v[42:43], v3 offset:512
    v_add_f32 v33, 1.0, v33
    v_mfma_f32_16x16x32_bf16 v[128:131], v[48:51], a[40:43], v[128:131]
    buffer_load_dwordx4 v15, s[16:19], 0 offen offset:0 lds
    v_mfma_f32_16x16x32_bf16 v[128:131], v[52:55], a[56:59], v[128:131]
    ds_read_b64_tr_b16 v[44:45], v3 offset:4096
    v_rcp_f32 v32, v32
    v_mfma_f32_16x16x32_bf16 v[144:147], v[48:51], a[44:47], v[144:147]
    v_rcp_f32 v33, v33
    v_mfma_f32_16x16x32_bf16 v[144:147], v[52:55], a[60:63], v[144:147]
    ds_read_b64_tr_b16 v[46:47], v3 offset:4608
    s_waitcnt lgkmcnt(4)
    v_mfma_f32_16x16x32_bf16 v[100:103], v[56:59], a[32:35], v[100:103]
    v_mul_f32 v34, v34, v32
    v_mul_f32 v35, v35, v33
    v_mfma_f32_16x16x32_bf16 v[100:103], v[60:63], a[48:51], v[100:103]
    ds_read_b64_tr_b16 v[48:49], v3 offset:8192
    v_cvt_pk_bf16_f32 v241, v34, v35
    v_mfma_f32_16x16x32_bf16 v[116:119], v[56:59], a[36:39], v[116:119]
    buffer_load_dwordx4 v16, s[16:19], s33 offen offset:1024 lds
    v_mfma_f32_16x16x32_bf16 v[116:119], v[60:63], a[52:55], v[116:119]
    ds_read_b64_tr_b16 v[50:51], v3 offset:8704
    v_exp_f32 v28, v28
    v_mfma_f32_16x16x32_bf16 v[132:135], v[56:59], a[40:43], v[132:135]
    v_exp_f32 v29, v29
    v_mfma_f32_16x16x32_bf16 v[132:135], v[60:63], a[56:59], v[132:135]
    ds_read_b64_tr_b16 v[52:53], v3 offset:12288
    v_mul_f32 v30, v168, v172
    v_mfma_f32_16x16x32_bf16 v[148:151], v[56:59], a[44:47], v[148:151]
    buffer_load_dwordx4 v15, s[16:19], s34 offen offset:2048 lds
    v_mfma_f32_16x16x32_bf16 v[148:151], v[60:63], a[60:63], v[148:151]
    ds_read_b64_tr_b16 v[54:55], v3 offset:12800
    s_waitcnt lgkmcnt(4)
    v_mfma_f32_16x16x32_bf16 v[104:107], v[40:43], a[32:35], v[104:107]
    v_mul_f32 v31, v169, v173
    v_add_f32 v28, 1.0, v28
    v_mfma_f32_16x16x32_bf16 v[104:107], v[44:47], a[48:51], v[104:107]
    v_add_u32 v2, 4294885376, v2
    ds_read_b64_tr_b16 v[56:57], v2 offset:0
    v_mfma_f32_16x16x32_bf16 v[120:123], v[40:43], a[36:39], v[120:123]
    v_add_f32 v29, 1.0, v29
    v_mul_f32 v32, v24, v170
    v_mfma_f32_16x16x32_bf16 v[120:123], v[44:47], a[52:55], v[120:123]
    ds_read_b64_tr_b16 v[58:59], v2 offset:512
    v_add_u32 v15, 589824, v15
    v_mfma_f32_16x16x32_bf16 v[136:139], v[40:43], a[40:43], v[136:139]
    v_rcp_f32 v28, v28
    v_mfma_f32_16x16x32_bf16 v[136:139], v[44:47], a[56:59], v[136:139]
    ds_read_b64_tr_b16 v[60:61], v2 offset:4096
    v_mul_f32 v30, v30, v28
    v_mfma_f32_16x16x32_bf16 v[152:155], v[40:43], a[44:47], v[152:155]
    v_rcp_f32 v29, v29
    v_mfma_f32_16x16x32_bf16 v[152:155], v[44:47], a[60:63], v[152:155]
    ds_read_b64_tr_b16 v[62:63], v2 offset:4608
    s_waitcnt lgkmcnt(4)
    v_mfma_f32_16x16x32_bf16 v[108:111], v[48:51], a[32:35], v[108:111]
    buffer_load_dwordx4 v16, s[16:19], s35 offen offset:3072 lds
    v_mfma_f32_16x16x32_bf16 v[108:111], v[52:55], a[48:51], v[108:111]
    ds_read_b64_tr_b16 v[40:41], v2 offset:8192
    v_mul_f32 v31, v31, v29
    v_cvt_pk_bf16_f32 v242, v30, v31
    v_mfma_f32_16x16x32_bf16 v[124:127], v[48:51], a[36:39], v[124:127]
    v_mul_f32 v33, v24, v171
    v_mul_f32 v34, v170, v174
    v_mfma_f32_16x16x32_bf16 v[124:127], v[52:55], a[52:55], v[124:127]
    ds_read_b64_tr_b16 v[42:43], v2 offset:8704
    v_mul_f32 v35, v171, v175
    v_mfma_f32_16x16x32_bf16 v[140:143], v[48:51], a[40:43], v[140:143]
    v_add_u32 v16, 589824, v16
    v_mul_f32 v28, v25, v176
    v_mfma_f32_16x16x32_bf16 v[140:143], v[52:55], a[56:59], v[140:143]
    ds_read_b64_tr_b16 v[44:45], v2 offset:12288
    v_mul_f32 v29, v25, v177
    v_mfma_f32_16x16x32_bf16 v[156:159], v[48:51], a[44:47], v[156:159]
    v_exp_f32 v32, v32
    v_mfma_f32_16x16x32_bf16 v[156:159], v[52:55], a[60:63], v[156:159]
    ds_read_b64_tr_b16 v[46:47], v2 offset:12800
    s_waitcnt lgkmcnt(4)
    v_mfma_f32_16x16x32_bf16 v[96:99], v[56:59], a[64:67], v[96:99]
    s_waitcnt vmcnt(32)
    s_barrier
    v_add_f32 v32, 1.0, v32
    v_mfma_f32_16x16x32_bf16 v[96:99], v[60:63], a[80:83], v[96:99]
    s_add_u32 m0, s38, 147456
    v_add_u32 v3, 4294885376, v3
    ds_read_b64_tr_b16 v[48:49], v3 offset:0
    v_mfma_f32_16x16x32_bf16 v[112:115], v[56:59], a[68:71], v[112:115]
    v_exp_f32 v33, v33
    v_mfma_f32_16x16x32_bf16 v[112:115], v[60:63], a[84:87], v[112:115]
    ds_read_b64_tr_b16 v[50:51], v3 offset:512
    v_add_f32 v33, 1.0, v33
    v_mfma_f32_16x16x32_bf16 v[128:131], v[56:59], a[72:75], v[128:131]
    buffer_load_dwordx4 v15, s[16:19], 0 offen offset:0 lds
    v_mfma_f32_16x16x32_bf16 v[128:131], v[60:63], a[88:91], v[128:131]
    ds_read_b64_tr_b16 v[52:53], v3 offset:4096
    v_rcp_f32 v32, v32
    v_mfma_f32_16x16x32_bf16 v[144:147], v[56:59], a[76:79], v[144:147]
    v_rcp_f32 v33, v33
    v_mfma_f32_16x16x32_bf16 v[144:147], v[60:63], a[92:95], v[144:147]
    ds_read_b64_tr_b16 v[54:55], v3 offset:4608
    s_waitcnt lgkmcnt(4)
    v_mfma_f32_16x16x32_bf16 v[100:103], v[40:43], a[64:67], v[100:103]
    v_mul_f32 v34, v34, v32
    v_mul_f32 v35, v35, v33
    v_mfma_f32_16x16x32_bf16 v[100:103], v[44:47], a[80:83], v[100:103]
    ds_read_b64_tr_b16 v[56:57], v3 offset:8192
    v_cvt_pk_bf16_f32 v243, v34, v35
    v_mfma_f32_16x16x32_bf16 v[116:119], v[40:43], a[68:71], v[116:119]
    buffer_load_dwordx4 v16, s[16:19], s33 offen offset:1024 lds
    v_mfma_f32_16x16x32_bf16 v[116:119], v[44:47], a[84:87], v[116:119]
    ds_read_b64_tr_b16 v[58:59], v3 offset:8704
    v_exp_f32 v28, v28
    v_mfma_f32_16x16x32_bf16 v[132:135], v[40:43], a[72:75], v[132:135]
    buffer_store_dwordx4 v[240:243], v1, s[24:27], s47 offen offset:0 sc1
    v_mfma_f32_16x16x32_bf16 v[132:135], v[44:47], a[88:91], v[132:135]
    ds_read_b64_tr_b16 v[60:61], v3 offset:12288
    v_mul_f32 v30, v176, v180
    v_mfma_f32_16x16x32_bf16 v[148:151], v[40:43], a[76:79], v[148:151]
    buffer_load_dwordx4 v15, s[16:19], s34 offen offset:2048 lds
    v_mfma_f32_16x16x32_bf16 v[148:151], v[44:47], a[92:95], v[148:151]
    ds_read_b64_tr_b16 v[62:63], v3 offset:12800
    s_waitcnt lgkmcnt(4)
    v_mfma_f32_16x16x32_bf16 v[104:107], v[48:51], a[64:67], v[104:107]
    v_exp_f32 v29, v29
    v_mfma_f32_16x16x32_bf16 v[104:107], v[52:55], a[80:83], v[104:107]
    ds_read_b64_tr_b16 v[40:41], v2 offset:16384
    v_mul_f32 v31, v177, v181
    v_mfma_f32_16x16x32_bf16 v[120:123], v[48:51], a[68:71], v[120:123]
    v_add_f32 v28, 1.0, v28
    v_add_f32 v29, 1.0, v29
    v_mfma_f32_16x16x32_bf16 v[120:123], v[52:55], a[84:87], v[120:123]
    ds_read_b64_tr_b16 v[42:43], v2 offset:16896
    v_add_u32 v15, 589824, v15
    v_mfma_f32_16x16x32_bf16 v[136:139], v[48:51], a[72:75], v[136:139]
    v_rcp_f32 v28, v28
    v_mfma_f32_16x16x32_bf16 v[136:139], v[52:55], a[88:91], v[136:139]
    ds_read_b64_tr_b16 v[44:45], v2 offset:20480
    v_mul_f32 v30, v30, v28
    v_mfma_f32_16x16x32_bf16 v[152:155], v[48:51], a[76:79], v[152:155]
    v_rcp_f32 v29, v29
    v_mfma_f32_16x16x32_bf16 v[152:155], v[52:55], a[92:95], v[152:155]
    ds_read_b64_tr_b16 v[46:47], v2 offset:20992
    s_waitcnt lgkmcnt(4)
    v_mfma_f32_16x16x32_bf16 v[108:111], v[56:59], a[64:67], v[108:111]
    buffer_load_dwordx4 v16, s[16:19], s35 offen offset:3072 lds
    v_mfma_f32_16x16x32_bf16 v[108:111], v[60:63], a[80:83], v[108:111]
    ds_read_b64_tr_b16 v[48:49], v2 offset:24576
    v_mul_f32 v31, v31, v29
    v_mfma_f32_16x16x32_bf16 v[124:127], v[56:59], a[68:71], v[124:127]
    v_cvt_pk_bf16_f32 v244, v30, v31
    v_mul_f32 v32, v25, v178
    v_mfma_f32_16x16x32_bf16 v[124:127], v[60:63], a[84:87], v[124:127]
    ds_read_b64_tr_b16 v[50:51], v2 offset:25088
    v_mul_f32 v33, v25, v179
    v_mfma_f32_16x16x32_bf16 v[140:143], v[56:59], a[72:75], v[140:143]
    v_add_u32 v16, 589824, v16
    v_mul_f32 v34, v178, v182
    v_mfma_f32_16x16x32_bf16 v[140:143], v[60:63], a[88:91], v[140:143]
    ds_read_b64_tr_b16 v[52:53], v2 offset:28672
    v_mul_f32 v35, v179, v183
    v_mfma_f32_16x16x32_bf16 v[156:159], v[56:59], a[76:79], v[156:159]
    v_exp_f32 v32, v32
    v_mfma_f32_16x16x32_bf16 v[156:159], v[60:63], a[92:95], v[156:159]
    ds_read_b64_tr_b16 v[54:55], v2 offset:29184
    s_waitcnt lgkmcnt(4)
    v_mfma_f32_16x16x32_bf16 v[96:99], v[40:43], a[96:99], v[96:99]
    s_waitcnt vmcnt(32)
    s_barrier
    v_add_f32 v32, 1.0, v32
    v_mfma_f32_16x16x32_bf16 v[96:99], v[44:47], a[112:115], v[96:99]
    s_add_u32 m0, s38, 65536
    ds_read_b64_tr_b16 v[56:57], v3 offset:16384
    v_mul_f32 v28, v25, v184
    v_mfma_f32_16x16x32_bf16 v[112:115], v[40:43], a[100:103], v[112:115]
    v_exp_f32 v33, v33
    v_mfma_f32_16x16x32_bf16 v[112:115], v[44:47], a[116:119], v[112:115]
    ds_read_b64_tr_b16 v[58:59], v3 offset:16896
    v_add_f32 v33, 1.0, v33
    v_mfma_f32_16x16x32_bf16 v[128:131], v[40:43], a[104:107], v[128:131]
    buffer_load_dwordx4 v15, s[16:19], 0 offen offset:0 lds
    v_mfma_f32_16x16x32_bf16 v[128:131], v[44:47], a[120:123], v[128:131]
    ds_read_b64_tr_b16 v[60:61], v3 offset:20480
    v_mul_f32 v29, v25, v185
    v_mfma_f32_16x16x32_bf16 v[144:147], v[40:43], a[108:111], v[144:147]
    v_rcp_f32 v32, v32
    v_mfma_f32_16x16x32_bf16 v[144:147], v[44:47], a[124:127], v[144:147]
    ds_read_b64_tr_b16 v[62:63], v3 offset:20992
    s_waitcnt lgkmcnt(4)
    v_mfma_f32_16x16x32_bf16 v[100:103], v[48:51], a[96:99], v[100:103]
    v_rcp_f32 v33, v33
    v_mfma_f32_16x16x32_bf16 v[100:103], v[52:55], a[112:115], v[100:103]
    ds_read_b64_tr_b16 v[40:41], v3 offset:24576
    v_mul_f32 v34, v34, v32
    v_mfma_f32_16x16x32_bf16 v[116:119], v[48:51], a[100:103], v[116:119]
    buffer_load_dwordx4 v16, s[16:19], s33 offen offset:1024 lds
    v_mfma_f32_16x16x32_bf16 v[116:119], v[52:55], a[116:119], v[116:119]
    ds_read_b64_tr_b16 v[42:43], v3 offset:25088
    v_mul_f32 v35, v35, v33
    v_mfma_f32_16x16x32_bf16 v[132:135], v[48:51], a[104:107], v[132:135]
    v_cvt_pk_bf16_f32 v245, v34, v35
    v_mul_f32 v30, v184, v188
    v_mfma_f32_16x16x32_bf16 v[132:135], v[52:55], a[120:123], v[132:135]
    ds_read_b64_tr_b16 v[44:45], v3 offset:28672
    v_mul_f32 v31, v185, v189
    v_mfma_f32_16x16x32_bf16 v[148:151], v[48:51], a[108:111], v[148:151]
    buffer_load_dwordx4 v15, s[16:19], s34 offen offset:2048 lds
    v_mfma_f32_16x16x32_bf16 v[148:151], v[52:55], a[124:127], v[148:151]
    ds_read_b64_tr_b16 v[46:47], v3 offset:29184
    s_waitcnt lgkmcnt(4)
    v_mfma_f32_16x16x32_bf16 v[104:107], v[56:59], a[96:99], v[104:107]
    v_exp_f32 v28, v28
    v_mfma_f32_16x16x32_bf16 v[104:107], v[60:63], a[112:115], v[104:107]
    v_add_u32 v2, 4294901760, v2
    ds_read_b64_tr_b16 v[48:49], v2 offset:0
    v_mfma_f32_16x16x32_bf16 v[120:123], v[56:59], a[100:103], v[120:123]
    v_exp_f32 v29, v29
    v_mfma_f32_16x16x32_bf16 v[120:123], v[60:63], a[116:119], v[120:123]
    ds_read_b64_tr_b16 v[50:51], v2 offset:512
    v_add_u32 v15, 589824, v15
    v_mfma_f32_16x16x32_bf16 v[136:139], v[56:59], a[104:107], v[136:139]
    v_add_f32 v28, 1.0, v28
    v_add_f32 v29, 1.0, v29
    v_mfma_f32_16x16x32_bf16 v[136:139], v[60:63], a[120:123], v[136:139]
    ds_read_b64_tr_b16 v[52:53], v2 offset:4096
    v_mul_f32 v32, v25, v186
    v_mfma_f32_16x16x32_bf16 v[152:155], v[56:59], a[108:111], v[152:155]
    v_rcp_f32 v28, v28
    v_mfma_f32_16x16x32_bf16 v[152:155], v[60:63], a[124:127], v[152:155]
    ds_read_b64_tr_b16 v[54:55], v2 offset:4608
    s_waitcnt lgkmcnt(4)
    v_mfma_f32_16x16x32_bf16 v[108:111], v[40:43], a[96:99], v[108:111]
    buffer_load_dwordx4 v16, s[16:19], s35 offen offset:3072 lds
    v_mfma_f32_16x16x32_bf16 v[108:111], v[44:47], a[112:115], v[108:111]
    ds_read_b64_tr_b16 v[56:57], v2 offset:8192
    v_mul_f32 v30, v30, v28
    v_mfma_f32_16x16x32_bf16 v[124:127], v[40:43], a[100:103], v[124:127]
    v_rcp_f32 v29, v29
    v_mfma_f32_16x16x32_bf16 v[124:127], v[44:47], a[116:119], v[124:127]
    ds_read_b64_tr_b16 v[58:59], v2 offset:8704
    v_mul_f32 v31, v31, v29
    v_mfma_f32_16x16x32_bf16 v[140:143], v[40:43], a[104:107], v[140:143]
    v_add_u32 v16, 589824, v16
    v_cvt_pk_bf16_f32 v246, v30, v31
    v_mfma_f32_16x16x32_bf16 v[140:143], v[44:47], a[120:123], v[140:143]
    ds_read_b64_tr_b16 v[60:61], v2 offset:12288
    v_mul_f32 v33, v25, v187
    v_mfma_f32_16x16x32_bf16 v[156:159], v[40:43], a[108:111], v[156:159]
    v_exp_f32 v32, v32
    v_mfma_f32_16x16x32_bf16 v[156:159], v[44:47], a[124:127], v[156:159]
    ds_read_b64_tr_b16 v[62:63], v2 offset:12800
    s_waitcnt lgkmcnt(4)
    v_mfma_f32_16x16x32_bf16 v[96:99], v[48:51], a[128:131], v[96:99]
    s_waitcnt vmcnt(32)
    s_barrier
    v_mul_f32 v34, v186, v190
    v_mfma_f32_16x16x32_bf16 v[96:99], v[52:55], a[144:147], v[96:99]
    v_add_u32 v3, 4294901760, v3
    ds_read_b64_tr_b16 v[40:41], v3 offset:0
    v_mfma_f32_16x16x32_bf16 v[112:115], v[48:51], a[132:135], v[112:115]
    v_exp_f32 v33, v33
    v_mfma_f32_16x16x32_bf16 v[112:115], v[52:55], a[148:151], v[112:115]
    ds_read_b64_tr_b16 v[42:43], v3 offset:512
    v_mul_f32 v35, v187, v191
    v_mfma_f32_16x16x32_bf16 v[128:131], v[48:51], a[136:139], v[128:131]
    v_add_f32 v32, 1.0, v32
    v_add_f32 v33, 1.0, v33
    v_mfma_f32_16x16x32_bf16 v[128:131], v[52:55], a[152:155], v[128:131]
    ds_read_b64_tr_b16 v[44:45], v3 offset:4096
    v_mul_f32 v28, v26, v192
    v_mfma_f32_16x16x32_bf16 v[144:147], v[48:51], a[140:143], v[144:147]
    v_rcp_f32 v32, v32
    v_mfma_f32_16x16x32_bf16 v[144:147], v[52:55], a[156:159], v[144:147]
    ds_read_b64_tr_b16 v[46:47], v3 offset:4608
    s_waitcnt lgkmcnt(4)
    v_mfma_f32_16x16x32_bf16 v[100:103], v[56:59], a[128:131], v[100:103]
    v_rcp_f32 v33, v33
    v_mfma_f32_16x16x32_bf16 v[100:103], v[60:63], a[144:147], v[100:103]
    ds_read_b64_tr_b16 v[48:49], v3 offset:8192
    v_mul_f32 v34, v34, v32
    v_mfma_f32_16x16x32_bf16 v[116:119], v[56:59], a[132:135], v[116:119]
    v_mul_f32 v35, v35, v33
    v_cvt_pk_bf16_f32 v247, v34, v35
    v_mfma_f32_16x16x32_bf16 v[116:119], v[60:63], a[148:151], v[116:119]
    ds_read_b64_tr_b16 v[50:51], v3 offset:8704
    v_mul_f32 v29, v26, v193
    v_mfma_f32_16x16x32_bf16 v[132:135], v[56:59], a[136:139], v[132:135]
    buffer_store_dwordx4 v[244:247], v1, s[24:27], s47 offen offset:1024 sc1
    v_mfma_f32_16x16x32_bf16 v[132:135], v[60:63], a[152:155], v[132:135]
    ds_read_b64_tr_b16 v[52:53], v3 offset:12288
    v_mul_f32 v30, v192, v196
    v_mfma_f32_16x16x32_bf16 v[148:151], v[56:59], a[140:143], v[148:151]
    v_exp_f32 v28, v28
    v_mfma_f32_16x16x32_bf16 v[148:151], v[60:63], a[156:159], v[148:151]
    ds_read_b64_tr_b16 v[54:55], v3 offset:12800
    s_waitcnt lgkmcnt(4)
    v_mfma_f32_16x16x32_bf16 v[104:107], v[40:43], a[128:131], v[104:107]
    v_exp_f32 v29, v29
    v_mfma_f32_16x16x32_bf16 v[104:107], v[44:47], a[144:147], v[104:107]
    v_add_u32 v2, 98304, v2
    ds_read_b64_tr_b16 v[56:57], v2 offset:0
    v_mfma_f32_16x16x32_bf16 v[120:123], v[40:43], a[132:135], v[120:123]
    v_mul_f32 v31, v193, v197
    v_add_f32 v28, 1.0, v28
    v_mfma_f32_16x16x32_bf16 v[120:123], v[44:47], a[148:151], v[120:123]
    ds_read_b64_tr_b16 v[58:59], v2 offset:512
    v_add_f32 v29, 1.0, v29
    v_mfma_f32_16x16x32_bf16 v[136:139], v[40:43], a[136:139], v[136:139]
    v_rcp_f32 v28, v28
    v_mfma_f32_16x16x32_bf16 v[136:139], v[44:47], a[152:155], v[136:139]
    ds_read_b64_tr_b16 v[60:61], v2 offset:4096
    v_mul_f32 v30, v30, v28
    v_mfma_f32_16x16x32_bf16 v[152:155], v[40:43], a[140:143], v[152:155]
    v_rcp_f32 v29, v29
    v_mfma_f32_16x16x32_bf16 v[152:155], v[44:47], a[156:159], v[152:155]
    ds_read_b64_tr_b16 v[62:63], v2 offset:4608
    s_waitcnt lgkmcnt(4)
    v_mfma_f32_16x16x32_bf16 v[108:111], v[48:51], a[128:131], v[108:111]
    v_mul_f32 v31, v31, v29
    v_cvt_pk_bf16_f32 v248, v30, v31
    v_mfma_f32_16x16x32_bf16 v[108:111], v[52:55], a[144:147], v[108:111]
    ds_read_b64_tr_b16 v[40:41], v2 offset:8192
    v_mul_f32 v32, v26, v194
    v_mfma_f32_16x16x32_bf16 v[124:127], v[48:51], a[132:135], v[124:127]
    v_mul_f32 v33, v26, v195
    v_mul_f32 v34, v194, v198
    v_mfma_f32_16x16x32_bf16 v[124:127], v[52:55], a[148:151], v[124:127]
    ds_read_b64_tr_b16 v[42:43], v2 offset:8704
    v_mul_f32 v35, v195, v199
    v_mfma_f32_16x16x32_bf16 v[140:143], v[48:51], a[136:139], v[140:143]
    v_exp_f32 v32, v32
    v_mfma_f32_16x16x32_bf16 v[140:143], v[52:55], a[152:155], v[140:143]
    ds_read_b64_tr_b16 v[44:45], v2 offset:12288
    v_add_f32 v32, 1.0, v32
    v_mfma_f32_16x16x32_bf16 v[156:159], v[48:51], a[140:143], v[156:159]
    v_exp_f32 v33, v33
    v_mfma_f32_16x16x32_bf16 v[156:159], v[52:55], a[156:159], v[156:159]
    ds_read_b64_tr_b16 v[46:47], v2 offset:12800
    s_waitcnt lgkmcnt(4)
    v_mfma_f32_16x16x32_bf16 v[96:99], v[56:59], a[160:163], v[96:99]
    s_waitcnt vmcnt(28)
    s_barrier
    v_add_f32 v33, 1.0, v33
    v_mfma_f32_16x16x32_bf16 v[96:99], v[60:63], a[176:179], v[96:99]
    s_add_u32 m0, s38, 0
    v_add_u32 v3, 98304, v3
    ds_read_b64_tr_b16 v[48:49], v3 offset:0
    v_mfma_f32_16x16x32_bf16 v[112:115], v[56:59], a[164:167], v[112:115]
    buffer_load_dwordx4 v15, s[16:19], 0 offen offset:0 lds
    v_mfma_f32_16x16x32_bf16 v[112:115], v[60:63], a[180:183], v[112:115]
    ds_read_b64_tr_b16 v[50:51], v3 offset:512
    v_mul_f32 v28, v26, v200
    v_mfma_f32_16x16x32_bf16 v[128:131], v[56:59], a[168:171], v[128:131]
    buffer_load_dwordx4 v16, s[16:19], s33 offen offset:1024 lds
    v_mfma_f32_16x16x32_bf16 v[128:131], v[60:63], a[184:187], v[128:131]
    ds_read_b64_tr_b16 v[52:53], v3 offset:4096
    v_mul_f32 v29, v26, v201
    v_mfma_f32_16x16x32_bf16 v[144:147], v[56:59], a[172:175], v[144:147]
    buffer_load_dwordx4 v15, s[16:19], s34 offen offset:2048 lds
    v_mfma_f32_16x16x32_bf16 v[144:147], v[60:63], a[188:191], v[144:147]
    ds_read_b64_tr_b16 v[54:55], v3 offset:4608
    s_waitcnt lgkmcnt(4)
    v_mfma_f32_16x16x32_bf16 v[100:103], v[40:43], a[160:163], v[100:103]
    buffer_load_dwordx4 v16, s[16:19], s35 offen offset:3072 lds
    v_mfma_f32_16x16x32_bf16 v[100:103], v[44:47], a[176:179], v[100:103]
    s_lshl_b32 s15, s31, 5
    ds_read_b64_tr_b16 v[56:57], v3 offset:8192
    v_add_u32 v15, 589824, v15
    v_mfma_f32_16x16x32_bf16 v[116:119], v[40:43], a[164:167], v[116:119]
    v_add_u32 v16, 589824, v16
    v_mul_f32 v30, v200, v204
    v_mfma_f32_16x16x32_bf16 v[116:119], v[44:47], a[180:183], v[116:119]
    ds_read_b64_tr_b16 v[58:59], v3 offset:8704
    v_lshrrev_b32 v22, 2, v0
    v_mfma_f32_16x16x32_bf16 v[132:135], v[40:43], a[168:171], v[132:135]
    v_add_u32 v22, s15, v22
    v_mul_f32 v31, v201, v205
    v_mfma_f32_16x16x32_bf16 v[132:135], v[44:47], a[184:187], v[132:135]
    ds_read_b64_tr_b16 v[60:61], v3 offset:12288
    v_mul_u32_u24 v22, 9216, v22
    v_mfma_f32_16x16x32_bf16 v[148:151], v[40:43], a[172:175], v[148:151]
    v_lshrrev_b32 v37, 4, v0
    v_mfma_f32_16x16x32_bf16 v[148:151], v[44:47], a[188:191], v[148:151]
    ds_read_b64_tr_b16 v[62:63], v3 offset:12800
    s_waitcnt lgkmcnt(4)
    v_mfma_f32_16x16x32_bf16 v[104:107], v[48:51], a[160:163], v[104:107]
    v_and_b32 v37, 2, v37
    v_and_b32 v23, 3, v0
    v_mfma_f32_16x16x32_bf16 v[104:107], v[52:55], a[176:179], v[104:107]
    s_lshl_b32 s15, s30, 6
    v_add_u32 v2, 4294885376, v2
    ds_read_b64_tr_b16 v[40:41], v2 offset:0
    v_mfma_f32_16x16x32_bf16 v[120:123], v[48:51], a[164:167], v[120:123]
    v_xor_b32 v37, v37, v23
    v_rcp_f32 v32, v32
    v_mfma_f32_16x16x32_bf16 v[120:123], v[52:55], a[180:183], v[120:123]
    ds_read_b64_tr_b16 v[42:43], v2 offset:512
    v_lshl_add_u32 v22, v37, 4, v22
    v_mfma_f32_16x16x32_bf16 v[136:139], v[48:51], a[168:171], v[136:139]
    s_add_u32 s15, s15, s53
    v_rcp_f32 v33, v33
    v_mfma_f32_16x16x32_bf16 v[136:139], v[52:55], a[184:187], v[136:139]
    s_add_u32 s15, s15, 512
    ds_read_b64_tr_b16 v[44:45], v2 offset:4096
    v_mul_f32 v34, v34, v32
    v_mfma_f32_16x16x32_bf16 v[152:155], v[48:51], a[172:175], v[152:155]
    s_sub_u32 s13, 8, s8
    v_mul_f32 v35, v35, v33
    v_cvt_pk_bf16_f32 v249, v34, v35
    v_mfma_f32_16x16x32_bf16 v[152:155], v[52:55], a[188:191], v[152:155]
    s_mul_i32 s13, s13, 589824
    ds_read_b64_tr_b16 v[46:47], v2 offset:4608
    s_waitcnt lgkmcnt(4)
    v_mfma_f32_16x16x32_bf16 v[108:111], v[56:59], a[160:163], v[108:111]
    s_add_u32 s15, s15, s13
    v_exp_f32 v28, v28
    v_mfma_f32_16x16x32_bf16 v[108:111], v[60:63], a[176:179], v[108:111]
    ds_read_b64_tr_b16 v[48:49], v2 offset:8192
    v_add_u32 v22, s15, v22
    v_mfma_f32_16x16x32_bf16 v[124:127], v[56:59], a[164:167], v[124:127]
    s_add_u32 m0, s39, 90112
    v_exp_f32 v29, v29
    v_mfma_f32_16x16x32_bf16 v[124:127], v[60:63], a[180:183], v[124:127]
    ds_read_b64_tr_b16 v[50:51], v2 offset:8704
    v_add_f32 v28, 1.0, v28
    v_mfma_f32_16x16x32_bf16 v[140:143], v[56:59], a[168:171], v[140:143]
    buffer_load_dwordx4 v22, s[16:19], 0 offen offset:0 lds
    v_mfma_f32_16x16x32_bf16 v[140:143], v[60:63], a[184:187], v[140:143]
    ds_read_b64_tr_b16 v[52:53], v2 offset:12288
    buffer_load_dwordx4 v22, s[16:19], s36 offen offset:1024 lds
    v_mfma_f32_16x16x32_bf16 v[156:159], v[56:59], a[172:175], v[156:159]
    v_add_u32 v22, 589824, v22
    v_add_f32 v29, 1.0, v29
    v_mul_f32 v32, v26, v202
    v_mfma_f32_16x16x32_bf16 v[156:159], v[60:63], a[188:191], v[156:159]
    ds_read_b64_tr_b16 v[54:55], v2 offset:12800
    v_mul_f32 v33, v26, v203
    s_waitcnt lgkmcnt(4)
    v_mfma_f32_16x16x32_bf16 v[96:99], v[40:43], a[192:195], v[96:99]
    s_waitcnt vmcnt(30)
    s_barrier
    v_rcp_f32 v28, v28
    v_mfma_f32_16x16x32_bf16 v[96:99], v[44:47], a[208:211], v[96:99]
    s_add_u32 m0, s39, 98304
    v_add_u32 v3, 4294885376, v3
    ds_read_b64_tr_b16 v[56:57], v3 offset:0
    v_mfma_f32_16x16x32_bf16 v[112:115], v[40:43], a[196:199], v[112:115]
    v_rcp_f32 v29, v29
    v_mfma_f32_16x16x32_bf16 v[112:115], v[44:47], a[212:215], v[112:115]
    ds_read_b64_tr_b16 v[58:59], v3 offset:512
    v_mul_f32 v30, v30, v28
    v_mfma_f32_16x16x32_bf16 v[128:131], v[40:43], a[200:203], v[128:131]
    v_mul_f32 v31, v31, v29
    v_cvt_pk_bf16_f32 v250, v30, v31
    v_mfma_f32_16x16x32_bf16 v[128:131], v[44:47], a[216:219], v[128:131]
    ds_read_b64_tr_b16 v[60:61], v3 offset:4096
    v_mul_f32 v34, v202, v206
    v_mfma_f32_16x16x32_bf16 v[144:147], v[40:43], a[204:207], v[144:147]
    v_exp_f32 v32, v32
    v_mfma_f32_16x16x32_bf16 v[144:147], v[44:47], a[220:223], v[144:147]
    ds_read_b64_tr_b16 v[62:63], v3 offset:4608
    s_waitcnt lgkmcnt(4)
    v_mfma_f32_16x16x32_bf16 v[100:103], v[48:51], a[192:195], v[100:103]
    buffer_load_dwordx4 v22, s[16:19], 0 offen offset:0 lds
    v_mfma_f32_16x16x32_bf16 v[100:103], v[52:55], a[208:211], v[100:103]
    ds_read_b64_tr_b16 v[40:41], v3 offset:8192
    v_mul_f32 v35, v203, v207
    v_mfma_f32_16x16x32_bf16 v[116:119], v[48:51], a[196:199], v[116:119]
    v_exp_f32 v33, v33
    v_mfma_f32_16x16x32_bf16 v[116:119], v[52:55], a[212:215], v[116:119]
    ds_read_b64_tr_b16 v[42:43], v3 offset:8704
    v_add_f32 v32, 1.0, v32
    v_mfma_f32_16x16x32_bf16 v[132:135], v[48:51], a[200:203], v[132:135]
    v_add_f32 v33, 1.0, v33
    v_mul_f32 v28, v27, v208
    v_mfma_f32_16x16x32_bf16 v[132:135], v[52:55], a[216:219], v[132:135]
    ds_read_b64_tr_b16 v[44:45], v3 offset:12288
    v_mul_f32 v29, v27, v209
    v_mfma_f32_16x16x32_bf16 v[148:151], v[48:51], a[204:207], v[148:151]
    v_rcp_f32 v32, v32
    v_mfma_f32_16x16x32_bf16 v[148:151], v[52:55], a[220:223], v[148:151]
    ds_read_b64_tr_b16 v[46:47], v3 offset:12800
    s_waitcnt lgkmcnt(4)
    v_mfma_f32_16x16x32_bf16 v[104:107], v[56:59], a[192:195], v[104:107]
    buffer_load_dwordx4 v22, s[16:19], s36 offen offset:1024 lds
    v_mfma_f32_16x16x32_bf16 v[104:107], v[60:63], a[208:211], v[104:107]
    v_add_u32 v2, 98304, v2
    ds_read_b64_tr_b16 v[48:49], v2 offset:0
    v_mfma_f32_16x16x32_bf16 v[120:123], v[56:59], a[196:199], v[120:123]
    v_rcp_f32 v33, v33
    v_mfma_f32_16x16x32_bf16 v[120:123], v[60:63], a[212:215], v[120:123]
    ds_read_b64_tr_b16 v[50:51], v2 offset:512
    v_mul_f32 v34, v34, v32
    v_mfma_f32_16x16x32_bf16 v[136:139], v[56:59], a[200:203], v[136:139]
    v_mul_f32 v35, v35, v33
    v_cvt_pk_bf16_f32 v251, v34, v35
    v_mfma_f32_16x16x32_bf16 v[136:139], v[60:63], a[216:219], v[136:139]
    ds_read_b64_tr_b16 v[52:53], v2 offset:4096
    v_mul_f32 v30, v208, v212
    v_mfma_f32_16x16x32_bf16 v[152:155], v[56:59], a[204:207], v[152:155]
    buffer_store_dwordx4 v[248:251], v1, s[24:27], s47 offen offset:2048 sc1
    v_mfma_f32_16x16x32_bf16 v[152:155], v[60:63], a[220:223], v[152:155]
    ds_read_b64_tr_b16 v[54:55], v2 offset:4608
    s_waitcnt lgkmcnt(4)
    v_mfma_f32_16x16x32_bf16 v[108:111], v[40:43], a[192:195], v[108:111]
    v_exp_f32 v28, v28
    v_mfma_f32_16x16x32_bf16 v[108:111], v[44:47], a[208:211], v[108:111]
    ds_read_b64_tr_b16 v[56:57], v2 offset:8192
    v_add_u32 v22, 589824, v22
    v_mfma_f32_16x16x32_bf16 v[124:127], v[40:43], a[196:199], v[124:127]
    v_exp_f32 v29, v29
    v_mfma_f32_16x16x32_bf16 v[124:127], v[44:47], a[212:215], v[124:127]
    ds_read_b64_tr_b16 v[58:59], v2 offset:8704
    v_mul_f32 v31, v209, v213
    v_mfma_f32_16x16x32_bf16 v[140:143], v[40:43], a[200:203], v[140:143]
    v_add_f32 v28, 1.0, v28
    v_add_f32 v29, 1.0, v29
    v_mfma_f32_16x16x32_bf16 v[140:143], v[44:47], a[216:219], v[140:143]
    ds_read_b64_tr_b16 v[60:61], v2 offset:12288
    v_mul_f32 v32, v27, v210
    v_mfma_f32_16x16x32_bf16 v[156:159], v[40:43], a[204:207], v[156:159]
    v_rcp_f32 v28, v28
    v_mfma_f32_16x16x32_bf16 v[156:159], v[44:47], a[220:223], v[156:159]
    ds_read_b64_tr_b16 v[62:63], v2 offset:12800
    s_waitcnt lgkmcnt(4)
    v_mfma_f32_16x16x32_bf16 v[96:99], v[48:51], a[224:227], v[96:99]
    s_waitcnt vmcnt(29)
    s_barrier
    v_mul_f32 v30, v30, v28
    v_mfma_f32_16x16x32_bf16 v[96:99], v[52:55], a[240:243], v[96:99]
    s_add_u32 m0, s38, 16384
    v_add_u32 v3, 98304, v3
    ds_read_b64_tr_b16 v[40:41], v3 offset:0
    v_mfma_f32_16x16x32_bf16 v[112:115], v[48:51], a[228:231], v[112:115]
    v_rcp_f32 v29, v29
    v_mfma_f32_16x16x32_bf16 v[112:115], v[52:55], a[244:247], v[112:115]
    ds_read_b64_tr_b16 v[42:43], v3 offset:512
    v_mul_f32 v31, v31, v29
    v_mfma_f32_16x16x32_bf16 v[128:131], v[48:51], a[232:235], v[128:131]
    buffer_load_dwordx4 v15, s[16:19], 0 offen offset:0 lds
    v_mfma_f32_16x16x32_bf16 v[128:131], v[52:55], a[248:251], v[128:131]
    ds_read_b64_tr_b16 v[44:45], v3 offset:4096
    v_cvt_pk_bf16_f32 v252, v30, v31
    v_mfma_f32_16x16x32_bf16 v[144:147], v[48:51], a[236:239], v[144:147]
    buffer_load_dwordx4 v16, s[16:19], s33 offen offset:1024 lds
    v_mfma_f32_16x16x32_bf16 v[144:147], v[52:55], a[252:255], v[144:147]
    ds_read_b64_tr_b16 v[46:47], v3 offset:4608
    s_waitcnt lgkmcnt(4)
    v_mfma_f32_16x16x32_bf16 v[100:103], v[56:59], a[224:227], v[100:103]
    v_mul_f32 v33, v27, v211
    v_mul_f32 v34, v210, v214
    v_mfma_f32_16x16x32_bf16 v[100:103], v[60:63], a[240:243], v[100:103]
    ds_read_b64_tr_b16 v[48:49], v3 offset:8192
    v_mul_f32 v35, v211, v215
    v_mfma_f32_16x16x32_bf16 v[116:119], v[56:59], a[228:231], v[116:119]
    buffer_load_dwordx4 v15, s[16:19], s34 offen offset:2048 lds
    v_mfma_f32_16x16x32_bf16 v[116:119], v[60:63], a[244:247], v[116:119]
    ds_read_b64_tr_b16 v[50:51], v3 offset:8704
    v_mul_f32 v28, v27, v216
    v_mfma_f32_16x16x32_bf16 v[132:135], v[56:59], a[232:235], v[132:135]
    v_exp_f32 v32, v32
    v_mfma_f32_16x16x32_bf16 v[132:135], v[60:63], a[248:251], v[132:135]
    ds_read_b64_tr_b16 v[52:53], v3 offset:12288
    v_add_u32 v15, 589824, v15
    v_mfma_f32_16x16x32_bf16 v[148:151], v[56:59], a[236:239], v[148:151]
    v_exp_f32 v33, v33
    v_mfma_f32_16x16x32_bf16 v[148:151], v[60:63], a[252:255], v[148:151]
    ds_read_b64_tr_b16 v[54:55], v3 offset:12800
    s_waitcnt lgkmcnt(4)
    v_mfma_f32_16x16x32_bf16 v[104:107], v[40:43], a[224:227], v[104:107]
    buffer_load_dwordx4 v16, s[16:19], s35 offen offset:3072 lds
    v_mfma_f32_16x16x32_bf16 v[104:107], v[44:47], a[240:243], v[104:107]
    v_add_u32 v2, 4294885376, v2
    ds_read_b64_tr_b16 v[56:57], v2 offset:0
    v_mfma_f32_16x16x32_bf16 v[120:123], v[40:43], a[228:231], v[120:123]
    v_add_u32 v16, 589824, v16
    v_add_f32 v32, 1.0, v32
    v_mfma_f32_16x16x32_bf16 v[120:123], v[44:47], a[244:247], v[120:123]
    ds_read_b64_tr_b16 v[58:59], v2 offset:512
    v_add_f32 v33, 1.0, v33
    v_mfma_f32_16x16x32_bf16 v[136:139], v[40:43], a[232:235], v[136:139]
    s_add_u32 m0, s39, 106496
    v_rcp_f32 v32, v32
    v_mfma_f32_16x16x32_bf16 v[136:139], v[44:47], a[248:251], v[136:139]
    ds_read_b64_tr_b16 v[60:61], v2 offset:4096
    v_mul_f32 v34, v34, v32
    v_mfma_f32_16x16x32_bf16 v[152:155], v[40:43], a[236:239], v[152:155]
    v_rcp_f32 v33, v33
    v_mfma_f32_16x16x32_bf16 v[152:155], v[44:47], a[252:255], v[152:155]
    ds_read_b64_tr_b16 v[62:63], v2 offset:4608
    s_waitcnt lgkmcnt(4)
    v_mfma_f32_16x16x32_bf16 v[108:111], v[48:51], a[224:227], v[108:111]
    buffer_load_dwordx4 v22, s[16:19], 0 offen offset:0 lds
    v_mfma_f32_16x16x32_bf16 v[108:111], v[52:55], a[240:243], v[108:111]
    ds_read_b64_tr_b16 v[40:41], v2 offset:8192
    v_mul_f32 v35, v35, v33
    v_mfma_f32_16x16x32_bf16 v[124:127], v[48:51], a[228:231], v[124:127]
    buffer_load_dwordx4 v22, s[16:19], s36 offen offset:1024 lds
    v_mfma_f32_16x16x32_bf16 v[124:127], v[52:55], a[244:247], v[124:127]
    ds_read_b64_tr_b16 v[42:43], v2 offset:8704
    v_cvt_pk_bf16_f32 v253, v34, v35
    v_mfma_f32_16x16x32_bf16 v[140:143], v[48:51], a[232:235], v[140:143]
    v_mul_f32 v29, v27, v217
    v_mul_f32 v30, v216, v220
    v_mfma_f32_16x16x32_bf16 v[140:143], v[52:55], a[248:251], v[140:143]
    ds_read_b64_tr_b16 v[44:45], v2 offset:12288
    v_add_u32 v22, 589824, v22
    v_mfma_f32_16x16x32_bf16 v[156:159], v[48:51], a[236:239], v[156:159]
    v_exp_f32 v28, v28
    v_mfma_f32_16x16x32_bf16 v[156:159], v[52:55], a[252:255], v[156:159]
    ds_read_b64_tr_b16 v[46:47], v2 offset:12800
    v_mul_f32 v31, v217, v221
    s_waitcnt lgkmcnt(4)
    v_mfma_f32_16x16x32_bf16 v[96:99], v[56:59], v[64:67], v[96:99]
    s_waitcnt vmcnt(29)
    s_barrier
    v_exp_f32 v29, v29
    v_mfma_f32_16x16x32_bf16 v[96:99], v[60:63], v[80:83], v[96:99]
    s_add_u32 m0, s39, 114688
    v_add_u32 v3, 4294885376, v3
    ds_read_b64_tr_b16 v[48:49], v3 offset:0
    v_mfma_f32_16x16x32_bf16 v[112:115], v[56:59], v[68:71], v[112:115]
    v_add_f32 v28, 1.0, v28
    v_add_f32 v29, 1.0, v29
    v_mfma_f32_16x16x32_bf16 v[112:115], v[60:63], v[84:87], v[112:115]
    ds_read_b64_tr_b16 v[50:51], v3 offset:512
    v_mul_f32 v32, v27, v218
    v_mfma_f32_16x16x32_bf16 v[128:131], v[56:59], v[72:75], v[128:131]
    buffer_load_dwordx4 v22, s[16:19], 0 offen offset:0 lds
    v_mfma_f32_16x16x32_bf16 v[128:131], v[60:63], v[88:91], v[128:131]
    ds_read_b64_tr_b16 v[52:53], v3 offset:4096
    v_rcp_f32 v28, v28
    v_mfma_f32_16x16x32_bf16 v[144:147], v[56:59], v[76:79], v[144:147]
    v_rcp_f32 v29, v29
    v_mfma_f32_16x16x32_bf16 v[144:147], v[60:63], v[92:95], v[144:147]
    ds_read_b64_tr_b16 v[54:55], v3 offset:4608
    s_waitcnt lgkmcnt(4)
    v_mfma_f32_16x16x32_bf16 v[100:103], v[40:43], v[64:67], v[100:103]
    buffer_load_dwordx4 v22, s[16:19], s36 offen offset:1024 lds
    v_mfma_f32_16x16x32_bf16 v[100:103], v[44:47], v[80:83], v[100:103]
    ds_read_b64_tr_b16 v[56:57], v3 offset:8192
    v_mul_f32 v30, v30, v28
    v_mfma_f32_16x16x32_bf16 v[116:119], v[40:43], v[68:71], v[116:119]
    v_mul_f32 v31, v31, v29
    v_cvt_pk_bf16_f32 v254, v30, v31
    v_mfma_f32_16x16x32_bf16 v[116:119], v[44:47], v[84:87], v[116:119]
    ds_read_b64_tr_b16 v[58:59], v3 offset:8704
    v_mul_f32 v33, v27, v219
    v_mfma_f32_16x16x32_bf16 v[132:135], v[40:43], v[72:75], v[132:135]
    v_exp_f32 v32, v32
    v_mfma_f32_16x16x32_bf16 v[132:135], v[44:47], v[88:91], v[132:135]
    ds_read_b64_tr_b16 v[60:61], v3 offset:12288
    v_add_u32 v22, 589824, v22
    v_mfma_f32_16x16x32_bf16 v[148:151], v[40:43], v[76:79], v[148:151]
    v_exp_f32 v33, v33
    v_mfma_f32_16x16x32_bf16 v[148:151], v[44:47], v[92:95], v[148:151]
    ds_read_b64_tr_b16 v[62:63], v3 offset:12800
    s_waitcnt lgkmcnt(4)
    v_mfma_f32_16x16x32_bf16 v[104:107], v[48:51], v[64:67], v[104:107]
    s_add_u32 m0, s39, 122880
    v_mul_f32 v34, v218, v222
    v_mul_f32 v35, v219, v223
    v_mfma_f32_16x16x32_bf16 v[104:107], v[52:55], v[80:83], v[104:107]
    v_add_u32 v2, 98304, v2
    ds_read_b64_tr_b16 v[40:41], v2 offset:0
    v_mfma_f32_16x16x32_bf16 v[120:123], v[48:51], v[68:71], v[120:123]
    v_add_f32 v32, 1.0, v32
    v_add_f32 v33, 1.0, v33
    v_mfma_f32_16x16x32_bf16 v[120:123], v[52:55], v[84:87], v[120:123]
    ds_read_b64_tr_b16 v[42:43], v2 offset:512
    v_mfma_f32_16x16x32_bf16 v[136:139], v[48:51], v[72:75], v[136:139]
    buffer_load_dwordx4 v22, s[16:19], 0 offen offset:0 lds
    v_mfma_f32_16x16x32_bf16 v[136:139], v[52:55], v[88:91], v[136:139]
    ds_read_b64_tr_b16 v[44:45], v2 offset:4096
    v_rcp_f32 v32, v32
    v_mfma_f32_16x16x32_bf16 v[152:155], v[48:51], v[76:79], v[152:155]
    v_rcp_f32 v33, v33
    v_mfma_f32_16x16x32_bf16 v[152:155], v[52:55], v[92:95], v[152:155]
    ds_read_b64_tr_b16 v[46:47], v2 offset:4608
    s_waitcnt lgkmcnt(4)
    v_mfma_f32_16x16x32_bf16 v[108:111], v[56:59], v[64:67], v[108:111]
    buffer_load_dwordx4 v22, s[16:19], s36 offen offset:1024 lds
    v_mul_f32 v34, v34, v32
    v_mfma_f32_16x16x32_bf16 v[108:111], v[60:63], v[80:83], v[108:111]
    ds_read_b64_tr_b16 v[48:49], v2 offset:8192
    v_mul_f32 v35, v35, v33
    v_mfma_f32_16x16x32_bf16 v[124:127], v[56:59], v[68:71], v[124:127]
    v_cvt_pk_bf16_f32 v255, v34, v35
    v_mfma_f32_16x16x32_bf16 v[124:127], v[60:63], v[84:87], v[124:127]
    ds_read_b64_tr_b16 v[50:51], v2 offset:8704
    v_mfma_f32_16x16x32_bf16 v[140:143], v[56:59], v[72:75], v[140:143]
    v_add_u32 v22, 589824, v22
    v_mfma_f32_16x16x32_bf16 v[140:143], v[60:63], v[88:91], v[140:143]
    ds_read_b64_tr_b16 v[52:53], v2 offset:12288
    v_mfma_f32_16x16x32_bf16 v[156:159], v[56:59], v[76:79], v[156:159]
    buffer_store_dwordx4 v[252:255], v1, s[24:27], s47 offen offset:3072 sc1
    v_mfma_f32_16x16x32_bf16 v[156:159], v[60:63], v[92:95], v[156:159]
    s_add_u32 s47, s47, 4096
    ds_read_b64_tr_b16 v[54:55], v2 offset:12800
    s_waitcnt lgkmcnt(4)
    v_mfma_f32_16x16x32_bf16 v[160:163], v[40:43], a[0:3], 0
    s_waitcnt vmcnt(30)
    s_barrier
    v_mfma_f32_16x16x32_bf16 v[160:163], v[44:47], a[16:19], v[160:163]
    s_add_u32 m0, s38, 32768
    v_add_u32 v3, 98304, v3
    ds_read_b64_tr_b16 v[56:57], v3 offset:0
    v_mfma_f32_16x16x32_bf16 v[176:179], v[40:43], a[4:7], 0
    v_mfma_f32_16x16x32_bf16 v[176:179], v[44:47], a[20:23], v[176:179]
    ds_read_b64_tr_b16 v[58:59], v3 offset:512
    v_mfma_f32_16x16x32_bf16 v[192:195], v[40:43], a[8:11], 0
    buffer_load_dwordx4 v15, s[16:19], 0 offen offset:0 lds
    v_mfma_f32_16x16x32_bf16 v[192:195], v[44:47], a[24:27], v[192:195]
    ds_read_b64_tr_b16 v[60:61], v3 offset:4096
    s_mov_b32 s60, 18432
    buffer_load_dword v38, v39, s[4:7], s60 offen sc0 sc1
    v_mfma_f32_16x16x32_bf16 v[208:211], v[40:43], a[12:15], 0
    v_mfma_f32_16x16x32_bf16 v[208:211], v[44:47], a[28:31], v[208:211]
    ds_read_b64_tr_b16 v[62:63], v3 offset:4608
    s_waitcnt lgkmcnt(4)
    v_mfma_f32_16x16x32_bf16 v[164:167], v[48:51], a[0:3], 0
    v_mul_f32 v28, v24, v96
    v_mul_f32 v29, v24, v97
    v_mfma_f32_16x16x32_bf16 v[164:167], v[52:55], a[16:19], v[164:167]
    ds_read_b64_tr_b16 v[40:41], v3 offset:8192
    v_mul_f32 v30, v96, v100
    v_mfma_f32_16x16x32_bf16 v[180:183], v[48:51], a[4:7], 0
    buffer_load_dwordx4 v16, s[16:19], s33 offen offset:1024 lds
    v_mfma_f32_16x16x32_bf16 v[180:183], v[52:55], a[20:23], v[180:183]
    ds_read_b64_tr_b16 v[42:43], v3 offset:8704
    v_mul_f32 v31, v97, v101
    v_mfma_f32_16x16x32_bf16 v[196:199], v[48:51], a[8:11], 0
    v_exp_f32 v28, v28
    v_mfma_f32_16x16x32_bf16 v[196:199], v[52:55], a[24:27], v[196:199]
    ds_read_b64_tr_b16 v[44:45], v3 offset:12288
    v_add_f32 v28, 1.0, v28
    v_mfma_f32_16x16x32_bf16 v[212:215], v[48:51], a[12:15], 0
    buffer_load_dwordx4 v15, s[16:19], s34 offen offset:2048 lds
    v_mfma_f32_16x16x32_bf16 v[212:215], v[52:55], a[28:31], v[212:215]
    ds_read_b64_tr_b16 v[46:47], v3 offset:12800
    v_mul_f32 v32, v24, v98
    s_waitcnt lgkmcnt(4)
    v_mfma_f32_16x16x32_bf16 v[168:171], v[56:59], a[0:3], 0
    v_exp_f32 v29, v29
    v_mfma_f32_16x16x32_bf16 v[168:171], v[60:63], a[16:19], v[168:171]
    v_add_u32 v2, 4294885376, v2
    ds_read_b64_tr_b16 v[48:49], v2 offset:0
    v_add_f32 v29, 1.0, v29
    v_mfma_f32_16x16x32_bf16 v[184:187], v[56:59], a[4:7], 0
    v_rcp_f32 v28, v28
    v_mfma_f32_16x16x32_bf16 v[184:187], v[60:63], a[20:23], v[184:187]
    ds_read_b64_tr_b16 v[50:51], v2 offset:512
    v_add_u32 v15, 589824, v15
    v_mfma_f32_16x16x32_bf16 v[200:203], v[56:59], a[8:11], 0
    v_rcp_f32 v29, v29
    v_mfma_f32_16x16x32_bf16 v[200:203], v[60:63], a[24:27], v[200:203]
    ds_read_b64_tr_b16 v[52:53], v2 offset:4096
    v_mul_f32 v30, v30, v28
    v_mfma_f32_16x16x32_bf16 v[216:219], v[56:59], a[12:15], 0
    v_mul_f32 v31, v31, v29
    v_cvt_pk_bf16_f32 v96, v30, v31
    v_mfma_f32_16x16x32_bf16 v[216:219], v[60:63], a[28:31], v[216:219]
    ds_read_b64_tr_b16 v[54:55], v2 offset:4608
    s_waitcnt lgkmcnt(4)
    v_mfma_f32_16x16x32_bf16 v[172:175], v[40:43], a[0:3], 0
    buffer_load_dwordx4 v16, s[16:19], s35 offen offset:3072 lds
    v_mul_f32 v33, v24, v99
    v_mfma_f32_16x16x32_bf16 v[172:175], v[44:47], a[16:19], v[172:175]
    ds_read_b64_tr_b16 v[56:57], v2 offset:8192
    v_exp_f32 v32, v32
    v_mfma_f32_16x16x32_bf16 v[188:191], v[40:43], a[4:7], 0
    v_exp_f32 v33, v33
    v_mfma_f32_16x16x32_bf16 v[188:191], v[44:47], a[20:23], v[188:191]
    ds_read_b64_tr_b16 v[58:59], v2 offset:8704
    v_mul_f32 v34, v98, v102
    v_mfma_f32_16x16x32_bf16 v[204:207], v[40:43], a[8:11], 0
    v_add_u32 v16, 589824, v16
    v_mul_f32 v35, v99, v103
    v_mfma_f32_16x16x32_bf16 v[204:207], v[44:47], a[24:27], v[204:207]
    ds_read_b64_tr_b16 v[60:61], v2 offset:12288
    v_add_f32 v32, 1.0, v32
    v_mfma_f32_16x16x32_bf16 v[220:223], v[40:43], a[12:15], 0
    v_add_f32 v33, 1.0, v33
    v_mul_f32 v28, v24, v104
    v_mfma_f32_16x16x32_bf16 v[220:223], v[44:47], a[28:31], v[220:223]
    ds_read_b64_tr_b16 v[62:63], v2 offset:12800
    s_waitcnt lgkmcnt(4)
    v_mfma_f32_16x16x32_bf16 v[160:163], v[48:51], a[32:35], v[160:163]
    s_waitcnt vmcnt(30)
    s_barrier
    v_rcp_f32 v32, v32
    v_mfma_f32_16x16x32_bf16 v[160:163], v[52:55], a[48:51], v[160:163]
    s_add_u32 m0, s39, 131072
    v_add_u32 v3, 4294885376, v3
    ds_read_b64_tr_b16 v[40:41], v3 offset:0
    v_mul_f32 v34, v34, v32
    v_mfma_f32_16x16x32_bf16 v[176:179], v[48:51], a[36:39], v[176:179]
    v_rcp_f32 v33, v33
    v_mfma_f32_16x16x32_bf16 v[176:179], v[52:55], a[52:55], v[176:179]
    ds_read_b64_tr_b16 v[42:43], v3 offset:512
    v_mul_f32 v35, v35, v33
    v_mfma_f32_16x16x32_bf16 v[192:195], v[48:51], a[40:43], v[192:195]
    buffer_load_dwordx4 v22, s[16:19], 0 offen offset:0 lds
    v_mfma_f32_16x16x32_bf16 v[192:195], v[52:55], a[56:59], v[192:195]
    ds_read_b64_tr_b16 v[44:45], v3 offset:4096
    v_cvt_pk_bf16_f32 v97, v34, v35
    v_mul_f32 v29, v24, v105
    v_mfma_f32_16x16x32_bf16 v[208:211], v[48:51], a[44:47], v[208:211]
    v_exp_f32 v28, v28
    v_mfma_f32_16x16x32_bf16 v[208:211], v[52:55], a[60:63], v[208:211]
    ds_read_b64_tr_b16 v[46:47], v3 offset:4608
    s_waitcnt lgkmcnt(4)
    v_mfma_f32_16x16x32_bf16 v[164:167], v[56:59], a[32:35], v[164:167]
    buffer_load_dwordx4 v22, s[16:19], s36 offen offset:1024 lds
    v_mul_f32 v30, v104, v108
    v_mfma_f32_16x16x32_bf16 v[164:167], v[60:63], a[48:51], v[164:167]
    ds_read_b64_tr_b16 v[48:49], v3 offset:8192
    v_exp_f32 v29, v29
    v_mfma_f32_16x16x32_bf16 v[180:183], v[56:59], a[36:39], v[180:183]
    v_mul_f32 v31, v105, v109
    v_add_f32 v28, 1.0, v28
    v_mfma_f32_16x16x32_bf16 v[180:183], v[60:63], a[52:55], v[180:183]
    ds_read_b64_tr_b16 v[50:51], v3 offset:8704
    v_add_f32 v29, 1.0, v29
    v_mfma_f32_16x16x32_bf16 v[196:199], v[56:59], a[40:43], v[196:199]
    v_rcp_f32 v28, v28
    v_mfma_f32_16x16x32_bf16 v[196:199], v[60:63], a[56:59], v[196:199]
    ds_read_b64_tr_b16 v[52:53], v3 offset:12288
    v_add_u32 v22, 589824, v22
    v_mfma_f32_16x16x32_bf16 v[212:215], v[56:59], a[44:47], v[212:215]
    v_rcp_f32 v29, v29
    v_mfma_f32_16x16x32_bf16 v[212:215], v[60:63], a[60:63], v[212:215]
    ds_read_b64_tr_b16 v[54:55], v3 offset:12800
    s_waitcnt lgkmcnt(4)
    v_mfma_f32_16x16x32_bf16 v[168:171], v[40:43], a[32:35], v[168:171]
    s_add_u32 m0, s39, 139264
    v_mul_f32 v30, v30, v28
    v_mul_f32 v31, v31, v29
    v_mfma_f32_16x16x32_bf16 v[168:171], v[44:47], a[48:51], v[168:171]
    v_add_u32 v2, 98304, v2
    ds_read_b64_tr_b16 v[56:57], v2 offset:0
    v_mfma_f32_16x16x32_bf16 v[184:187], v[40:43], a[36:39], v[184:187]
    v_cvt_pk_bf16_f32 v98, v30, v31
    v_mul_f32 v32, v24, v106
    v_mfma_f32_16x16x32_bf16 v[184:187], v[44:47], a[52:55], v[184:187]
    ds_read_b64_tr_b16 v[58:59], v2 offset:512
    v_mul_f32 v33, v24, v107
    v_mfma_f32_16x16x32_bf16 v[200:203], v[40:43], a[40:43], v[200:203]
    buffer_load_dwordx4 v22, s[16:19], 0 offen offset:0 lds
    v_mul_f32 v34, v106, v110
    v_mfma_f32_16x16x32_bf16 v[200:203], v[44:47], a[56:59], v[200:203]
    ds_read_b64_tr_b16 v[60:61], v2 offset:4096
    v_exp_f32 v32, v32
    v_mfma_f32_16x16x32_bf16 v[216:219], v[40:43], a[44:47], v[216:219]
    v_exp_f32 v33, v33
    v_mfma_f32_16x16x32_bf16 v[216:219], v[44:47], a[60:63], v[216:219]
    ds_read_b64_tr_b16 v[62:63], v2 offset:4608
    s_waitcnt lgkmcnt(4)
    v_mfma_f32_16x16x32_bf16 v[172:175], v[48:51], a[32:35], v[172:175]
    buffer_load_dwordx4 v22, s[16:19], s36 offen offset:1024 lds
    v_mul_f32 v35, v107, v111
    v_mfma_f32_16x16x32_bf16 v[172:175], v[52:55], a[48:51], v[172:175]
    ds_read_b64_tr_b16 v[40:41], v2 offset:8192
    v_add_f32 v32, 1.0, v32
    v_mfma_f32_16x16x32_bf16 v[188:191], v[48:51], a[36:39], v[188:191]
    v_add_f32 v33, 1.0, v33
    v_rcp_f32 v32, v32
    v_mfma_f32_16x16x32_bf16 v[188:191], v[52:55], a[52:55], v[188:191]
    ds_read_b64_tr_b16 v[42:43], v2 offset:8704
    v_mul_f32 v34, v34, v32
    v_mfma_f32_16x16x32_bf16 v[204:207], v[48:51], a[40:43], v[204:207]
    v_add_u32 v22, 589824, v22
    v_mul_f32 v28, v25, v112
    v_mfma_f32_16x16x32_bf16 v[204:207], v[52:55], a[56:59], v[204:207]
    ds_read_b64_tr_b16 v[44:45], v2 offset:12288
    v_mul_f32 v29, v25, v113
    v_mfma_f32_16x16x32_bf16 v[220:223], v[48:51], a[44:47], v[220:223]
    v_rcp_f32 v33, v33
    v_mfma_f32_16x16x32_bf16 v[220:223], v[52:55], a[60:63], v[220:223]
    ds_read_b64_tr_b16 v[46:47], v2 offset:12800
    s_waitcnt lgkmcnt(4)
    v_mfma_f32_16x16x32_bf16 v[160:163], v[56:59], a[64:67], v[160:163]
    s_waitcnt vmcnt(30)
    s_barrier
    v_mul_f32 v35, v35, v33
    v_mfma_f32_16x16x32_bf16 v[160:163], v[60:63], a[80:83], v[160:163]
    s_add_u32 m0, s38, 49152
    v_add_u32 v3, 98304, v3
    ds_read_b64_tr_b16 v[48:49], v3 offset:0
    v_cvt_pk_bf16_f32 v99, v34, v35
    v_mfma_f32_16x16x32_bf16 v[176:179], v[56:59], a[68:71], v[176:179]
    buffer_store_dwordx4 v[96:99], v1, s[24:27], s47 offen offset:0 sc1
    v_mfma_f32_16x16x32_bf16 v[176:179], v[60:63], a[84:87], v[176:179]
    ds_read_b64_tr_b16 v[50:51], v3 offset:512
    v_mul_f32 v30, v112, v116
    v_mfma_f32_16x16x32_bf16 v[192:195], v[56:59], a[72:75], v[192:195]
    buffer_load_dwordx4 v15, s[16:19], 0 offen offset:0 lds
    v_mfma_f32_16x16x32_bf16 v[192:195], v[60:63], a[88:91], v[192:195]
    ds_read_b64_tr_b16 v[52:53], v3 offset:4096
    v_mul_f32 v31, v113, v117
    v_mfma_f32_16x16x32_bf16 v[208:211], v[56:59], a[76:79], v[208:211]
    v_exp_f32 v28, v28
    v_mfma_f32_16x16x32_bf16 v[208:211], v[60:63], a[92:95], v[208:211]
    ds_read_b64_tr_b16 v[54:55], v3 offset:4608
    s_waitcnt lgkmcnt(4)
    v_mfma_f32_16x16x32_bf16 v[164:167], v[40:43], a[64:67], v[164:167]
    v_exp_f32 v29, v29
    v_mfma_f32_16x16x32_bf16 v[164:167], v[44:47], a[80:83], v[164:167]
    ds_read_b64_tr_b16 v[56:57], v3 offset:8192
    v_add_f32 v28, 1.0, v28
    v_mfma_f32_16x16x32_bf16 v[180:183], v[40:43], a[68:71], v[180:183]
    buffer_load_dwordx4 v16, s[16:19], s33 offen offset:1024 lds
    v_mfma_f32_16x16x32_bf16 v[180:183], v[44:47], a[84:87], v[180:183]
    ds_read_b64_tr_b16 v[58:59], v3 offset:8704
    v_add_f32 v29, 1.0, v29
    v_mfma_f32_16x16x32_bf16 v[196:199], v[40:43], a[72:75], v[196:199]
    v_rcp_f32 v28, v28
    v_mfma_f32_16x16x32_bf16 v[196:199], v[44:47], a[88:91], v[196:199]
    ds_read_b64_tr_b16 v[60:61], v3 offset:12288
    v_mul_f32 v30, v30, v28
    v_mfma_f32_16x16x32_bf16 v[212:215], v[40:43], a[76:79], v[212:215]
    buffer_load_dwordx4 v15, s[16:19], s34 offen offset:2048 lds
    v_mfma_f32_16x16x32_bf16 v[212:215], v[44:47], a[92:95], v[212:215]
    ds_read_b64_tr_b16 v[62:63], v3 offset:12800
    v_mul_f32 v32, v25, v114
    s_waitcnt lgkmcnt(4)
    v_mfma_f32_16x16x32_bf16 v[168:171], v[48:51], a[64:67], v[168:171]
    v_rcp_f32 v29, v29
    v_mfma_f32_16x16x32_bf16 v[168:171], v[52:55], a[80:83], v[168:171]
    v_add_u32 v2, 4294885376, v2
    ds_read_b64_tr_b16 v[40:41], v2 offset:0
    v_mfma_f32_16x16x32_bf16 v[184:187], v[48:51], a[68:71], v[184:187]
    v_mul_f32 v31, v31, v29
    v_cvt_pk_bf16_f32 v112, v30, v31
    v_mfma_f32_16x16x32_bf16 v[184:187], v[52:55], a[84:87], v[184:187]
    ds_read_b64_tr_b16 v[42:43], v2 offset:512
    v_add_u32 v15, 589824, v15
    v_mul_f32 v33, v25, v115
    v_mfma_f32_16x16x32_bf16 v[200:203], v[48:51], a[72:75], v[200:203]
    v_exp_f32 v32, v32
    v_mfma_f32_16x16x32_bf16 v[200:203], v[52:55], a[88:91], v[200:203]
    ds_read_b64_tr_b16 v[44:45], v2 offset:4096
    v_mul_f32 v34, v114, v118
    v_mfma_f32_16x16x32_bf16 v[216:219], v[48:51], a[76:79], v[216:219]
    v_exp_f32 v33, v33
    v_mfma_f32_16x16x32_bf16 v[216:219], v[52:55], a[92:95], v[216:219]
    ds_read_b64_tr_b16 v[46:47], v2 offset:4608
    s_waitcnt lgkmcnt(4)
    v_mfma_f32_16x16x32_bf16 v[172:175], v[56:59], a[64:67], v[172:175]
    buffer_load_dwordx4 v16, s[16:19], s35 offen offset:3072 lds
    v_mul_f32 v35, v115, v119
    v_mfma_f32_16x16x32_bf16 v[172:175], v[60:63], a[80:83], v[172:175]
    ds_read_b64_tr_b16 v[48:49], v2 offset:8192
    v_add_f32 v32, 1.0, v32
    v_mfma_f32_16x16x32_bf16 v[188:191], v[56:59], a[68:71], v[188:191]
    v_add_f32 v33, 1.0, v33
    v_mul_f32 v28, v25, v120
    v_mfma_f32_16x16x32_bf16 v[188:191], v[60:63], a[84:87], v[188:191]
    ds_read_b64_tr_b16 v[50:51], v2 offset:8704
    v_mul_f32 v29, v25, v121
    v_mfma_f32_16x16x32_bf16 v[204:207], v[56:59], a[72:75], v[204:207]
    v_add_u32 v16, 589824, v16
    v_rcp_f32 v32, v32
    v_mfma_f32_16x16x32_bf16 v[204:207], v[60:63], a[88:91], v[204:207]
    ds_read_b64_tr_b16 v[52:53], v2 offset:12288
    v_mul_f32 v34, v34, v32
    v_mfma_f32_16x16x32_bf16 v[220:223], v[56:59], a[76:79], v[220:223]
    v_rcp_f32 v33, v33
    v_mfma_f32_16x16x32_bf16 v[220:223], v[60:63], a[92:95], v[220:223]
    ds_read_b64_tr_b16 v[54:55], v2 offset:12800
    s_waitcnt lgkmcnt(4)
    v_mfma_f32_16x16x32_bf16 v[160:163], v[40:43], a[96:99], v[160:163]
    s_waitcnt vmcnt(30)
    s_barrier
    v_mul_f32 v35, v35, v33
    v_mfma_f32_16x16x32_bf16 v[160:163], v[44:47], a[112:115], v[160:163]
    s_add_u32 m0, s39, 147456
    v_add_u32 v3, 4294885376, v3
    ds_read_b64_tr_b16 v[56:57], v3 offset:0
    v_cvt_pk_bf16_f32 v113, v34, v35
    v_mfma_f32_16x16x32_bf16 v[176:179], v[40:43], a[100:103], v[176:179]
    v_exp_f32 v28, v28
    v_mfma_f32_16x16x32_bf16 v[176:179], v[44:47], a[116:119], v[176:179]
    ds_read_b64_tr_b16 v[58:59], v3 offset:512
    v_mul_f32 v30, v120, v124
    v_mfma_f32_16x16x32_bf16 v[192:195], v[40:43], a[104:107], v[192:195]
    buffer_load_dwordx4 v22, s[16:19], 0 offen offset:0 lds
    v_mul_f32 v31, v121, v125
    v_mfma_f32_16x16x32_bf16 v[192:195], v[44:47], a[120:123], v[192:195]
    ds_read_b64_tr_b16 v[60:61], v3 offset:4096
    v_exp_f32 v29, v29
    v_mfma_f32_16x16x32_bf16 v[208:211], v[40:43], a[108:111], v[208:211]
    v_add_f32 v28, 1.0, v28
    v_add_f32 v29, 1.0, v29
    v_mfma_f32_16x16x32_bf16 v[208:211], v[44:47], a[124:127], v[208:211]
    ds_read_b64_tr_b16 v[62:63], v3 offset:4608
    s_waitcnt lgkmcnt(4)
    v_mfma_f32_16x16x32_bf16 v[164:167], v[48:51], a[96:99], v[164:167]
    buffer_load_dwordx4 v22, s[16:19], s36 offen offset:1024 lds
    v_mul_f32 v32, v25, v122
    v_mfma_f32_16x16x32_bf16 v[164:167], v[52:55], a[112:115], v[164:167]
    ds_read_b64_tr_b16 v[40:41], v3 offset:8192
    v_rcp_f32 v28, v28
    v_mfma_f32_16x16x32_bf16 v[180:183], v[48:51], a[100:103], v[180:183]
    v_rcp_f32 v29, v29
    v_mfma_f32_16x16x32_bf16 v[180:183], v[52:55], a[116:119], v[180:183]
    ds_read_b64_tr_b16 v[42:43], v3 offset:8704
    v_add_u32 v22, 589824, v22
    v_mfma_f32_16x16x32_bf16 v[196:199], v[48:51], a[104:107], v[196:199]
    v_mul_f32 v30, v30, v28
    v_mul_f32 v31, v31, v29
    v_mfma_f32_16x16x32_bf16 v[196:199], v[52:55], a[120:123], v[196:199]
    s_add_u32 m0, s39, 155648
    ds_read_b64_tr_b16 v[44:45], v3 offset:12288
    v_cvt_pk_bf16_f32 v114, v30, v31
    v_mfma_f32_16x16x32_bf16 v[212:215], v[48:51], a[108:111], v[212:215]
    v_mul_f32 v33, v25, v123
    v_mul_f32 v34, v122, v126
    v_mfma_f32_16x16x32_bf16 v[212:215], v[52:55], a[124:127], v[212:215]
    ds_read_b64_tr_b16 v[46:47], v3 offset:12800
    s_waitcnt lgkmcnt(4)
    v_mfma_f32_16x16x32_bf16 v[168:171], v[56:59], a[96:99], v[168:171]
    buffer_load_dwordx4 v22, s[16:19], 0 offen offset:0 lds
    v_mfma_f32_16x16x32_bf16 v[168:171], v[60:63], a[112:115], v[168:171]
    v_add_u32 v2, 4294901760, v2
    ds_read_b64_tr_b16 v[48:49], v2 offset:0
    v_mul_f32 v35, v123, v127
    v_mfma_f32_16x16x32_bf16 v[184:187], v[56:59], a[100:103], v[184:187]
    v_exp_f32 v32, v32
    v_mfma_f32_16x16x32_bf16 v[184:187], v[60:63], a[116:119], v[184:187]
    ds_read_b64_tr_b16 v[50:51], v2 offset:512
    v_exp_f32 v33, v33
    v_mfma_f32_16x16x32_bf16 v[200:203], v[56:59], a[104:107], v[200:203]
    buffer_load_dwordx4 v22, s[16:19], s36 offen offset:1024 lds
    v_mfma_f32_16x16x32_bf16 v[200:203], v[60:63], a[120:123], v[200:203]
    ds_read_b64_tr_b16 v[52:53], v2 offset:4096
    v_add_f32 v32, 1.0, v32
    v_add_f32 v33, 1.0, v33
    v_mfma_f32_16x16x32_bf16 v[216:219], v[56:59], a[108:111], v[216:219]
    v_rcp_f32 v32, v32
    v_mfma_f32_16x16x32_bf16 v[216:219], v[60:63], a[124:127], v[216:219]
    ds_read_b64_tr_b16 v[54:55], v2 offset:4608
    s_waitcnt lgkmcnt(4)
    v_mfma_f32_16x16x32_bf16 v[172:175], v[40:43], a[96:99], v[172:175]
    s_cmp_eq_u32 s8, 8
    s_cselect_b32 s13, s12, s9
    v_rcp_f32 v33, v33
    v_mfma_f32_16x16x32_bf16 v[172:175], v[44:47], a[112:115], v[172:175]
    ds_read_b64_tr_b16 v[56:57], v2 offset:8192
    v_mul_f32 v34, v34, v32
    v_mfma_f32_16x16x32_bf16 v[188:191], v[40:43], a[100:103], v[188:191]
    v_mul_f32 v35, v35, v33
    v_cvt_pk_bf16_f32 v115, v34, v35
    v_mfma_f32_16x16x32_bf16 v[188:191], v[44:47], a[116:119], v[188:191]
    ds_read_b64_tr_b16 v[58:59], v2 offset:8704
    v_mul_f32 v28, v26, v128
    v_mfma_f32_16x16x32_bf16 v[204:207], v[40:43], a[104:107], v[204:207]
    buffer_store_dwordx4 v[112:115], v1, s[24:27], s47 offen offset:1024 sc1
    v_mfma_f32_16x16x32_bf16 v[204:207], v[44:47], a[120:123], v[204:207]
    ds_read_b64_tr_b16 v[60:61], v2 offset:12288
    v_add_u32 v22, s13, v22
    v_mfma_f32_16x16x32_bf16 v[220:223], v[40:43], a[108:111], v[220:223]
    v_mul_f32 v29, v26, v129
    v_mul_f32 v30, v128, v132
    v_mfma_f32_16x16x32_bf16 v[220:223], v[44:47], a[124:127], v[220:223]
    ds_read_b64_tr_b16 v[62:63], v2 offset:12800
    s_waitcnt lgkmcnt(4)
    v_mfma_f32_16x16x32_bf16 v[160:163], v[48:51], a[128:131], v[160:163]
    s_waitcnt vmcnt(26)
    s_barrier
    v_mul_f32 v31, v129, v133
    v_mfma_f32_16x16x32_bf16 v[160:163], v[52:55], a[144:147], v[160:163]
    s_add_u32 m0, s38, 65536
    v_add_u32 v3, 4294901760, v3
    ds_read_b64_tr_b16 v[40:41], v3 offset:0
    v_mfma_f32_16x16x32_bf16 v[176:179], v[48:51], a[132:135], v[176:179]
    v_exp_f32 v28, v28
    v_mfma_f32_16x16x32_bf16 v[176:179], v[52:55], a[148:151], v[176:179]
    ds_read_b64_tr_b16 v[42:43], v3 offset:512
    v_add_f32 v28, 1.0, v28
    v_mfma_f32_16x16x32_bf16 v[192:195], v[48:51], a[136:139], v[192:195]
    v_exp_f32 v29, v29
    v_mfma_f32_16x16x32_bf16 v[192:195], v[52:55], a[152:155], v[192:195]
    ds_read_b64_tr_b16 v[44:45], v3 offset:4096
    v_add_f32 v29, 1.0, v29
    v_mfma_f32_16x16x32_bf16 v[208:211], v[48:51], a[140:143], v[208:211]
    buffer_load_dwordx4 v15, s[16:19], 0 offen offset:0 lds
    v_mfma_f32_16x16x32_bf16 v[208:211], v[52:55], a[156:159], v[208:211]
    ds_read_b64_tr_b16 v[46:47], v3 offset:4608
    s_waitcnt lgkmcnt(4)
    v_mfma_f32_16x16x32_bf16 v[164:167], v[56:59], a[128:131], v[164:167]
    v_rcp_f32 v28, v28
    v_mfma_f32_16x16x32_bf16 v[164:167], v[60:63], a[144:147], v[164:167]
    ds_read_b64_tr_b16 v[48:49], v3 offset:8192
    v_mul_f32 v30, v30, v28
    v_mfma_f32_16x16x32_bf16 v[180:183], v[56:59], a[132:135], v[180:183]
    v_rcp_f32 v29, v29
    v_mfma_f32_16x16x32_bf16 v[180:183], v[60:63], a[148:151], v[180:183]
    ds_read_b64_tr_b16 v[50:51], v3 offset:8704
    v_mul_f32 v31, v31, v29
    v_mfma_f32_16x16x32_bf16 v[196:199], v[56:59], a[136:139], v[196:199]
    buffer_load_dwordx4 v16, s[16:19], s33 offen offset:1024 lds
    v_mfma_f32_16x16x32_bf16 v[196:199], v[60:63], a[152:155], v[196:199]
    ds_read_b64_tr_b16 v[52:53], v3 offset:12288
    v_cvt_pk_bf16_f32 v128, v30, v31
    v_mfma_f32_16x16x32_bf16 v[212:215], v[56:59], a[140:143], v[212:215]
    v_mul_f32 v32, v26, v130
    v_mul_f32 v33, v26, v131
    v_mfma_f32_16x16x32_bf16 v[212:215], v[60:63], a[156:159], v[212:215]
    ds_read_b64_tr_b16 v[54:55], v3 offset:12800
    s_waitcnt lgkmcnt(4)
    v_mfma_f32_16x16x32_bf16 v[168:171], v[40:43], a[128:131], v[168:171]
    v_exp_f32 v32, v32
    v_mfma_f32_16x16x32_bf16 v[168:171], v[44:47], a[144:147], v[168:171]
    ds_read_b64_tr_b16 v[56:57], v2 offset:16384
    v_mul_f32 v34, v130, v134
    v_mfma_f32_16x16x32_bf16 v[184:187], v[40:43], a[132:135], v[184:187]
    buffer_load_dwordx4 v15, s[16:19], s34 offen offset:2048 lds
    v_mul_f32 v35, v131, v135
    v_mfma_f32_16x16x32_bf16 v[184:187], v[44:47], a[148:151], v[184:187]
    ds_read_b64_tr_b16 v[58:59], v2 offset:16896
    v_exp_f32 v33, v33
    v_mfma_f32_16x16x32_bf16 v[200:203], v[40:43], a[136:139], v[200:203]
    v_add_f32 v32, 1.0, v32
    v_add_f32 v33, 1.0, v33
    v_mfma_f32_16x16x32_bf16 v[200:203], v[44:47], a[152:155], v[200:203]
    ds_read_b64_tr_b16 v[60:61], v2 offset:20480
    v_mul_f32 v28, v26, v136
    v_mfma_f32_16x16x32_bf16 v[216:219], v[40:43], a[140:143], v[216:219]
    v_rcp_f32 v32, v32
    v_mfma_f32_16x16x32_bf16 v[216:219], v[44:47], a[156:159], v[216:219]
    ds_read_b64_tr_b16 v[62:63], v2 offset:20992
    s_waitcnt lgkmcnt(4)
    v_mfma_f32_16x16x32_bf16 v[172:175], v[48:51], a[128:131], v[172:175]
    v_rcp_f32 v33, v33
    v_mfma_f32_16x16x32_bf16 v[172:175], v[52:55], a[144:147], v[172:175]
    ds_read_b64_tr_b16 v[40:41], v2 offset:24576
    v_mul_f32 v34, v34, v32
    v_mfma_f32_16x16x32_bf16 v[188:191], v[48:51], a[132:135], v[188:191]
    buffer_load_dwordx4 v16, s[16:19], s35 offen offset:3072 lds
    v_mfma_f32_16x16x32_bf16 v[188:191], v[52:55], a[148:151], v[188:191]
    ds_read_b64_tr_b16 v[42:43], v2 offset:25088
    v_mul_f32 v35, v35, v33
    v_mfma_f32_16x16x32_bf16 v[204:207], v[48:51], a[136:139], v[204:207]
    v_cvt_pk_bf16_f32 v129, v34, v35
    v_mul_f32 v29, v26, v137
    v_mfma_f32_16x16x32_bf16 v[204:207], v[52:55], a[152:155], v[204:207]
    ds_read_b64_tr_b16 v[44:45], v2 offset:28672
    v_mul_f32 v30, v136, v140
    v_mfma_f32_16x16x32_bf16 v[220:223], v[48:51], a[140:143], v[220:223]
    v_exp_f32 v28, v28
    v_mfma_f32_16x16x32_bf16 v[220:223], v[52:55], a[156:159], v[220:223]
    ds_read_b64_tr_b16 v[46:47], v2 offset:29184
    s_waitcnt lgkmcnt(4)
    v_mfma_f32_16x16x32_bf16 v[160:163], v[56:59], a[160:163], v[160:163]
    s_waitcnt vmcnt(18)
    s_barrier
    v_exp_f32 v29, v29
    v_mfma_f32_16x16x32_bf16 v[160:163], v[60:63], a[176:179], v[160:163]
    ds_read_b64_tr_b16 v[48:49], v3 offset:16384
    v_mul_f32 v31, v137, v141
    v_mfma_f32_16x16x32_bf16 v[176:179], v[56:59], a[164:167], v[176:179]
    v_add_f32 v28, 1.0, v28
    v_add_f32 v29, 1.0, v29
    v_mfma_f32_16x16x32_bf16 v[176:179], v[60:63], a[180:183], v[176:179]
    ds_read_b64_tr_b16 v[50:51], v3 offset:16896
    v_mul_f32 v32, v26, v138
    v_mfma_f32_16x16x32_bf16 v[192:195], v[56:59], a[168:171], v[192:195]
    v_rcp_f32 v28, v28
    v_mfma_f32_16x16x32_bf16 v[192:195], v[60:63], a[184:187], v[192:195]
    ds_read_b64_tr_b16 v[52:53], v3 offset:20480
    v_mul_f32 v30, v30, v28
    v_mfma_f32_16x16x32_bf16 v[208:211], v[56:59], a[172:175], v[208:211]
    v_rcp_f32 v29, v29
    v_mfma_f32_16x16x32_bf16 v[208:211], v[60:63], a[188:191], v[208:211]
    ds_read_b64_tr_b16 v[54:55], v3 offset:20992
    s_waitcnt lgkmcnt(4)
    v_mfma_f32_16x16x32_bf16 v[164:167], v[40:43], a[160:163], v[164:167]
    v_mul_f32 v31, v31, v29
    v_cvt_pk_bf16_f32 v130, v30, v31
    v_mfma_f32_16x16x32_bf16 v[164:167], v[44:47], a[176:179], v[164:167]
    ds_read_b64_tr_b16 v[56:57], v3 offset:24576
    v_mul_f32 v33, v26, v139
    v_mfma_f32_16x16x32_bf16 v[180:183], v[40:43], a[164:167], v[180:183]
    v_exp_f32 v32, v32
    v_mfma_f32_16x16x32_bf16 v[180:183], v[44:47], a[180:183], v[180:183]
    ds_read_b64_tr_b16 v[58:59], v3 offset:25088
    v_mul_f32 v34, v138, v142
    v_mfma_f32_16x16x32_bf16 v[196:199], v[40:43], a[168:171], v[196:199]
    v_exp_f32 v33, v33
    v_mfma_f32_16x16x32_bf16 v[196:199], v[44:47], a[184:187], v[196:199]
    ds_read_b64_tr_b16 v[60:61], v3 offset:28672
    v_mul_f32 v35, v139, v143
    v_mfma_f32_16x16x32_bf16 v[212:215], v[40:43], a[172:175], v[212:215]
    v_add_f32 v32, 1.0, v32
    v_add_f32 v33, 1.0, v33
    v_mfma_f32_16x16x32_bf16 v[212:215], v[44:47], a[188:191], v[212:215]
    ds_read_b64_tr_b16 v[62:63], v3 offset:29184
    s_waitcnt lgkmcnt(4)
    v_mfma_f32_16x16x32_bf16 v[168:171], v[48:51], a[160:163], v[168:171]
    v_rcp_f32 v32, v32
    v_mfma_f32_16x16x32_bf16 v[168:171], v[52:55], a[176:179], v[168:171]
    ds_read_b64_tr_b16 v[40:41], v2 offset:32768
    v_mul_f32 v34, v34, v32
    v_mfma_f32_16x16x32_bf16 v[184:187], v[48:51], a[164:167], v[184:187]
    v_rcp_f32 v33, v33
    v_mfma_f32_16x16x32_bf16 v[184:187], v[52:55], a[180:183], v[184:187]
    ds_read_b64_tr_b16 v[42:43], v2 offset:33280
    v_mul_f32 v35, v35, v33
    v_mfma_f32_16x16x32_bf16 v[200:203], v[48:51], a[168:171], v[200:203]
    v_cvt_pk_bf16_f32 v131, v34, v35
    v_mul_f32 v28, v27, v144
    v_mfma_f32_16x16x32_bf16 v[200:203], v[52:55], a[184:187], v[200:203]
    ds_read_b64_tr_b16 v[44:45], v2 offset:36864
    v_mul_f32 v29, v27, v145
    v_mfma_f32_16x16x32_bf16 v[216:219], v[48:51], a[172:175], v[216:219]
    buffer_store_dwordx4 v[128:131], v1, s[24:27], s47 offen offset:2048 sc1
    v_mfma_f32_16x16x32_bf16 v[216:219], v[52:55], a[188:191], v[216:219]
    ds_read_b64_tr_b16 v[46:47], v2 offset:37376
    s_waitcnt lgkmcnt(4)
    v_mfma_f32_16x16x32_bf16 v[172:175], v[56:59], a[160:163], v[172:175]
    v_exp_f32 v28, v28
    v_mfma_f32_16x16x32_bf16 v[172:175], v[60:63], a[176:179], v[172:175]
    ds_read_b64_tr_b16 v[48:49], v2 offset:40960
    v_mul_f32 v30, v144, v148
    v_mfma_f32_16x16x32_bf16 v[188:191], v[56:59], a[164:167], v[188:191]
    v_exp_f32 v29, v29
    v_mfma_f32_16x16x32_bf16 v[188:191], v[60:63], a[180:183], v[188:191]
    ds_read_b64_tr_b16 v[50:51], v2 offset:41472
    v_mul_f32 v31, v145, v149
    v_mfma_f32_16x16x32_bf16 v[204:207], v[56:59], a[168:171], v[204:207]
    v_add_f32 v28, 1.0, v28
    v_add_f32 v29, 1.0, v29
    v_mfma_f32_16x16x32_bf16 v[204:207], v[60:63], a[184:187], v[204:207]
    ds_read_b64_tr_b16 v[52:53], v2 offset:45056
    v_mul_f32 v32, v27, v146
    v_mfma_f32_16x16x32_bf16 v[220:223], v[56:59], a[172:175], v[220:223]
    v_rcp_f32 v28, v28
    v_mfma_f32_16x16x32_bf16 v[220:223], v[60:63], a[188:191], v[220:223]
    ds_read_b64_tr_b16 v[54:55], v2 offset:45568
    s_waitcnt lgkmcnt(4)
    v_mfma_f32_16x16x32_bf16 v[160:163], v[40:43], a[192:195], v[160:163]
    s_waitcnt vmcnt(10)
    s_barrier
    v_mul_f32 v30, v30, v28
    v_mfma_f32_16x16x32_bf16 v[160:163], v[44:47], a[208:211], v[160:163]
    ds_read_b64_tr_b16 v[56:57], v3 offset:32768
    v_mul_f32 v33, v27, v147
    v_mfma_f32_16x16x32_bf16 v[176:179], v[40:43], a[196:199], v[176:179]
    v_rcp_f32 v29, v29
    v_mfma_f32_16x16x32_bf16 v[176:179], v[44:47], a[212:215], v[176:179]
    ds_read_b64_tr_b16 v[58:59], v3 offset:33280
    v_mul_f32 v31, v31, v29
    v_mfma_f32_16x16x32_bf16 v[192:195], v[40:43], a[200:203], v[192:195]
    v_cvt_pk_bf16_f32 v144, v30, v31
    v_mul_f32 v34, v146, v150
    v_mfma_f32_16x16x32_bf16 v[192:195], v[44:47], a[216:219], v[192:195]
    ds_read_b64_tr_b16 v[60:61], v3 offset:36864
    s_mov_b32 s60, 26624
    buffer_load_dword v38, v39, s[4:7], s60 offen sc0 sc1
    v_mfma_f32_16x16x32_bf16 v[208:211], v[40:43], a[204:207], v[208:211]
    v_exp_f32 v32, v32
    v_mfma_f32_16x16x32_bf16 v[208:211], v[44:47], a[220:223], v[208:211]
    ds_read_b64_tr_b16 v[62:63], v3 offset:37376
    s_waitcnt lgkmcnt(4)
    v_mfma_f32_16x16x32_bf16 v[164:167], v[48:51], a[192:195], v[164:167]
    v_exp_f32 v33, v33
    v_mfma_f32_16x16x32_bf16 v[164:167], v[52:55], a[208:211], v[164:167]
    ds_read_b64_tr_b16 v[40:41], v3 offset:40960
    v_mul_f32 v35, v147, v151
    v_mfma_f32_16x16x32_bf16 v[180:183], v[48:51], a[196:199], v[180:183]
    v_add_f32 v32, 1.0, v32
    v_add_f32 v33, 1.0, v33
    v_mfma_f32_16x16x32_bf16 v[180:183], v[52:55], a[212:215], v[180:183]
    ds_read_b64_tr_b16 v[42:43], v3 offset:41472
    v_mul_f32 v28, v27, v152
    v_mfma_f32_16x16x32_bf16 v[196:199], v[48:51], a[200:203], v[196:199]
    v_rcp_f32 v32, v32
    v_mfma_f32_16x16x32_bf16 v[196:199], v[52:55], a[216:219], v[196:199]
    ds_read_b64_tr_b16 v[44:45], v3 offset:45056
    v_mul_f32 v34, v34, v32
    v_mfma_f32_16x16x32_bf16 v[212:215], v[48:51], a[204:207], v[212:215]
    v_rcp_f32 v33, v33
    v_mfma_f32_16x16x32_bf16 v[212:215], v[52:55], a[220:223], v[212:215]
    ds_read_b64_tr_b16 v[46:47], v3 offset:45568
    s_waitcnt lgkmcnt(4)
    v_mfma_f32_16x16x32_bf16 v[168:171], v[56:59], a[192:195], v[168:171]
    v_mul_f32 v35, v35, v33
    v_cvt_pk_bf16_f32 v145, v34, v35
    v_mfma_f32_16x16x32_bf16 v[168:171], v[60:63], a[208:211], v[168:171]
    ds_read_b64_tr_b16 v[48:49], v2 offset:49152
    v_mul_f32 v29, v27, v153
    v_mfma_f32_16x16x32_bf16 v[184:187], v[56:59], a[196:199], v[184:187]
    v_exp_f32 v28, v28
    v_mfma_f32_16x16x32_bf16 v[184:187], v[60:63], a[212:215], v[184:187]
    ds_read_b64_tr_b16 v[50:51], v2 offset:49664
    v_mul_f32 v30, v152, v156
    v_mfma_f32_16x16x32_bf16 v[200:203], v[56:59], a[200:203], v[200:203]
    v_exp_f32 v29, v29
    v_mfma_f32_16x16x32_bf16 v[200:203], v[60:63], a[216:219], v[200:203]
    ds_read_b64_tr_b16 v[52:53], v2 offset:53248
    v_mul_f32 v31, v153, v157
    v_mfma_f32_16x16x32_bf16 v[216:219], v[56:59], a[204:207], v[216:219]
    v_add_f32 v28, 1.0, v28
    v_add_f32 v29, 1.0, v29
    v_mfma_f32_16x16x32_bf16 v[216:219], v[60:63], a[220:223], v[216:219]
    ds_read_b64_tr_b16 v[54:55], v2 offset:53760
    s_waitcnt lgkmcnt(4)
    v_mfma_f32_16x16x32_bf16 v[172:175], v[40:43], a[192:195], v[172:175]
    v_rcp_f32 v28, v28
    v_mfma_f32_16x16x32_bf16 v[172:175], v[44:47], a[208:211], v[172:175]
    ds_read_b64_tr_b16 v[56:57], v2 offset:57344
    v_mul_f32 v30, v30, v28
    v_mfma_f32_16x16x32_bf16 v[188:191], v[40:43], a[196:199], v[188:191]
    v_rcp_f32 v29, v29
    v_mfma_f32_16x16x32_bf16 v[188:191], v[44:47], a[212:215], v[188:191]
    ds_read_b64_tr_b16 v[58:59], v2 offset:57856
    v_mul_f32 v31, v31, v29
    v_mfma_f32_16x16x32_bf16 v[204:207], v[40:43], a[200:203], v[204:207]
    v_cvt_pk_bf16_f32 v146, v30, v31
    v_mul_f32 v32, v27, v154
    v_mfma_f32_16x16x32_bf16 v[204:207], v[44:47], a[216:219], v[204:207]
    ds_read_b64_tr_b16 v[60:61], v2 offset:61440
    v_mul_f32 v33, v27, v155
    v_mfma_f32_16x16x32_bf16 v[220:223], v[40:43], a[204:207], v[220:223]
    v_exp_f32 v32, v32
    v_mfma_f32_16x16x32_bf16 v[220:223], v[44:47], a[220:223], v[220:223]
    ds_read_b64_tr_b16 v[62:63], v2 offset:61952
    s_waitcnt lgkmcnt(4)
    v_mfma_f32_16x16x32_bf16 v[160:163], v[48:51], a[224:227], v[160:163]
    s_waitcnt vmcnt(2)
    s_barrier
    v_mul_f32 v34, v154, v158
    v_mfma_f32_16x16x32_bf16 v[160:163], v[52:55], a[240:243], v[160:163]
    s_add_u32 m0, s40, 0
    ds_read_b64_tr_b16 v[40:41], v3 offset:49152
    v_mul_f32 v35, v155, v159
    v_mfma_f32_16x16x32_bf16 v[176:179], v[48:51], a[228:231], v[176:179]
    s_add_u32 s14, s41, 0
    s_add_u32 s15, s41, 73728
    s_cmp_eq_u32 s31, 0
    s_cselect_b32 s52, s14, s15
    v_mfma_f32_16x16x32_bf16 v[176:179], v[52:55], a[244:247], v[176:179]
    ds_read_b64_tr_b16 v[42:43], v3 offset:49664
    v_add_f32 v32, 1.0, v32
    v_mfma_f32_16x16x32_bf16 v[192:195], v[48:51], a[232:235], v[192:195]
    v_exp_f32 v33, v33
    v_mfma_f32_16x16x32_bf16 v[192:195], v[52:55], a[248:251], v[192:195]
    ds_read_b64_tr_b16 v[44:45], v3 offset:53248
    v_add_f32 v33, 1.0, v33
    v_mfma_f32_16x16x32_bf16 v[208:211], v[48:51], a[236:239], v[208:211]
    v_rcp_f32 v32, v32
    v_mfma_f32_16x16x32_bf16 v[208:211], v[52:55], a[252:255], v[208:211]
    ds_read_b64_tr_b16 v[46:47], v3 offset:53760
    s_waitcnt lgkmcnt(4)
    v_mfma_f32_16x16x32_bf16 v[164:167], v[56:59], a[224:227], v[164:167]
    v_rcp_f32 v33, v33
    v_mfma_f32_16x16x32_bf16 v[164:167], v[60:63], a[240:243], v[164:167]
    ds_read_b64_tr_b16 v[48:49], v3 offset:57344
    v_mul_f32 v34, v34, v32
    v_mfma_f32_16x16x32_bf16 v[180:183], v[56:59], a[228:231], v[180:183]
    buffer_load_dwordx4 v8, s[20:23], s52 offen offset:0 lds
    v_mfma_f32_16x16x32_bf16 v[180:183], v[60:63], a[244:247], v[180:183]
    ds_read_b64_tr_b16 v[50:51], v3 offset:57856
    v_mul_f32 v35, v35, v33
    v_mfma_f32_16x16x32_bf16 v[196:199], v[56:59], a[232:235], v[196:199]
    buffer_load_dwordx4 v9, s[20:23], s52 offen offset:1024 lds
    v_mfma_f32_16x16x32_bf16 v[196:199], v[60:63], a[248:251], v[196:199]
    ds_read_b64_tr_b16 v[52:53], v3 offset:61440
    v_cvt_pk_bf16_f32 v147, v34, v35
    v_mfma_f32_16x16x32_bf16 v[212:215], v[56:59], a[236:239], v[212:215]
    buffer_load_dwordx4 v10, s[20:23], s52 offen offset:2048 lds
    v_mfma_f32_16x16x32_bf16 v[212:215], v[60:63], a[252:255], v[212:215]
    ds_read_b64_tr_b16 v[54:55], v3 offset:61952
    s_waitcnt lgkmcnt(4)
    v_mfma_f32_16x16x32_bf16 v[168:171], v[40:43], a[224:227], v[168:171]
    buffer_store_dwordx4 v[144:147], v1, s[24:27], s47 offen offset:3072 sc1
    v_mfma_f32_16x16x32_bf16 v[168:171], v[44:47], a[240:243], v[168:171]
    s_add_u32 s47, s47, 4096
    v_add_u32 v2, 65536, v2
    ds_read_b64_tr_b16 v[56:57], v2 offset:0
    v_mfma_f32_16x16x32_bf16 v[184:187], v[40:43], a[228:231], v[184:187]
    buffer_load_dwordx4 v11, s[20:23], s52 offen offset:3072 lds
    v_mfma_f32_16x16x32_bf16 v[184:187], v[44:47], a[244:247], v[184:187]
    s_add_u32 m0, s40, 4096
    ds_read_b64_tr_b16 v[58:59], v2 offset:512
    v_mfma_f32_16x16x32_bf16 v[200:203], v[40:43], a[232:235], v[200:203]
    v_mfma_f32_16x16x32_bf16 v[200:203], v[44:47], a[248:251], v[200:203]
    ds_read_b64_tr_b16 v[60:61], v2 offset:4096
    v_mfma_f32_16x16x32_bf16 v[216:219], v[40:43], a[236:239], v[216:219]
    buffer_load_dwordx4 v12, s[20:23], s52 offen offset:0 lds
    v_mfma_f32_16x16x32_bf16 v[216:219], v[44:47], a[252:255], v[216:219]
    ds_read_b64_tr_b16 v[62:63], v2 offset:4608
    s_waitcnt lgkmcnt(4)
    v_mfma_f32_16x16x32_bf16 v[172:175], v[48:51], a[224:227], v[172:175]
    buffer_load_dwordx4 v13, s[20:23], s52 offen offset:1024 lds
    v_mfma_f32_16x16x32_bf16 v[172:175], v[52:55], a[240:243], v[172:175]
    ds_read_b64_tr_b16 v[40:41], v2 offset:8192
    v_mfma_f32_16x16x32_bf16 v[188:191], v[48:51], a[228:231], v[188:191]
    buffer_load_dwordx4 v14, s[20:23], s52 offen offset:2048 lds
    v_mfma_f32_16x16x32_bf16 v[188:191], v[52:55], a[244:247], v[188:191]
    ds_read_b64_tr_b16 v[42:43], v2 offset:8704
    v_mfma_f32_16x16x32_bf16 v[204:207], v[48:51], a[232:235], v[204:207]
    v_mfma_f32_16x16x32_bf16 v[204:207], v[52:55], a[248:251], v[204:207]
    ds_read_b64_tr_b16 v[44:45], v2 offset:12288
    v_mfma_f32_16x16x32_bf16 v[220:223], v[48:51], a[236:239], v[220:223]
    buffer_load_dwordx4 v17, s[20:23], s52 offen offset:3072 lds
    v_mfma_f32_16x16x32_bf16 v[220:223], v[52:55], a[252:255], v[220:223]
    ds_read_b64_tr_b16 v[46:47], v2 offset:12800
    s_waitcnt lgkmcnt(4)
    v_mfma_f32_16x16x32_bf16 v[160:163], v[56:59], v[64:67], v[160:163]
    s_waitcnt vmcnt(46)
    s_barrier
    v_mfma_f32_16x16x32_bf16 v[160:163], v[60:63], v[80:83], v[160:163]
    s_add_u32 m0, s40, 8192
    v_add_u32 v3, 65536, v3
    ds_read_b64_tr_b16 v[48:49], v3 offset:0
    v_mfma_f32_16x16x32_bf16 v[176:179], v[56:59], v[68:71], v[176:179]
    v_mfma_f32_16x16x32_bf16 v[176:179], v[60:63], v[84:87], v[176:179]
    ds_read_b64_tr_b16 v[50:51], v3 offset:512
    v_mfma_f32_16x16x32_bf16 v[192:195], v[56:59], v[72:75], v[192:195]
    v_mfma_f32_16x16x32_bf16 v[192:195], v[60:63], v[88:91], v[192:195]
    ds_read_b64_tr_b16 v[52:53], v3 offset:4096
    v_mfma_f32_16x16x32_bf16 v[208:211], v[56:59], v[76:79], v[208:211]
    v_mfma_f32_16x16x32_bf16 v[208:211], v[60:63], v[92:95], v[208:211]
    ds_read_b64_tr_b16 v[54:55], v3 offset:4608
    s_waitcnt lgkmcnt(4)
    v_mfma_f32_16x16x32_bf16 v[164:167], v[40:43], v[64:67], v[164:167]
    v_mfma_f32_16x16x32_bf16 v[164:167], v[44:47], v[80:83], v[164:167]
    ds_read_b64_tr_b16 v[56:57], v3 offset:8192
    v_mfma_f32_16x16x32_bf16 v[180:183], v[40:43], v[68:71], v[180:183]
    v_mfma_f32_16x16x32_bf16 v[180:183], v[44:47], v[84:87], v[180:183]
    ds_read_b64_tr_b16 v[58:59], v3 offset:8704
    v_mfma_f32_16x16x32_bf16 v[196:199], v[40:43], v[72:75], v[196:199]
    v_mfma_f32_16x16x32_bf16 v[196:199], v[44:47], v[88:91], v[196:199]
    ds_read_b64_tr_b16 v[60:61], v3 offset:12288
    v_mfma_f32_16x16x32_bf16 v[212:215], v[40:43], v[76:79], v[212:215]
    buffer_load_dwordx4 v18, s[20:23], s52 offen offset:0 lds
    v_mfma_f32_16x16x32_bf16 v[212:215], v[44:47], v[92:95], v[212:215]
    ds_read_b64_tr_b16 v[62:63], v3 offset:12800
    s_waitcnt lgkmcnt(4)
    v_mfma_f32_16x16x32_bf16 v[168:171], v[48:51], v[64:67], v[168:171]
    v_mfma_f32_16x16x32_bf16 v[168:171], v[52:55], v[80:83], v[168:171]
    v_add_u32 v6, 90112, v6
    ds_read_b64_tr_b16 v[40:41], v6 offset:0
    v_mfma_f32_16x16x32_bf16 v[184:187], v[48:51], v[68:71], v[184:187]
    v_mfma_f32_16x16x32_bf16 v[184:187], v[52:55], v[84:87], v[184:187]
    ds_read_b64_tr_b16 v[42:43], v6 offset:256
    v_mfma_f32_16x16x32_bf16 v[200:203], v[48:51], v[72:75], v[200:203]
    v_mfma_f32_16x16x32_bf16 v[200:203], v[52:55], v[88:91], v[200:203]
    ds_read_b64_tr_b16 v[44:45], v6 offset:2048
    v_mfma_f32_16x16x32_bf16 v[216:219], v[48:51], v[76:79], v[216:219]
    v_mfma_f32_16x16x32_bf16 v[216:219], v[52:55], v[92:95], v[216:219]
    ds_read_b64_tr_b16 v[46:47], v6 offset:2304
    s_waitcnt lgkmcnt(4)
    v_mfma_f32_16x16x32_bf16 v[172:175], v[56:59], v[64:67], v[172:175]
    v_mfma_f32_16x16x32_bf16 v[172:175], v[60:63], v[80:83], v[172:175]
    ds_read_b64_tr_b16 v[48:49], v6 offset:4096
    v_mfma_f32_16x16x32_bf16 v[188:191], v[56:59], v[68:71], v[188:191]
    v_mfma_f32_16x16x32_bf16 v[188:191], v[60:63], v[84:87], v[188:191]
    ds_read_b64_tr_b16 v[50:51], v6 offset:4352
    v_mfma_f32_16x16x32_bf16 v[204:207], v[56:59], v[72:75], v[204:207]
    v_mfma_f32_16x16x32_bf16 v[204:207], v[60:63], v[88:91], v[204:207]
    ds_read_b64_tr_b16 v[52:53], v6 offset:6144
    v_mfma_f32_16x16x32_bf16 v[220:223], v[56:59], v[76:79], v[220:223]
    v_mfma_f32_16x16x32_bf16 v[220:223], v[60:63], v[92:95], v[220:223]
    ds_read_b64_tr_b16 v[54:55], v6 offset:6400
    s_waitcnt lgkmcnt(4)
    v_mfma_f32_16x16x32_bf16 v[100:103], v[40:43], a[0:3], 0
    s_waitcnt vmcnt(38)
    s_barrier
    v_mfma_f32_16x16x32_bf16 v[100:103], v[44:47], a[16:19], v[100:103]
    s_add_u32 m0, s40, 36864
    ds_read_b64_tr_b16 v[56:57], v6 offset:8192
    v_mfma_f32_16x16x32_bf16 v[116:119], v[40:43], a[4:7], 0
    s_add_u32 s14, s41, 147456
    s_add_u32 s15, s41, 221184
    s_cmp_eq_u32 s31, 0
    s_cselect_b32 s52, s14, s15
    v_mfma_f32_16x16x32_bf16 v[116:119], v[44:47], a[20:23], v[116:119]
    ds_read_b64_tr_b16 v[58:59], v6 offset:8448
    v_mfma_f32_16x16x32_bf16 v[132:135], v[40:43], a[8:11], 0
    v_mfma_f32_16x16x32_bf16 v[132:135], v[44:47], a[24:27], v[132:135]
    ds_read_b64_tr_b16 v[60:61], v6 offset:10240
    v_mfma_f32_16x16x32_bf16 v[148:151], v[40:43], a[12:15], 0
    v_mfma_f32_16x16x32_bf16 v[148:151], v[44:47], a[28:31], v[148:151]
    ds_read_b64_tr_b16 v[62:63], v6 offset:10496
    s_waitcnt lgkmcnt(4)
    v_mfma_f32_16x16x32_bf16 v[104:107], v[48:51], a[0:3], 0
    v_mul_f32 v28, v24, v160
    v_mul_f32 v29, v24, v161
    v_mfma_f32_16x16x32_bf16 v[104:107], v[52:55], a[16:19], v[104:107]
    ds_read_b64_tr_b16 v[40:41], v6 offset:12288
    v_exp_f32 v28, v28
    v_mfma_f32_16x16x32_bf16 v[120:123], v[48:51], a[4:7], 0
    buffer_load_dwordx4 v8, s[20:23], s52 offen offset:0 lds
    v_exp_f32 v29, v29
    v_mfma_f32_16x16x32_bf16 v[120:123], v[52:55], a[20:23], v[120:123]
    ds_read_b64_tr_b16 v[42:43], v6 offset:12544
    v_mul_f32 v30, v160, v164
    v_mul_f32 v31, v161, v165
    v_mfma_f32_16x16x32_bf16 v[136:139], v[48:51], a[8:11], 0
    buffer_load_dwordx4 v9, s[20:23], s52 offen offset:1024 lds
    v_add_f32 v28, 1.0, v28
    v_add_f32 v29, 1.0, v29
    v_mfma_f32_16x16x32_bf16 v[136:139], v[52:55], a[24:27], v[136:139]
    ds_read_b64_tr_b16 v[44:45], v6 offset:14336
    v_rcp_f32 v28, v28
    v_rcp_f32 v29, v29
    v_mfma_f32_16x16x32_bf16 v[152:155], v[48:51], a[12:15], 0
    buffer_load_dwordx4 v10, s[20:23], s52 offen offset:2048 lds
    v_mul_f32 v30, v30, v28
    v_mfma_f32_16x16x32_bf16 v[152:155], v[52:55], a[28:31], v[152:155]
    ds_read_b64_tr_b16 v[46:47], v6 offset:14592
    v_mul_f32 v31, v31, v29
    v_cvt_pk_bf16_f32 v160, v30, v31
    v_mul_f32 v32, v24, v162
    s_waitcnt lgkmcnt(4)
    v_mfma_f32_16x16x32_bf16 v[100:103], v[56:59], a[32:35], v[100:103]
    v_mul_f32 v33, v24, v163
    v_exp_f32 v32, v32
    v_mfma_f32_16x16x32_bf16 v[100:103], v[60:63], a[48:51], v[100:103]
    ds_read_b64_tr_b16 v[48:49], v6 offset:16384
    v_exp_f32 v33, v33
    v_mfma_f32_16x16x32_bf16 v[116:119], v[56:59], a[36:39], v[116:119]
    buffer_load_dwordx4 v11, s[20:23], s52 offen offset:3072 lds
    v_mul_f32 v34, v162, v166
    v_mul_f32 v35, v163, v167
    v_mfma_f32_16x16x32_bf16 v[116:119], v[60:63], a[52:55], v[116:119]
    s_add_u32 m0, s40, 40960
    ds_read_b64_tr_b16 v[50:51], v6 offset:16640
    v_add_f32 v32, 1.0, v32
    v_add_f32 v33, 1.0, v33
    v_mfma_f32_16x16x32_bf16 v[132:135], v[56:59], a[40:43], v[132:135]
    v_rcp_f32 v32, v32
    v_rcp_f32 v33, v33
    v_mfma_f32_16x16x32_bf16 v[132:135], v[60:63], a[56:59], v[132:135]
    ds_read_b64_tr_b16 v[52:53], v6 offset:18432
    v_mul_f32 v34, v34, v32
    v_mfma_f32_16x16x32_bf16 v[148:151], v[56:59], a[44:47], v[148:151]
    buffer_load_dwordx4 v12, s[20:23], s52 offen offset:0 lds
    v_mul_f32 v35, v35, v33
    v_cvt_pk_bf16_f32 v161, v34, v35
    v_mfma_f32_16x16x32_bf16 v[148:151], v[60:63], a[60:63], v[148:151]
    ds_read_b64_tr_b16 v[54:55], v6 offset:18688
    v_mul_f32 v28, v24, v168
    v_mul_f32 v29, v24, v169
    v_exp_f32 v28, v28
    s_waitcnt lgkmcnt(4)
    v_mfma_f32_16x16x32_bf16 v[104:107], v[40:43], a[32:35], v[104:107]
    buffer_load_dwordx4 v13, s[20:23], s52 offen offset:1024 lds
    v_exp_f32 v29, v29
    v_mfma_f32_16x16x32_bf16 v[104:107], v[44:47], a[48:51], v[104:107]
    ds_read_b64_tr_b16 v[56:57], v6 offset:20480
    v_mul_f32 v30, v168, v172
    v_mul_f32 v31, v169, v173
    v_mfma_f32_16x16x32_bf16 v[120:123], v[40:43], a[36:39], v[120:123]
    buffer_load_dwordx4 v14, s[20:23], s52 offen offset:2048 lds
    v_add_f32 v28, 1.0, v28
    v_add_f32 v29, 1.0, v29
    v_mfma_f32_16x16x32_bf16 v[120:123], v[44:47], a[52:55], v[120:123]
    ds_read_b64_tr_b16 v[58:59], v6 offset:20736
    v_rcp_f32 v28, v28
    v_mfma_f32_16x16x32_bf16 v[136:139], v[40:43], a[40:43], v[136:139]
    v_rcp_f32 v29, v29
    v_mul_f32 v30, v30, v28
    v_mfma_f32_16x16x32_bf16 v[136:139], v[44:47], a[56:59], v[136:139]
    ds_read_b64_tr_b16 v[60:61], v6 offset:22528
    v_mul_f32 v31, v31, v29
    v_cvt_pk_bf16_f32 v162, v30, v31
    v_mfma_f32_16x16x32_bf16 v[152:155], v[40:43], a[44:47], v[152:155]
    buffer_load_dwordx4 v17, s[20:23], s52 offen offset:3072 lds
    v_mul_f32 v32, v24, v170
    v_mul_f32 v33, v24, v171
    v_exp_f32 v32, v32
    v_mfma_f32_16x16x32_bf16 v[152:155], v[44:47], a[60:63], v[152:155]
    ds_read_b64_tr_b16 v[62:63], v6 offset:22784
    v_exp_f32 v33, v33
    s_waitcnt lgkmcnt(4)
    v_mfma_f32_16x16x32_bf16 v[100:103], v[48:51], a[64:67], v[100:103]
    s_waitcnt vmcnt(36)
    s_barrier
    v_mul_f32 v34, v170, v174
    v_mfma_f32_16x16x32_bf16 v[100:103], v[52:55], a[80:83], v[100:103]
    s_add_u32 m0, s40, 45056
    ds_read_b64_tr_b16 v[40:41], v6 offset:24576
    v_mul_f32 v35, v171, v175
    v_add_f32 v32, 1.0, v32
    v_add_f32 v33, 1.0, v33
    v_mfma_f32_16x16x32_bf16 v[116:119], v[48:51], a[68:71], v[116:119]
    v_rcp_f32 v32, v32
    v_mfma_f32_16x16x32_bf16 v[116:119], v[52:55], a[84:87], v[116:119]
    ds_read_b64_tr_b16 v[42:43], v6 offset:24832
    v_rcp_f32 v33, v33
    v_mul_f32 v34, v34, v32
    v_mfma_f32_16x16x32_bf16 v[132:135], v[48:51], a[72:75], v[132:135]
    v_mul_f32 v35, v35, v33
    v_cvt_pk_bf16_f32 v163, v34, v35
    v_mfma_f32_16x16x32_bf16 v[132:135], v[52:55], a[88:91], v[132:135]
    ds_read_b64_tr_b16 v[44:45], v6 offset:26624
    buffer_store_dwordx4 v[160:163], v1, s[24:27], s47 offen offset:0 sc1
    v_mfma_f32_16x16x32_bf16 v[148:151], v[48:51], a[76:79], v[148:151]
    v_mul_f32 v28, v25, v176
    v_mul_f32 v29, v25, v177
    v_mfma_f32_16x16x32_bf16 v[148:151], v[52:55], a[92:95], v[148:151]
    ds_read_b64_tr_b16 v[46:47], v6 offset:26880
    s_waitcnt lgkmcnt(4)
    v_mfma_f32_16x16x32_bf16 v[104:107], v[56:59], a[64:67], v[104:107]
    v_exp_f32 v28, v28
    v_mfma_f32_16x16x32_bf16 v[104:107], v[60:63], a[80:83], v[104:107]
    ds_read_b64_tr_b16 v[48:49], v6 offset:28672
    v_exp_f32 v29, v29
    v_mfma_f32_16x16x32_bf16 v[120:123], v[56:59], a[68:71], v[120:123]
    v_mul_f32 v30, v176, v180
    v_mul_f32 v31, v177, v181
    v_mfma_f32_16x16x32_bf16 v[120:123], v[60:63], a[84:87], v[120:123]
    ds_read_b64_tr_b16 v[50:51], v6 offset:28928
    v_add_f32 v28, 1.0, v28
    v_add_f32 v29, 1.0, v29
    v_rcp_f32 v28, v28
    v_mfma_f32_16x16x32_bf16 v[136:139], v[56:59], a[72:75], v[136:139]
    v_rcp_f32 v29, v29
    s_waitcnt vmcnt(15)
    v_mov_b32 v37, 1
    s_mov_b64 exec, 1
    buffer_store_dword v37, off, s[24:27], s49 offset:0 sc1
    s_mov_b64 exec, -1
    v_mfma_f32_16x16x32_bf16 v[136:139], v[60:63], a[88:91], v[136:139]
    ds_read_b64_tr_b16 v[52:53], v6 offset:30720
    v_mul_f32 v30, v30, v28
    v_mul_f32 v31, v31, v29
    v_mfma_f32_16x16x32_bf16 v[152:155], v[56:59], a[76:79], v[152:155]
    buffer_load_dwordx4 v18, s[20:23], s52 offen offset:0 lds
    v_cvt_pk_bf16_f32 v176, v30, v31
    v_mul_f32 v32, v25, v178
    v_mfma_f32_16x16x32_bf16 v[152:155], v[60:63], a[92:95], v[152:155]
    ds_read_b64_tr_b16 v[54:55], v6 offset:30976
    v_mul_f32 v33, v25, v179
    v_exp_f32 v32, v32
    s_waitcnt lgkmcnt(4)
    v_mfma_f32_16x16x32_bf16 v[100:103], v[40:43], a[96:99], v[100:103]
    v_exp_f32 v33, v33
    v_mfma_f32_16x16x32_bf16 v[100:103], v[44:47], a[112:115], v[100:103]
    ds_read_b64_tr_b16 v[56:57], v6 offset:32768
    v_mul_f32 v34, v178, v182
    v_mul_f32 v35, v179, v183
    v_mfma_f32_16x16x32_bf16 v[116:119], v[40:43], a[100:103], v[116:119]
    v_add_f32 v32, 1.0, v32
    v_add_f32 v33, 1.0, v33
    v_mfma_f32_16x16x32_bf16 v[116:119], v[44:47], a[116:119], v[116:119]
    ds_read_b64_tr_b16 v[58:59], v6 offset:33024
    v_rcp_f32 v32, v32
    v_rcp_f32 v33, v33
    v_mfma_f32_16x16x32_bf16 v[132:135], v[40:43], a[104:107], v[132:135]
    v_mul_f32 v34, v34, v32
    v_mul_f32 v35, v35, v33
    v_mfma_f32_16x16x32_bf16 v[132:135], v[44:47], a[120:123], v[132:135]
    ds_read_b64_tr_b16 v[60:61], v6 offset:34816
    v_cvt_pk_bf16_f32 v177, v34, v35
    v_mul_f32 v28, v25, v184
    v_mfma_f32_16x16x32_bf16 v[148:151], v[40:43], a[108:111], v[148:151]
    v_mul_f32 v29, v25, v185
    v_exp_f32 v28, v28
    v_mfma_f32_16x16x32_bf16 v[148:151], v[44:47], a[124:127], v[148:151]
    ds_read_b64_tr_b16 v[62:63], v6 offset:35072
    v_exp_f32 v29, v29
    s_waitcnt lgkmcnt(4)
    v_mfma_f32_16x16x32_bf16 v[104:107], v[48:51], a[96:99], v[104:107]
    v_mul_f32 v30, v184, v188
    v_mul_f32 v31, v185, v189
    v_mfma_f32_16x16x32_bf16 v[104:107], v[52:55], a[112:115], v[104:107]
    ds_read_b64_tr_b16 v[40:41], v6 offset:36864
    v_add_f32 v28, 1.0, v28
    v_add_f32 v29, 1.0, v29
    v_mfma_f32_16x16x32_bf16 v[120:123], v[48:51], a[100:103], v[120:123]
    v_rcp_f32 v28, v28
    v_rcp_f32 v29, v29
    v_mfma_f32_16x16x32_bf16 v[120:123], v[52:55], a[116:119], v[120:123]
    ds_read_b64_tr_b16 v[42:43], v6 offset:37120
    v_mul_f32 v30, v30, v28
    v_mfma_f32_16x16x32_bf16 v[136:139], v[48:51], a[104:107], v[136:139]
    v_mul_f32 v31, v31, v29
    v_cvt_pk_bf16_f32 v178, v30, v31
    v_mfma_f32_16x16x32_bf16 v[136:139], v[52:55], a[120:123], v[136:139]
    ds_read_b64_tr_b16 v[44:45], v6 offset:38912
    v_mul_f32 v32, v25, v186
    v_mul_f32 v33, v25, v187
    v_exp_f32 v32, v32
    v_mfma_f32_16x16x32_bf16 v[152:155], v[48:51], a[108:111], v[152:155]
    v_exp_f32 v33, v33
    v_mfma_f32_16x16x32_bf16 v[152:155], v[52:55], a[124:127], v[152:155]
    ds_read_b64_tr_b16 v[46:47], v6 offset:39168
    v_mul_f32 v34, v186, v190
    v_mul_f32 v35, v187, v191
    s_waitcnt lgkmcnt(4)
    v_mfma_f32_16x16x32_bf16 v[100:103], v[56:59], a[128:131], v[100:103]
    s_waitcnt vmcnt(30)
    s_barrier
    v_add_f32 v32, 1.0, v32
    v_add_f32 v33, 1.0, v33
    v_mfma_f32_16x16x32_bf16 v[100:103], v[60:63], a[144:147], v[100:103]
    s_add_u32 m0, s40, 73728
    ds_read_b64_tr_b16 v[48:49], v6 offset:40960
    v_rcp_f32 v32, v32
    v_mfma_f32_16x16x32_bf16 v[116:119], v[56:59], a[132:135], v[116:119]
    s_add_u32 s14, s42, 0
    s_add_u32 s15, s43, 0
    s_cmp_eq_u32 s31, 0
    s_cselect_b32 s52, s14, s15
    v_rcp_f32 v33, v33
    v_mul_f32 v34, v34, v32
    v_mfma_f32_16x16x32_bf16 v[116:119], v[60:63], a[148:151], v[116:119]
    ds_read_b64_tr_b16 v[50:51], v6 offset:41216
    v_mul_f32 v35, v35, v33
    v_cvt_pk_bf16_f32 v179, v34, v35
    v_mfma_f32_16x16x32_bf16 v[132:135], v[56:59], a[136:139], v[132:135]
    buffer_store_dwordx4 v[176:179], v1, s[24:27], s47 offen offset:1024 sc1
    v_mfma_f32_16x16x32_bf16 v[132:135], v[60:63], a[152:155], v[132:135]
    ds_read_b64_tr_b16 v[52:53], v6 offset:43008
    v_mul_f32 v28, v26, v192
    v_mfma_f32_16x16x32_bf16 v[148:151], v[56:59], a[140:143], v[148:151]
    v_mul_f32 v29, v26, v193
    v_mul_f32 v30, v192, v196
    v_mfma_f32_16x16x32_bf16 v[148:151], v[60:63], a[156:159], v[148:151]
    ds_read_b64_tr_b16 v[54:55], v6 offset:43264
    v_exp_f32 v28, v28
    s_waitcnt lgkmcnt(4)
    v_mfma_f32_16x16x32_bf16 v[104:107], v[40:43], a[128:131], v[104:107]
    v_exp_f32 v29, v29
    v_mfma_f32_16x16x32_bf16 v[104:107], v[44:47], a[144:147], v[104:107]
    ds_read_b64_tr_b16 v[56:57], v6 offset:45056
    v_mul_f32 v31, v193, v197
    v_add_f32 v28, 1.0, v28
    v_mfma_f32_16x16x32_bf16 v[120:123], v[40:43], a[132:135], v[120:123]
    buffer_load_dwordx4 v8, s[20:23], s52 offen offset:0 lds
    v_add_f32 v29, 1.0, v29
    v_rcp_f32 v28, v28
    v_mfma_f32_16x16x32_bf16 v[120:123], v[44:47], a[148:151], v[120:123]
    ds_read_b64_tr_b16 v[58:59], v6 offset:45312
    v_rcp_f32 v29, v29
    v_mfma_f32_16x16x32_bf16 v[136:139], v[40:43], a[136:139], v[136:139]
    buffer_load_dwordx4 v9, s[20:23], s52 offen offset:1024 lds
    v_mul_f32 v30, v30, v28
    v_mul_f32 v31, v31, v29
    v_mfma_f32_16x16x32_bf16 v[136:139], v[44:47], a[152:155], v[136:139]
    ds_read_b64_tr_b16 v[60:61], v6 offset:47104
    v_cvt_pk_bf16_f32 v192, v30, v31
    v_mul_f32 v32, v26, v194
    v_mfma_f32_16x16x32_bf16 v[152:155], v[40:43], a[140:143], v[152:155]
    buffer_load_dwordx4 v10, s[20:23], s52 offen offset:2048 lds
    v_mul_f32 v33, v26, v195
    v_exp_f32 v32, v32
    v_mfma_f32_16x16x32_bf16 v[152:155], v[44:47], a[156:159], v[152:155]
    ds_read_b64_tr_b16 v[62:63], v6 offset:47360
    v_exp_f32 v33, v33
    s_waitcnt lgkmcnt(4)
    v_mfma_f32_16x16x32_bf16 v[100:103], v[48:51], a[160:163], v[100:103]
    v_mul_f32 v34, v194, v198
    v_mul_f32 v35, v195, v199
    v_mfma_f32_16x16x32_bf16 v[100:103], v[52:55], a[176:179], v[100:103]
    ds_read_b64_tr_b16 v[40:41], v6 offset:49152
    v_add_f32 v32, 1.0, v32
    v_add_f32 v33, 1.0, v33
    v_rcp_f32 v32, v32
    v_mfma_f32_16x16x32_bf16 v[116:119], v[48:51], a[164:167], v[116:119]
    buffer_load_dwordx4 v11, s[20:23], s52 offen offset:3072 lds
    v_rcp_f32 v33, v33
    v_mfma_f32_16x16x32_bf16 v[116:119], v[52:55], a[180:183], v[116:119]
    s_add_u32 m0, s40, 77824
    ds_read_b64_tr_b16 v[42:43], v6 offset:49408
    v_mul_f32 v34, v34, v32
    v_mul_f32 v35, v35, v33
    v_mfma_f32_16x16x32_bf16 v[132:135], v[48:51], a[168:171], v[132:135]
    v_cvt_pk_bf16_f32 v193, v34, v35
    v_mul_f32 v28, v26, v200
    v_mfma_f32_16x16x32_bf16 v[132:135], v[52:55], a[184:187], v[132:135]
    ds_read_b64_tr_b16 v[44:45], v6 offset:51200
    v_mul_f32 v29, v26, v201
    v_exp_f32 v28, v28
    v_mfma_f32_16x16x32_bf16 v[148:151], v[48:51], a[172:175], v[148:151]
    buffer_load_dwordx4 v12, s[20:23], s52 offen offset:0 lds
    v_exp_f32 v29, v29
    v_mfma_f32_16x16x32_bf16 v[148:151], v[52:55], a[188:191], v[148:151]
    ds_read_b64_tr_b16 v[46:47], v6 offset:51456
    v_mul_f32 v30, v200, v204
    v_mul_f32 v31, v201, v205
    s_waitcnt lgkmcnt(4)
    v_mfma_f32_16x16x32_bf16 v[104:107], v[56:59], a[160:163], v[104:107]
    buffer_load_dwordx4 v13, s[20:23], s52 offen offset:1024 lds
    v_add_f32 v28, 1.0, v28
    v_add_f32 v29, 1.0, v29
    v_rcp_f32 v28, v28
    v_mfma_f32_16x16x32_bf16 v[104:107], v[60:63], a[176:179], v[104:107]
    ds_read_b64_tr_b16 v[48:49], v6 offset:53248
    v_rcp_f32 v29, v29
    v_mfma_f32_16x16x32_bf16 v[120:123], v[56:59], a[164:167], v[120:123]
    buffer_load_dwordx4 v14, s[20:23], s52 offen offset:2048 lds
    v_mul_f32 v30, v30, v28
    v_mfma_f32_16x16x32_bf16 v[120:123], v[60:63], a[180:183], v[120:123]
    ds_read_b64_tr_b16 v[50:51], v6 offset:53504
    v_mul_f32 v31, v31, v29
    v_cvt_pk_bf16_f32 v194, v30, v31
    v_mul_f32 v32, v26, v202
    v_mfma_f32_16x16x32_bf16 v[136:139], v[56:59], a[168:171], v[136:139]
    v_mul_f32 v33, v26, v203
    v_exp_f32 v32, v32
    v_mfma_f32_16x16x32_bf16 v[136:139], v[60:63], a[184:187], v[136:139]
    ds_read_b64_tr_b16 v[52:53], v6 offset:55296
    v_exp_f32 v33, v33
    v_mfma_f32_16x16x32_bf16 v[152:155], v[56:59], a[172:175], v[152:155]
    buffer_load_dwordx4 v17, s[20:23], s52 offen offset:3072 lds
    v_mul_f32 v34, v202, v206
    v_mul_f32 v35, v203, v207
    buffer_load_dword v23, v21, s[24:27], 0 offen offset:0 sc1
    v_mfma_f32_16x16x32_bf16 v[152:155], v[60:63], a[188:191], v[152:155]
    ds_read_b64_tr_b16 v[54:55], v6 offset:55552
    v_add_f32 v32, 1.0, v32
    v_add_f32 v33, 1.0, v33
    s_waitcnt lgkmcnt(4)
    v_mfma_f32_16x16x32_bf16 v[100:103], v[40:43], a[192:195], v[100:103]
    s_waitcnt vmcnt(38)
    s_barrier
    v_rcp_f32 v32, v32
    v_rcp_f32 v33, v33
    v_mfma_f32_16x16x32_bf16 v[100:103], v[44:47], a[208:211], v[100:103]
    s_add_u32 m0, s40, 81920
    ds_read_b64_tr_b16 v[56:57], v6 offset:57344
    v_mul_f32 v34, v34, v32
    v_mfma_f32_16x16x32_bf16 v[116:119], v[40:43], a[196:199], v[116:119]
    v_mul_f32 v35, v35, v33
    v_cvt_pk_bf16_f32 v195, v34, v35
    v_mfma_f32_16x16x32_bf16 v[116:119], v[44:47], a[212:215], v[116:119]
    ds_read_b64_tr_b16 v[58:59], v6 offset:57600
    buffer_store_dwordx4 v[192:195], v1, s[24:27], s47 offen offset:2048 sc1
    v_mfma_f32_16x16x32_bf16 v[132:135], v[40:43], a[200:203], v[132:135]
    v_mul_f32 v28, v27, v208
    v_mul_f32 v29, v27, v209
    v_mfma_f32_16x16x32_bf16 v[132:135], v[44:47], a[216:219], v[132:135]
    ds_read_b64_tr_b16 v[60:61], v6 offset:59392
    s_mov_b32 s60, 34816
    buffer_load_dword v38, v39, s[4:7], s60 offen sc0 sc1
    v_mfma_f32_16x16x32_bf16 v[148:151], v[40:43], a[204:207], v[148:151]
    v_exp_f32 v28, v28
    v_mfma_f32_16x16x32_bf16 v[148:151], v[44:47], a[220:223], v[148:151]
    ds_read_b64_tr_b16 v[62:63], v6 offset:59648
    v_exp_f32 v29, v29
    s_waitcnt lgkmcnt(4)
    v_mfma_f32_16x16x32_bf16 v[104:107], v[48:51], a[192:195], v[104:107]
    v_mul_f32 v30, v208, v212
    v_mul_f32 v31, v209, v213
    v_add_f32 v28, 1.0, v28
    v_mfma_f32_16x16x32_bf16 v[104:107], v[52:55], a[208:211], v[104:107]
    ds_read_b64_tr_b16 v[40:41], v6 offset:61440
    v_add_f32 v29, 1.0, v29
    v_rcp_f32 v28, v28
    v_mfma_f32_16x16x32_bf16 v[120:123], v[48:51], a[196:199], v[120:123]
    v_rcp_f32 v29, v29
    v_mfma_f32_16x16x32_bf16 v[120:123], v[52:55], a[212:215], v[120:123]
    ds_read_b64_tr_b16 v[42:43], v6 offset:61696
    v_mul_f32 v30, v30, v28
    v_mul_f32 v31, v31, v29
    v_mfma_f32_16x16x32_bf16 v[136:139], v[48:51], a[200:203], v[136:139]
    v_cvt_pk_bf16_f32 v208, v30, v31
    v_mul_f32 v32, v27, v210
    v_mfma_f32_16x16x32_bf16 v[136:139], v[52:55], a[216:219], v[136:139]
    ds_read_b64_tr_b16 v[44:45], v6 offset:63488
    v_mul_f32 v33, v27, v211
    v_exp_f32 v32, v32
    v_mfma_f32_16x16x32_bf16 v[152:155], v[48:51], a[204:207], v[152:155]
    buffer_load_dwordx4 v18, s[20:23], s52 offen offset:0 lds
    v_exp_f32 v33, v33
    v_mfma_f32_16x16x32_bf16 v[152:155], v[52:55], a[220:223], v[152:155]
    ds_read_b64_tr_b16 v[46:47], v6 offset:63744
    v_mul_f32 v34, v210, v214
    v_mul_f32 v35, v211, v215
    v_add_f32 v32, 1.0, v32
    s_waitcnt lgkmcnt(4)
    v_mfma_f32_16x16x32_bf16 v[100:103], v[56:59], a[224:227], v[100:103]
    v_add_f32 v33, 1.0, v33
    v_rcp_f32 v32, v32
    v_mfma_f32_16x16x32_bf16 v[100:103], v[60:63], a[240:243], v[100:103]
    v_add_u32 v6, 65536, v6
    ds_read_b64_tr_b16 v[48:49], v6 offset:0
    v_rcp_f32 v33, v33
    v_mfma_f32_16x16x32_bf16 v[116:119], v[56:59], a[228:231], v[116:119]
    v_mul_f32 v34, v34, v32
    v_mul_f32 v35, v35, v33
    v_mfma_f32_16x16x32_bf16 v[116:119], v[60:63], a[244:247], v[116:119]
    ds_read_b64_tr_b16 v[50:51], v6 offset:256
    v_cvt_pk_bf16_f32 v209, v34, v35
    v_mul_f32 v28, v27, v216
    v_mfma_f32_16x16x32_bf16 v[132:135], v[56:59], a[232:235], v[132:135]
    v_mul_f32 v29, v27, v217
    v_exp_f32 v28, v28
    v_mfma_f32_16x16x32_bf16 v[132:135], v[60:63], a[248:251], v[132:135]
    ds_read_b64_tr_b16 v[52:53], v6 offset:2048
    v_exp_f32 v29, v29
    v_mfma_f32_16x16x32_bf16 v[148:151], v[56:59], a[236:239], v[148:151]
    v_mul_f32 v30, v216, v220
    v_mul_f32 v31, v217, v221
    v_mfma_f32_16x16x32_bf16 v[148:151], v[60:63], a[252:255], v[148:151]
    ds_read_b64_tr_b16 v[54:55], v6 offset:2304
    v_add_f32 v28, 1.0, v28
    v_add_f32 v29, 1.0, v29
    v_rcp_f32 v28, v28
    s_waitcnt lgkmcnt(4)
    v_mfma_f32_16x16x32_bf16 v[104:107], v[40:43], a[224:227], v[104:107]
    v_rcp_f32 v29, v29
    v_mfma_f32_16x16x32_bf16 v[104:107], v[44:47], a[240:243], v[104:107]
    ds_read_b64_tr_b16 v[56:57], v6 offset:4096
    v_mul_f32 v30, v30, v28
    v_mul_f32 v31, v31, v29
    v_mfma_f32_16x16x32_bf16 v[120:123], v[40:43], a[228:231], v[120:123]
    v_cvt_pk_bf16_f32 v210, v30, v31
    v_mul_f32 v32, v27, v218
    v_mfma_f32_16x16x32_bf16 v[120:123], v[44:47], a[244:247], v[120:123]
    ds_read_b64_tr_b16 v[58:59], v6 offset:4352
    v_mul_f32 v33, v27, v219
    v_exp_f32 v32, v32
    v_mfma_f32_16x16x32_bf16 v[136:139], v[40:43], a[232:235], v[136:139]
    v_exp_f32 v33, v33
    v_mfma_f32_16x16x32_bf16 v[136:139], v[44:47], a[248:251], v[136:139]
    ds_read_b64_tr_b16 v[60:61], v6 offset:6144
    v_mul_f32 v34, v218, v222
    v_mul_f32 v35, v219, v223
    v_mfma_f32_16x16x32_bf16 v[152:155], v[40:43], a[236:239], v[152:155]
    v_add_f32 v32, 1.0, v32
    v_add_f32 v33, 1.0, v33
    v_rcp_f32 v32, v32
    v_mfma_f32_16x16x32_bf16 v[152:155], v[44:47], a[252:255], v[152:155]
    ds_read_b64_tr_b16 v[62:63], v6 offset:6400
    v_rcp_f32 v33, v33
    s_waitcnt lgkmcnt(4)
    v_mfma_f32_16x16x32_bf16 v[100:103], v[48:51], v[64:67], v[100:103]
    s_waitcnt vmcnt(24)
    s_barrier
    v_mul_f32 v34, v34, v32
    v_mfma_f32_16x16x32_bf16 v[100:103], v[52:55], v[80:83], v[100:103]
    s_add_u32 m0, s40, 110592
    ds_read_b64_tr_b16 v[40:41], v7 offset:0
    v_mul_f32 v35, v35, v33
    v_cvt_pk_bf16_f32 v211, v34, v35
    v_mfma_f32_16x16x32_bf16 v[116:119], v[48:51], v[68:71], v[116:119]
    s_add_u32 s14, s44, 0
    s_add_u32 s15, s42, 73728
    s_cmp_eq_u32 s31, 0
    s_cselect_b32 s52, s14, s15
    v_mfma_f32_16x16x32_bf16 v[116:119], v[52:55], v[84:87], v[116:119]
    ds_read_b64_tr_b16 v[42:43], v7 offset:2304
    buffer_store_dwordx4 v[208:211], v1, s[24:27], s47 offen offset:3072 sc1
    s_add_u32 s47, s47, 4096
    v_mfma_f32_16x16x32_bf16 v[132:135], v[48:51], v[72:75], v[132:135]
    v_mfma_f32_16x16x32_bf16 v[132:135], v[52:55], v[88:91], v[132:135]
    ds_read_b64_tr_b16 v[44:45], v7 offset:9216
    v_mfma_f32_16x16x32_bf16 v[148:151], v[48:51], v[76:79], v[148:151]
    v_mfma_f32_16x16x32_bf16 v[148:151], v[52:55], v[92:95], v[148:151]
    ds_read_b64_tr_b16 v[46:47], v7 offset:11520
    s_waitcnt lgkmcnt(4)
    v_mfma_f32_16x16x32_bf16 v[104:107], v[56:59], v[64:67], v[104:107]
    buffer_load_dwordx4 v8, s[20:23], s52 offen offset:0 lds
    v_mfma_f32_16x16x32_bf16 v[104:107], v[60:63], v[80:83], v[104:107]
    ds_read_b64_tr_b16 v[48:49], v7 offset:32
    v_mfma_f32_16x16x32_bf16 v[120:123], v[56:59], v[68:71], v[120:123]
    buffer_load_dwordx4 v9, s[20:23], s52 offen offset:1024 lds
    v_mfma_f32_16x16x32_bf16 v[120:123], v[60:63], v[84:87], v[120:123]
    ds_read_b64_tr_b16 v[50:51], v7 offset:2336
    v_mfma_f32_16x16x32_bf16 v[136:139], v[56:59], v[72:75], v[136:139]
    buffer_load_dwordx4 v10, s[20:23], s52 offen offset:2048 lds
    v_mfma_f32_16x16x32_bf16 v[136:139], v[60:63], v[88:91], v[136:139]
    ds_read_b64_tr_b16 v[52:53], v7 offset:9248
    v_mfma_f32_16x16x32_bf16 v[152:155], v[56:59], v[76:79], v[152:155]
    buffer_load_dwordx4 v11, s[20:23], s52 offen offset:3072 lds
    v_mfma_f32_16x16x32_bf16 v[152:155], v[60:63], v[92:95], v[152:155]
    ds_read_b64_tr_b16 v[54:55], v7 offset:11552
    s_waitcnt lgkmcnt(4)
    v_mfma_f32_16x16x32_bf16 a[0:3], v[40:43], v[224:227], 0
    s_barrier
    v_mfma_f32_16x16x32_bf16 a[0:3], v[44:47], v[240:243], a[0:3]
    s_add_u32 m0, s40, 114688
    ds_read_b64_tr_b16 v[56:57], v7 offset:64
    v_mfma_f32_16x16x32_bf16 a[4:7], v[40:43], v[228:231], 0
    s_waitcnt vmcnt(8)
    v_cmp_eq_u32 vcc, 0, v23
    s_nop 4
    s_cbranch_vccnz L_k4_spin0
L_k4_back0:
    v_mfma_f32_16x16x32_bf16 a[4:7], v[44:47], v[244:247], a[4:7]
    s_add_u32 s57, s48, 0
    ds_read_b64_tr_b16 v[58:59], v7 offset:2368
    v_mfma_f32_16x16x32_bf16 a[8:11], v[40:43], v[232:235], 0
    v_mfma_f32_16x16x32_bf16 a[8:11], v[44:47], v[248:251], a[8:11]
    ds_read_b64_tr_b16 v[60:61], v7 offset:9280
    v_mfma_f32_16x16x32_bf16 a[12:15], v[40:43], v[236:239], 0
    v_lshlrev_b32 v36, 3, v0
    v_mul_f32 v28, v24, v100
    v_mfma_f32_16x16x32_bf16 a[12:15], v[44:47], v[252:255], a[12:15]
    ds_read_b64_tr_b16 v[62:63], v7 offset:11584
    v_mul_f32 v29, v24, v101
    v_exp_f32 v28, v28
    s_waitcnt lgkmcnt(4)
    v_mfma_f32_16x16x32_bf16 a[16:19], v[48:51], v[224:227], 0
    buffer_load_dwordx4 v12, s[20:23], s52 offen offset:0 lds
    v_exp_f32 v29, v29
    v_mfma_f32_16x16x32_bf16 a[16:19], v[52:55], v[240:243], a[16:19]
    ds_read_b64_tr_b16 v[40:41], v7 offset:96
    v_mul_f32 v30, v100, v104
    v_mul_f32 v31, v101, v105
    v_add_f32 v28, 1.0, v28
    v_mfma_f32_16x16x32_bf16 a[20:23], v[48:51], v[228:231], 0
    v_add_f32 v29, 1.0, v29
    v_rcp_f32 v28, v28
    v_mfma_f32_16x16x32_bf16 a[20:23], v[52:55], v[244:247], a[20:23]
    ds_read_b64_tr_b16 v[42:43], v7 offset:2400
    v_rcp_f32 v29, v29
    v_mul_f32 v30, v30, v28
    v_mfma_f32_16x16x32_bf16 a[24:27], v[48:51], v[232:235], 0
    v_mul_f32 v31, v31, v29
    v_cvt_pk_bf16_f32 v108, v30, v31
    v_mul_f32 v32, v24, v102
    v_mfma_f32_16x16x32_bf16 a[24:27], v[52:55], v[248:251], a[24:27]
    ds_read_b64_tr_b16 v[44:45], v7 offset:9312
    v_mul_f32 v33, v24, v103
    v_exp_f32 v32, v32
    v_mfma_f32_16x16x32_bf16 a[28:31], v[48:51], v[236:239], 0
    v_exp_f32 v33, v33
    v_mul_f32 v34, v102, v106
    v_mfma_f32_16x16x32_bf16 a[28:31], v[52:55], v[252:255], a[28:31]
    ds_read_b64_tr_b16 v[46:47], v7 offset:11616
    v_mul_f32 v35, v103, v107
    v_add_f32 v32, 1.0, v32
    v_add_f32 v33, 1.0, v33
    s_waitcnt lgkmcnt(4)
    v_mfma_f32_16x16x32_bf16 a[32:35], v[56:59], v[224:227], 0
    v_rcp_f32 v32, v32
    v_rcp_f32 v33, v33
    v_mfma_f32_16x16x32_bf16 a[32:35], v[60:63], v[240:243], a[32:35]
    ds_read_b64_tr_b16 v[48:49], v7 offset:128
    v_mul_f32 v34, v34, v32
    v_mul_f32 v35, v35, v33
    v_mfma_f32_16x16x32_bf16 a[36:39], v[56:59], v[228:231], 0
    v_cvt_pk_bf16_f32 v109, v34, v35
    buffer_store_dwordx2 v[108:109], v36, s[24:27], s47 offen offset:0 sc1
    v_mfma_f32_16x16x32_bf16 a[36:39], v[60:63], v[244:247], a[36:39]
    ds_read_b64_tr_b16 v[50:51], v7 offset:2432
    v_mul_f32 v28, v25, v116
    v_mul_f32 v29, v25, v117
    v_mfma_f32_16x16x32_bf16 a[40:43], v[56:59], v[232:235], 0
    buffer_load_dwordx4 v13, s[20:23], s52 offen offset:1024 lds
    v_exp_f32 v28, v28
    v_exp_f32 v29, v29
    v_mfma_f32_16x16x32_bf16 a[40:43], v[60:63], v[248:251], a[40:43]
    ds_read_b64_tr_b16 v[52:53], v7 offset:9344
    v_mul_f32 v30, v116, v120
    v_mul_f32 v31, v117, v121
    v_mfma_f32_16x16x32_bf16 a[44:47], v[56:59], v[236:239], 0
    v_add_f32 v28, 1.0, v28
    v_add_f32 v29, 1.0, v29
    v_rcp_f32 v28, v28
    v_mfma_f32_16x16x32_bf16 a[44:47], v[60:63], v[252:255], a[44:47]
    ds_read_b64_tr_b16 v[54:55], v7 offset:11648
    v_rcp_f32 v29, v29
    s_waitcnt lgkmcnt(4)
    v_mfma_f32_16x16x32_bf16 a[48:51], v[40:43], v[224:227], 0
    v_mul_f32 v30, v30, v28
    v_mul_f32 v31, v31, v29
    v_cvt_pk_bf16_f32 v124, v30, v31
    v_mfma_f32_16x16x32_bf16 a[48:51], v[44:47], v[240:243], a[48:51]
    ds_read_b64_tr_b16 v[56:57], v7 offset:160
    v_mul_f32 v32, v25, v118
    v_mul_f32 v33, v25, v119
    v_exp_f32 v32, v32
    v_mfma_f32_16x16x32_bf16 a[52:55], v[40:43], v[228:231], 0
    v_exp_f32 v33, v33
    v_mfma_f32_16x16x32_bf16 a[52:55], v[44:47], v[244:247], a[52:55]
    ds_read_b64_tr_b16 v[58:59], v7 offset:2464
    v_mul_f32 v34, v118, v122
    v_mul_f32 v35, v119, v123
    v_add_f32 v32, 1.0, v32
    v_mfma_f32_16x16x32_bf16 a[56:59], v[40:43], v[232:235], 0
    v_add_f32 v33, 1.0, v33
    v_rcp_f32 v32, v32
    v_mfma_f32_16x16x32_bf16 a[56:59], v[44:47], v[248:251], a[56:59]
    ds_read_b64_tr_b16 v[60:61], v7 offset:9376
    v_rcp_f32 v33, v33
    v_mul_f32 v34, v34, v32
    v_mfma_f32_16x16x32_bf16 a[60:63], v[40:43], v[236:239], 0
    buffer_load_dwordx4 v14, s[20:23], s52 offen offset:2048 lds
    v_mul_f32 v35, v35, v33
    v_cvt_pk_bf16_f32 v125, v34, v35
    v_mul_f32 v28, v26, v132
    v_mfma_f32_16x16x32_bf16 a[60:63], v[44:47], v[252:255], a[60:63]
    ds_read_b64_tr_b16 v[62:63], v7 offset:11680
    buffer_store_dwordx2 v[124:125], v36, s[24:27], s47 offen offset:512 sc1
    s_waitcnt lgkmcnt(4)
    v_mfma_f32_16x16x32_bf16 a[64:67], v[48:51], v[224:227], 0
    v_mul_f32 v29, v26, v133
    v_exp_f32 v28, v28
    v_mfma_f32_16x16x32_bf16 a[64:67], v[52:55], v[240:243], a[64:67]
    ds_read_b64_tr_b16 v[40:41], v7 offset:192
    v_exp_f32 v29, v29
    v_mul_f32 v30, v132, v136
    v_mfma_f32_16x16x32_bf16 a[68:71], v[48:51], v[228:231], 0
    v_mul_f32 v31, v133, v137
    v_add_f32 v28, 1.0, v28
    v_add_f32 v29, 1.0, v29
    v_mfma_f32_16x16x32_bf16 a[68:71], v[52:55], v[244:247], a[68:71]
    ds_read_b64_tr_b16 v[42:43], v7 offset:2496
    v_rcp_f32 v28, v28
    v_rcp_f32 v29, v29
    v_mfma_f32_16x16x32_bf16 a[72:75], v[48:51], v[232:235], 0
    v_mul_f32 v30, v30, v28
    v_mul_f32 v31, v31, v29
    v_mfma_f32_16x16x32_bf16 a[72:75], v[52:55], v[248:251], a[72:75]
    ds_read_b64_tr_b16 v[44:45], v7 offset:9408
    v_cvt_pk_bf16_f32 v140, v30, v31
    v_mul_f32 v32, v26, v134
    v_mul_f32 v33, v26, v135
    v_mfma_f32_16x16x32_bf16 a[76:79], v[48:51], v[236:239], 0
    v_exp_f32 v32, v32
    v_exp_f32 v33, v33
    v_mfma_f32_16x16x32_bf16 a[76:79], v[52:55], v[252:255], a[76:79]
    ds_read_b64_tr_b16 v[46:47], v7 offset:11712
    v_mul_f32 v34, v134, v138
    v_mul_f32 v35, v135, v139
    s_waitcnt lgkmcnt(4)
    v_mfma_f32_16x16x32_bf16 a[80:83], v[56:59], v[224:227], 0
    v_add_f32 v32, 1.0, v32
    v_add_f32 v33, 1.0, v33
    v_rcp_f32 v32, v32
    v_mfma_f32_16x16x32_bf16 a[80:83], v[60:63], v[240:243], a[80:83]
    ds_read_b64_tr_b16 v[48:49], v7 offset:224
    v_rcp_f32 v33, v33
    v_mfma_f32_16x16x32_bf16 a[84:87], v[56:59], v[228:231], 0
    buffer_load_dwordx4 v17, s[20:23], s52 offen offset:3072 lds
    v_mul_f32 v34, v34, v32
    v_mul_f32 v35, v35, v33
    v_cvt_pk_bf16_f32 v141, v34, v35
    v_mfma_f32_16x16x32_bf16 a[84:87], v[60:63], v[244:247], a[84:87]
    ds_read_b64_tr_b16 v[50:51], v7 offset:2528
    buffer_store_dwordx2 v[140:141], v36, s[24:27], s47 offen offset:1024 sc1
    v_mfma_f32_16x16x32_bf16 a[88:91], v[56:59], v[232:235], 0
    v_mul_f32 v28, v27, v148
    v_mul_f32 v29, v27, v149
    v_exp_f32 v28, v28
    v_mfma_f32_16x16x32_bf16 a[88:91], v[60:63], v[248:251], a[88:91]
    ds_read_b64_tr_b16 v[52:53], v7 offset:9440
    v_exp_f32 v29, v29
    v_mfma_f32_16x16x32_bf16 a[92:95], v[56:59], v[236:239], 0
    v_mul_f32 v30, v148, v152
    v_mul_f32 v31, v149, v153
    v_add_f32 v28, 1.0, v28
    v_mfma_f32_16x16x32_bf16 a[92:95], v[60:63], v[252:255], a[92:95]
    ds_read_b64_tr_b16 v[54:55], v7 offset:11744
    v_add_f32 v29, 1.0, v29
    v_rcp_f32 v28, v28
    s_waitcnt lgkmcnt(4)
    v_mfma_f32_16x16x32_bf16 a[96:99], v[40:43], v[224:227], 0
    v_rcp_f32 v29, v29
    v_mul_f32 v30, v30, v28
    v_mfma_f32_16x16x32_bf16 a[96:99], v[44:47], v[240:243], a[96:99]
    ds_read_b64_tr_b16 v[56:57], v7 offset:256
    v_mul_f32 v31, v31, v29
    v_cvt_pk_bf16_f32 v156, v30, v31
    v_mul_f32 v32, v27, v150
    v_mfma_f32_16x16x32_bf16 a[100:103], v[40:43], v[228:231], 0
    v_mul_f32 v33, v27, v151
    v_exp_f32 v32, v32
    v_mfma_f32_16x16x32_bf16 a[100:103], v[44:47], v[244:247], a[100:103]
    ds_read_b64_tr_b16 v[58:59], v7 offset:2560
    v_exp_f32 v33, v33
    v_mul_f32 v34, v150, v154
    v_mfma_f32_16x16x32_bf16 a[104:107], v[40:43], v[232:235], 0
    v_mul_f32 v35, v151, v155
    v_add_f32 v32, 1.0, v32
    v_add_f32 v33, 1.0, v33
    v_mfma_f32_16x16x32_bf16 a[104:107], v[44:47], v[248:251], a[104:107]
    s_add_u32 m0, s40, 118784
    ds_read_b64_tr_b16 v[60:61], v7 offset:9472
    v_rcp_f32 v32, v32
    v_rcp_f32 v33, v33
    v_mfma_f32_16x16x32_bf16 a[108:111], v[40:43], v[236:239], 0
    v_mul_f32 v34, v34, v32
    v_mul_f32 v35, v35, v33
    v_cvt_pk_bf16_f32 v157, v34, v35
    buffer_store_dwordx2 v[156:157], v36, s[24:27], s47 offen offset:1536 sc1
    v_mfma_f32_16x16x32_bf16 a[108:111], v[44:47], v[252:255], a[108:111]
    ds_read_b64_tr_b16 v[62:63], v7 offset:11776
    s_waitcnt lgkmcnt(4)
    s_waitcnt vmcnt(26)
    s_barrier
    v_mfma_f32_16x16x32_bf16 a[112:115], v[48:51], v[224:227], 0
    buffer_load_dwordx4 a[144:147], v1, s[24:27], s57 offen offset:0 sc1
    buffer_load_dwordx4 a[148:151], v1, s[24:27], s57 offen offset:1024 sc1
    v_mfma_f32_16x16x32_bf16 a[112:115], v[52:55], v[240:243], a[112:115]
    ds_read_b64_tr_b16 v[40:41], v7 offset:36864
    buffer_load_dwordx4 a[152:155], v1, s[24:27], s57 offen offset:2048 sc1
    v_mfma_f32_16x16x32_bf16 a[116:119], v[48:51], v[228:231], 0
    buffer_load_dwordx4 a[156:159], v1, s[24:27], s57 offen offset:3072 sc1
    s_add_u32 s57, s50, 0
    v_mfma_f32_16x16x32_bf16 a[116:119], v[52:55], v[244:247], a[116:119]
    ds_read_b64_tr_b16 v[42:43], v7 offset:39168
    buffer_load_dwordx4 a[160:163], v1, s[24:27], s57 offen offset:0 sc1
    v_mfma_f32_16x16x32_bf16 a[120:123], v[48:51], v[232:235], 0
    buffer_load_dwordx4 v18, s[20:23], s52 offen offset:0 lds
    buffer_load_dwordx4 a[164:167], v1, s[24:27], s57 offen offset:1024 sc1
    v_mfma_f32_16x16x32_bf16 a[120:123], v[52:55], v[248:251], a[120:123]
    ds_read_b64_tr_b16 v[44:45], v7 offset:46080
    v_mfma_f32_16x16x32_bf16 a[124:127], v[48:51], v[236:239], 0
    buffer_load_dwordx4 a[168:171], v1, s[24:27], s57 offen offset:2048 sc1
    v_mfma_f32_16x16x32_bf16 a[124:127], v[52:55], v[252:255], a[124:127]
    ds_read_b64_tr_b16 v[46:47], v7 offset:48384
    s_waitcnt lgkmcnt(4)
    v_mfma_f32_16x16x32_bf16 a[128:131], v[56:59], v[224:227], 0
    buffer_load_dwordx4 a[172:175], v1, s[24:27], s57 offen offset:3072 sc1
    v_mfma_f32_16x16x32_bf16 a[128:131], v[60:63], v[240:243], a[128:131]
    ds_read_b64_tr_b16 v[48:49], v7 offset:36896
    v_mfma_f32_16x16x32_bf16 a[132:135], v[56:59], v[228:231], 0
    v_mfma_f32_16x16x32_bf16 a[132:135], v[60:63], v[244:247], a[132:135]
    ds_read_b64_tr_b16 v[50:51], v7 offset:39200
    v_mfma_f32_16x16x32_bf16 a[136:139], v[56:59], v[232:235], 0
    v_mfma_f32_16x16x32_bf16 a[136:139], v[60:63], v[248:251], a[136:139]
    ds_read_b64_tr_b16 v[52:53], v7 offset:46112
    v_mfma_f32_16x16x32_bf16 a[140:143], v[56:59], v[236:239], 0
    v_mfma_f32_16x16x32_bf16 a[140:143], v[60:63], v[252:255], a[140:143]
    s_add_u32 s57, s51, 0
    ds_read_b64_tr_b16 v[54:55], v7 offset:48416
    s_waitcnt lgkmcnt(4)
    v_mfma_f32_16x16x32_bf16 a[0:3], v[40:43], v[96:99], a[0:3]
    s_barrier
    v_mfma_f32_16x16x32_bf16 a[0:3], v[44:47], v[160:163], a[0:3]
    s_add_u32 m0, s40, 0
    ds_read_b64_tr_b16 v[56:57], v7 offset:36928
    v_mfma_f32_16x16x32_bf16 a[4:7], v[40:43], v[112:115], a[4:7]
    v_mfma_f32_16x16x32_bf16 a[4:7], v[44:47], v[176:179], a[4:7]
    ds_read_b64_tr_b16 v[58:59], v7 offset:39232
    v_mfma_f32_16x16x32_bf16 a[8:11], v[40:43], v[128:131], a[8:11]
    s_add_u32 s14, s43, 73728
    s_add_u32 s15, s44, 73728
    s_cmp_eq_u32 s31, 0
    s_cselect_b32 s52, s14, s15
    v_mfma_f32_16x16x32_bf16 a[8:11], v[44:47], v[192:195], a[8:11]
    ds_read_b64_tr_b16 v[60:61], v7 offset:46144
    v_mfma_f32_16x16x32_bf16 a[12:15], v[40:43], v[144:147], a[12:15]
    buffer_load_dwordx4 a[176:179], v1, s[24:27], s57 offen offset:0 sc1
    v_mfma_f32_16x16x32_bf16 a[12:15], v[44:47], v[208:211], a[12:15]
    ds_read_b64_tr_b16 v[62:63], v7 offset:48448
    s_waitcnt lgkmcnt(4)
    v_mfma_f32_16x16x32_bf16 a[16:19], v[48:51], v[96:99], a[16:19]
    v_mfma_f32_16x16x32_bf16 a[16:19], v[52:55], v[160:163], a[16:19]
    ds_read_b64_tr_b16 v[40:41], v7 offset:36960
    v_mfma_f32_16x16x32_bf16 a[20:23], v[48:51], v[112:115], a[20:23]
    v_mfma_f32_16x16x32_bf16 a[20:23], v[52:55], v[176:179], a[20:23]
    ds_read_b64_tr_b16 v[42:43], v7 offset:39264
    v_mfma_f32_16x16x32_bf16 a[24:27], v[48:51], v[128:131], a[24:27]
    buffer_load_dwordx4 a[180:183], v1, s[24:27], s57 offen offset:1024 sc1
    v_mfma_f32_16x16x32_bf16 a[24:27], v[52:55], v[192:195], a[24:27]
    ds_read_b64_tr_b16 v[44:45], v7 offset:46176
    v_mfma_f32_16x16x32_bf16 a[28:31], v[48:51], v[144:147], a[28:31]
    v_mfma_f32_16x16x32_bf16 a[28:31], v[52:55], v[208:211], a[28:31]
    ds_read_b64_tr_b16 v[46:47], v7 offset:48480
    s_waitcnt lgkmcnt(4)
    v_mfma_f32_16x16x32_bf16 a[32:35], v[56:59], v[96:99], a[32:35]
    v_mfma_f32_16x16x32_bf16 a[32:35], v[60:63], v[160:163], a[32:35]
    ds_read_b64_tr_b16 v[48:49], v7 offset:36992
    v_mfma_f32_16x16x32_bf16 a[36:39], v[56:59], v[112:115], a[36:39]
    buffer_load_dwordx4 v8, s[20:23], s52 offen offset:0 lds
    v_mfma_f32_16x16x32_bf16 a[36:39], v[60:63], v[176:179], a[36:39]
    ds_read_b64_tr_b16 v[50:51], v7 offset:39296
    v_mfma_f32_16x16x32_bf16 a[40:43], v[56:59], v[128:131], a[40:43]
    buffer_load_dwordx4 a[184:187], v1, s[24:27], s57 offen offset:2048 sc1
    v_mfma_f32_16x16x32_bf16 a[40:43], v[60:63], v[192:195], a[40:43]
    ds_read_b64_tr_b16 v[52:53], v7 offset:46208
    v_mfma_f32_16x16x32_bf16 a[44:47], v[56:59], v[144:147], a[44:47]
    v_mfma_f32_16x16x32_bf16 a[44:47], v[60:63], v[208:211], a[44:47]
    ds_read_b64_tr_b16 v[54:55], v7 offset:48512
    s_waitcnt lgkmcnt(4)
    v_mfma_f32_16x16x32_bf16 a[48:51], v[40:43], v[96:99], a[48:51]
    buffer_load_dwordx4 v9, s[20:23], s52 offen offset:1024 lds
    v_mfma_f32_16x16x32_bf16 a[48:51], v[44:47], v[160:163], a[48:51]
    ds_read_b64_tr_b16 v[56:57], v7 offset:37024
    v_mfma_f32_16x16x32_bf16 a[52:55], v[40:43], v[112:115], a[52:55]
    buffer_load_dwordx4 a[188:191], v1, s[24:27], s57 offen offset:3072 sc1
    v_mfma_f32_16x16x32_bf16 a[52:55], v[44:47], v[176:179], a[52:55]
    ds_read_b64_tr_b16 v[58:59], v7 offset:39328
    v_mfma_f32_16x16x32_bf16 a[56:59], v[40:43], v[128:131], a[56:59]
    buffer_load_dwordx4 v10, s[20:23], s52 offen offset:2048 lds
    v_mfma_f32_16x16x32_bf16 a[56:59], v[44:47], v[192:195], a[56:59]
    ds_read_b64_tr_b16 v[60:61], v7 offset:46240
    v_mfma_f32_16x16x32_bf16 a[60:63], v[40:43], v[144:147], a[60:63]
    v_mfma_f32_16x16x32_bf16 a[60:63], v[44:47], v[208:211], a[60:63]
    ds_read_b64_tr_b16 v[62:63], v7 offset:48544
    s_waitcnt lgkmcnt(4)
    v_mfma_f32_16x16x32_bf16 a[64:67], v[48:51], v[96:99], a[64:67]
    v_mfma_f32_16x16x32_bf16 a[64:67], v[52:55], v[160:163], a[64:67]
    s_add_u32 s57, s48, 4096
    ds_read_b64_tr_b16 v[40:41], v7 offset:37056
    v_mfma_f32_16x16x32_bf16 a[68:71], v[48:51], v[112:115], a[68:71]
    buffer_load_dwordx4 v11, s[20:23], s52 offen offset:3072 lds
    v_mfma_f32_16x16x32_bf16 a[68:71], v[52:55], v[176:179], a[68:71]
    ds_read_b64_tr_b16 v[42:43], v7 offset:39360
    v_mfma_f32_16x16x32_bf16 a[72:75], v[48:51], v[128:131], a[72:75]
    v_mfma_f32_16x16x32_bf16 a[72:75], v[52:55], v[192:195], a[72:75]
    ds_read_b64_tr_b16 v[44:45], v7 offset:46272
    v_mfma_f32_16x16x32_bf16 a[76:79], v[48:51], v[144:147], a[76:79]
    buffer_load_dwordx4 a[192:195], v1, s[24:27], s57 offen offset:0 sc1
    v_mfma_f32_16x16x32_bf16 a[76:79], v[52:55], v[208:211], a[76:79]
    s_add_u32 m0, s40, 4096
    ds_read_b64_tr_b16 v[46:47], v7 offset:48576
    s_waitcnt lgkmcnt(4)
    v_mfma_f32_16x16x32_bf16 a[80:83], v[56:59], v[96:99], a[80:83]
    v_mfma_f32_16x16x32_bf16 a[80:83], v[60:63], v[160:163], a[80:83]
    ds_read_b64_tr_b16 v[48:49], v7 offset:37088
    v_mfma_f32_16x16x32_bf16 a[84:87], v[56:59], v[112:115], a[84:87]
    buffer_load_dwordx4 v12, s[20:23], s52 offen offset:0 lds
    v_mfma_f32_16x16x32_bf16 a[84:87], v[60:63], v[176:179], a[84:87]
    ds_read_b64_tr_b16 v[50:51], v7 offset:39392
    v_mfma_f32_16x16x32_bf16 a[88:91], v[56:59], v[128:131], a[88:91]
    v_mfma_f32_16x16x32_bf16 a[88:91], v[60:63], v[192:195], a[88:91]
    ds_read_b64_tr_b16 v[52:53], v7 offset:46304
    v_mfma_f32_16x16x32_bf16 a[92:95], v[56:59], v[144:147], a[92:95]
    buffer_load_dwordx4 a[196:199], v1, s[24:27], s57 offen offset:1024 sc1
    v_mfma_f32_16x16x32_bf16 a[92:95], v[60:63], v[208:211], a[92:95]
    ds_read_b64_tr_b16 v[54:55], v7 offset:48608
    s_waitcnt lgkmcnt(4)
    v_mfma_f32_16x16x32_bf16 a[96:99], v[40:43], v[96:99], a[96:99]
    buffer_load_dwordx4 v13, s[20:23], s52 offen offset:1024 lds
    v_mfma_f32_16x16x32_bf16 a[96:99], v[44:47], v[160:163], a[96:99]
    ds_read_b64_tr_b16 v[56:57], v7 offset:37120
    v_mfma_f32_16x16x32_bf16 a[100:103], v[40:43], v[112:115], a[100:103]
    v_mfma_f32_16x16x32_bf16 a[100:103], v[44:47], v[176:179], a[100:103]
    ds_read_b64_tr_b16 v[58:59], v7 offset:39424
    v_mfma_f32_16x16x32_bf16 a[104:107], v[40:43], v[128:131], a[104:107]
    buffer_load_dwordx4 v14, s[20:23], s52 offen offset:2048 lds
    v_mfma_f32_16x16x32_bf16 a[104:107], v[44:47], v[192:195], a[104:107]
    ds_read_b64_tr_b16 v[60:61], v7 offset:46336
    v_mfma_f32_16x16x32_bf16 a[108:111], v[40:43], v[144:147], a[108:111]
    buffer_load_dwordx4 a[200:203], v1, s[24:27], s57 offen offset:2048 sc1
    v_mfma_f32_16x16x32_bf16 a[108:111], v[44:47], v[208:211], a[108:111]
    ds_read_b64_tr_b16 v[62:63], v7 offset:48640
    s_waitcnt lgkmcnt(4)
    s_waitcnt vmcnt(36)
    s_barrier
    v_mfma_f32_16x16x32_bf16 a[112:115], v[48:51], v[96:99], a[112:115]
    v_mfma_f32_16x16x32_bf16 a[112:115], v[52:55], v[160:163], a[112:115]
    v_add_u32 v7, 73728, v7
    ds_read_b64_tr_b16 v[40:41], v7 offset:0
    v_mfma_f32_16x16x32_bf16 a[116:119], v[48:51], v[112:115], a[116:119]
    buffer_load_dwordx4 v17, s[20:23], s52 offen offset:3072 lds
    v_mfma_f32_16x16x32_bf16 a[116:119], v[52:55], v[176:179], a[116:119]
    ds_read_b64_tr_b16 v[42:43], v7 offset:2304
    v_mfma_f32_16x16x32_bf16 a[120:123], v[48:51], v[128:131], a[120:123]
    buffer_load_dwordx4 a[204:207], v1, s[24:27], s57 offen offset:3072 sc1
    v_mfma_f32_16x16x32_bf16 a[120:123], v[52:55], v[192:195], a[120:123]
    ds_read_b64_tr_b16 v[44:45], v7 offset:9216
    v_mfma_f32_16x16x32_bf16 a[124:127], v[48:51], v[144:147], a[124:127]
    v_mfma_f32_16x16x32_bf16 a[124:127], v[52:55], v[208:211], a[124:127]
    s_add_u32 m0, s40, 8192
    ds_read_b64_tr_b16 v[46:47], v7 offset:11520
    s_waitcnt lgkmcnt(4)
    v_mfma_f32_16x16x32_bf16 a[128:131], v[56:59], v[96:99], a[128:131]
    v_mfma_f32_16x16x32_bf16 a[128:131], v[60:63], v[160:163], a[128:131]
    ds_read_b64_tr_b16 v[48:49], v7 offset:32
    v_mfma_f32_16x16x32_bf16 a[132:135], v[56:59], v[112:115], a[132:135]
    buffer_load_dwordx4 v18, s[20:23], s52 offen offset:0 lds
    v_mfma_f32_16x16x32_bf16 a[132:135], v[60:63], v[176:179], a[132:135]
    s_add_u32 s57, s50, 4096
    ds_read_b64_tr_b16 v[50:51], v7 offset:2336
    v_mfma_f32_16x16x32_bf16 a[136:139], v[56:59], v[128:131], a[136:139]
    v_mfma_f32_16x16x32_bf16 a[136:139], v[60:63], v[192:195], a[136:139]
    ds_read_b64_tr_b16 v[52:53], v7 offset:9248
    v_mfma_f32_16x16x32_bf16 a[140:143], v[56:59], v[144:147], a[140:143]
    v_mfma_f32_16x16x32_bf16 a[140:143], v[60:63], v[208:211], a[140:143]
    ds_read_b64_tr_b16 v[54:55], v7 offset:11552
    s_waitcnt lgkmcnt(4)
    s_waitcnt vmcnt(17)
    v_mfma_f32_16x16x32_bf16 a[0:3], v[40:43], a[144:147], a[0:3]
    s_barrier
    buffer_load_dwordx4 a[208:211], v1, s[24:27], s57 offen offset:0 sc1
    v_mfma_f32_16x16x32_bf16 a[0:3], v[44:47], a[160:163], a[0:3]
    s_add_u32 m0, s40, 36864
    ds_read_b64_tr_b16 v[56:57], v7 offset:64
    v_mfma_f32_16x16x32_bf16 a[4:7], v[40:43], a[148:151], a[4:7]
    v_mfma_f32_16x16x32_bf16 a[4:7], v[44:47], a[164:167], a[4:7]
    ds_read_b64_tr_b16 v[58:59], v7 offset:2368
    v_mfma_f32_16x16x32_bf16 a[8:11], v[40:43], a[152:155], a[8:11]
    s_add_u32 s14, s42, 147456
    s_add_u32 s15, s43, 147456
    s_cmp_eq_u32 s31, 0
    s_cselect_b32 s52, s14, s15
    v_mfma_f32_16x16x32_bf16 a[8:11], v[44:47], a[168:171], a[8:11]
    ds_read_b64_tr_b16 v[60:61], v7 offset:9280
    v_mfma_f32_16x16x32_bf16 a[12:15], v[40:43], a[156:159], a[12:15]
    s_waitcnt vmcnt(27)
    v_mov_b32 v37, 1
    s_mov_b64 exec, 1
    buffer_store_dword v37, off, s[24:27], s49 offset:4 sc1
    s_mov_b64 exec, -1
    v_mfma_f32_16x16x32_bf16 a[12:15], v[44:47], a[172:175], a[12:15]
    ds_read_b64_tr_b16 v[62:63], v7 offset:11584
    s_waitcnt lgkmcnt(4)
    v_mfma_f32_16x16x32_bf16 a[16:19], v[48:51], a[144:147], a[16:19]
    buffer_load_dwordx4 a[212:215], v1, s[24:27], s57 offen offset:1024 sc1
    v_mfma_f32_16x16x32_bf16 a[16:19], v[52:55], a[160:163], a[16:19]
    ds_read_b64_tr_b16 v[40:41], v7 offset:96
    v_mfma_f32_16x16x32_bf16 a[20:23], v[48:51], a[148:151], a[20:23]
    v_mfma_f32_16x16x32_bf16 a[20:23], v[52:55], a[164:167], a[20:23]
    ds_read_b64_tr_b16 v[42:43], v7 offset:2400
    v_mfma_f32_16x16x32_bf16 a[24:27], v[48:51], a[152:155], a[24:27]
    v_mfma_f32_16x16x32_bf16 a[24:27], v[52:55], a[168:171], a[24:27]
    ds_read_b64_tr_b16 v[44:45], v7 offset:9312
    v_mfma_f32_16x16x32_bf16 a[28:31], v[48:51], a[156:159], a[28:31]
    buffer_load_dwordx4 a[216:219], v1, s[24:27], s57 offen offset:2048 sc1
    v_mfma_f32_16x16x32_bf16 a[28:31], v[52:55], a[172:175], a[28:31]
    ds_read_b64_tr_b16 v[46:47], v7 offset:11616
    s_waitcnt lgkmcnt(4)
    v_mfma_f32_16x16x32_bf16 a[32:35], v[56:59], a[144:147], a[32:35]
    s_lshr_b32 s10, s29, 2
    v_mfma_f32_16x16x32_bf16 a[32:35], v[60:63], a[160:163], a[32:35]
    ds_read_b64_tr_b16 v[48:49], v7 offset:128
    v_mfma_f32_16x16x32_bf16 a[36:39], v[56:59], a[148:151], a[36:39]
    s_and_b32 s9, s29, 3
    buffer_load_dwordx4 v8, s[20:23], s52 offen offset:0 lds
    v_mfma_f32_16x16x32_bf16 a[36:39], v[60:63], a[164:167], a[36:39]
    ds_read_b64_tr_b16 v[50:51], v7 offset:2432
    v_mfma_f32_16x16x32_bf16 a[40:43], v[56:59], a[152:155], a[40:43]
    s_and_b32 s13, s28, 7
    v_mfma_f32_16x16x32_bf16 a[40:43], v[60:63], a[168:171], a[40:43]
    ds_read_b64_tr_b16 v[52:53], v7 offset:9344
    v_mfma_f32_16x16x32_bf16 a[44:47], v[56:59], a[156:159], a[44:47]
    s_lshl_b32 s13, s13, 3
    buffer_load_dwordx4 a[220:223], v1, s[24:27], s57 offen offset:3072 sc1
    v_mfma_f32_16x16x32_bf16 a[44:47], v[60:63], a[172:175], a[44:47]
    ds_read_b64_tr_b16 v[54:55], v7 offset:11648
    s_waitcnt lgkmcnt(4)
    v_mfma_f32_16x16x32_bf16 a[48:51], v[40:43], a[144:147], a[48:51]
    buffer_load_dwordx4 v9, s[20:23], s52 offen offset:1024 lds
    v_mfma_f32_16x16x32_bf16 a[48:51], v[44:47], a[160:163], a[48:51]
    s_lshr_b32 s11, s28, 3
    ds_read_b64_tr_b16 v[56:57], v7 offset:160
    v_mfma_f32_16x16x32_bf16 a[52:55], v[40:43], a[148:151], a[52:55]
    v_mfma_f32_16x16x32_bf16 a[52:55], v[44:47], a[164:167], a[52:55]
    s_add_u32 s11, s11, s13
    ds_read_b64_tr_b16 v[58:59], v7 offset:2464
    v_mfma_f32_16x16x32_bf16 a[56:59], v[40:43], a[152:155], a[56:59]
    buffer_load_dwordx4 v10, s[20:23], s52 offen offset:2048 lds
    v_mfma_f32_16x16x32_bf16 a[56:59], v[44:47], a[168:171], a[56:59]
    s_add_u32 s57, s51, 4096
    ds_read_b64_tr_b16 v[60:61], v7 offset:9376
    s_lshl_b32 s13, s9, 6
    v_mfma_f32_16x16x32_bf16 a[60:63], v[40:43], a[156:159], a[60:63]
    v_mfma_f32_16x16x32_bf16 a[60:63], v[44:47], a[172:175], a[60:63]
    ds_read_b64_tr_b16 v[62:63], v7 offset:11680
    s_waitcnt lgkmcnt(4)
    v_mfma_f32_16x16x32_bf16 a[64:67], v[48:51], a[144:147], a[64:67]
    s_add_u32 s11, s11, s13
    v_mfma_f32_16x16x32_bf16 a[64:67], v[52:55], a[160:163], a[64:67]
    ds_read_b64_tr_b16 v[40:41], v7 offset:192
    v_mfma_f32_16x16x32_bf16 a[68:71], v[48:51], a[148:151], a[68:71]
    s_lshl_b32 s11, s11, 2
    buffer_load_dwordx4 v11, s[20:23], s52 offen offset:3072 lds
    v_mfma_f32_16x16x32_bf16 a[68:71], v[52:55], a[164:167], a[68:71]
    ds_read_b64_tr_b16 v[42:43], v7 offset:2496
    v_mfma_f32_16x16x32_bf16 a[72:75], v[48:51], a[152:155], a[72:75]
    s_lshr_b32 s13, s10, 1
    buffer_load_dwordx4 a[224:227], v1, s[24:27], s57 offen offset:0 sc1
    v_mfma_f32_16x16x32_bf16 a[72:75], v[52:55], a[168:171], a[72:75]
    ds_read_b64_tr_b16 v[44:45], v7 offset:9408
    v_mfma_f32_16x16x32_bf16 a[76:79], v[48:51], a[156:159], a[76:79]
    v_mfma_f32_16x16x32_bf16 a[76:79], v[52:55], a[172:175], a[76:79]
    s_add_u32 m0, s40, 40960
    ds_read_b64_tr_b16 v[46:47], v7 offset:11712
    s_waitcnt lgkmcnt(4)
    v_mfma_f32_16x16x32_bf16 a[80:83], v[56:59], a[144:147], a[80:83]
    s_add_u32 s11, s11, s13
    v_mfma_f32_16x16x32_bf16 a[80:83], v[60:63], a[160:163], a[80:83]
    s_and_b32 s13, s10, 1
    ds_read_b64_tr_b16 v[48:49], v7 offset:224
    v_mfma_f32_16x16x32_bf16 a[84:87], v[56:59], a[148:151], a[84:87]
    buffer_load_dwordx4 v12, s[20:23], s52 offen offset:0 lds
    v_mfma_f32_16x16x32_bf16 a[84:87], v[60:63], a[164:167], a[84:87]
    s_lshl_b32 s13, s13, 1
    ds_read_b64_tr_b16 v[50:51], v7 offset:2528
    v_mfma_f32_16x16x32_bf16 a[88:91], v[56:59], a[152:155], a[88:91]
    buffer_load_dwordx4 a[228:231], v1, s[24:27], s57 offen offset:1024 sc1
    v_mfma_f32_16x16x32_bf16 a[88:91], v[60:63], a[168:171], a[88:91]
    ds_read_b64_tr_b16 v[52:53], v7 offset:9440
    v_mfma_f32_16x16x32_bf16 a[92:95], v[56:59], a[156:159], a[92:95]
    s_add_u32 s11, s11, s13
    v_mfma_f32_16x16x32_bf16 a[92:95], v[60:63], a[172:175], a[92:95]
    ds_read_b64_tr_b16 v[54:55], v7 offset:11744
    s_waitcnt lgkmcnt(4)
    v_mfma_f32_16x16x32_bf16 a[96:99], v[40:43], a[144:147], a[96:99]
    s_add_u32 s12, s10, 1
    buffer_load_dwordx4 v13, s[20:23], s52 offen offset:1024 lds
    v_mfma_f32_16x16x32_bf16 a[96:99], v[44:47], a[160:163], a[96:99]
    ds_read_b64_tr_b16 v[56:57], v7 offset:256
    v_mfma_f32_16x16x32_bf16 a[100:103], v[40:43], a[148:151], a[100:103]
    s_and_b32 s12, s12, 3
    buffer_load_dwordx4 a[232:235], v1, s[24:27], s57 offen offset:2048 sc1
    v_mfma_f32_16x16x32_bf16 a[100:103], v[44:47], a[164:167], a[100:103]
    ds_read_b64_tr_b16 v[58:59], v7 offset:2560
    v_mfma_f32_16x16x32_bf16 a[104:107], v[40:43], a[152:155], a[104:107]
    buffer_load_dwordx4 v14, s[20:23], s52 offen offset:2048 lds
    v_mfma_f32_16x16x32_bf16 a[104:107], v[44:47], a[168:171], a[104:107]
    s_lshl_b32 s12, s12, 3
    ds_read_b64_tr_b16 v[60:61], v7 offset:9472
    v_mfma_f32_16x16x32_bf16 a[108:111], v[40:43], a[156:159], a[108:111]
    v_mfma_f32_16x16x32_bf16 a[108:111], v[44:47], a[172:175], a[108:111]
    s_add_u32 s12, s12, s11
    ds_read_b64_tr_b16 v[62:63], v7 offset:11776
    s_waitcnt lgkmcnt(4)
    s_waitcnt vmcnt(35)
    s_barrier
    v_mfma_f32_16x16x32_bf16 a[112:115], v[48:51], a[144:147], a[112:115]
    buffer_load_dwordx4 a[236:239], v1, s[24:27], s57 offen offset:3072 sc1
    v_mfma_f32_16x16x32_bf16 a[112:115], v[52:55], a[160:163], a[112:115]
    s_mul_i32 s12, s12, 9216
    ds_read_b64_tr_b16 v[40:41], v7 offset:36864
    v_mfma_f32_16x16x32_bf16 a[116:119], v[48:51], a[148:151], a[116:119]
    buffer_load_dwordx4 v17, s[20:23], s52 offen offset:3072 lds
    v_mfma_f32_16x16x32_bf16 a[116:119], v[52:55], a[164:167], a[116:119]
    ds_read_b64_tr_b16 v[42:43], v7 offset:39168
    v_mfma_f32_16x16x32_bf16 a[120:123], v[48:51], a[152:155], a[120:123]
    s_add_u32 s64, s12, 41943040
    v_mfma_f32_16x16x32_bf16 a[120:123], v[52:55], a[168:171], a[120:123]
    ds_read_b64_tr_b16 v[44:45], v7 offset:46080
    v_mfma_f32_16x16x32_bf16 a[124:127], v[48:51], a[156:159], a[124:127]
    s_add_u32 s12, s10, 2
    v_mfma_f32_16x16x32_bf16 a[124:127], v[52:55], a[172:175], a[124:127]
    s_add_u32 m0, s40, 45056
    ds_read_b64_tr_b16 v[46:47], v7 offset:48384
    s_waitcnt lgkmcnt(4)
    v_mfma_f32_16x16x32_bf16 a[128:131], v[56:59], a[144:147], a[128:131]
    s_add_u32 s57, s48, 8192
    s_and_b32 s12, s12, 3
    v_mfma_f32_16x16x32_bf16 a[128:131], v[60:63], a[160:163], a[128:131]
    ds_read_b64_tr_b16 v[48:49], v7 offset:36896
    v_mfma_f32_16x16x32_bf16 a[132:135], v[56:59], a[148:151], a[132:135]
    buffer_load_dwordx4 v18, s[20:23], s52 offen offset:0 lds
    v_mfma_f32_16x16x32_bf16 a[132:135], v[60:63], a[164:167], a[132:135]
    s_lshl_b32 s12, s12, 3
    ds_read_b64_tr_b16 v[50:51], v7 offset:39200
    v_mfma_f32_16x16x32_bf16 a[136:139], v[56:59], a[152:155], a[136:139]
    buffer_load_dwordx4 a[240:243], v1, s[24:27], s57 offen offset:0 sc1
    v_mfma_f32_16x16x32_bf16 a[136:139], v[60:63], a[168:171], a[136:139]
    s_add_u32 s12, s12, s11
    ds_read_b64_tr_b16 v[52:53], v7 offset:46112
    v_mfma_f32_16x16x32_bf16 a[140:143], v[56:59], a[156:159], a[140:143]
    v_mfma_f32_16x16x32_bf16 a[140:143], v[60:63], a[172:175], a[140:143]
    s_mul_i32 s12, s12, 9216
    ds_read_b64_tr_b16 v[54:55], v7 offset:48416
    buffer_load_dword v23, v21, s[24:27], 0 offen offset:4 sc1
    s_waitcnt lgkmcnt(4)
    s_waitcnt vmcnt(21)
    v_mfma_f32_16x16x32_bf16 a[0:3], v[40:43], a[176:179], a[0:3]
    s_barrier
    v_mfma_f32_16x16x32_bf16 a[0:3], v[44:47], a[192:195], a[0:3]
    s_add_u32 m0, s40, 73728
    ds_read_b64_tr_b16 v[56:57], v7 offset:36928
    v_mfma_f32_16x16x32_bf16 a[4:7], v[40:43], a[180:183], a[4:7]
    s_add_u32 s65, s12, 41943040
    v_mfma_f32_16x16x32_bf16 a[4:7], v[44:47], a[196:199], a[4:7]
    ds_read_b64_tr_b16 v[58:59], v7 offset:39232
    v_mfma_f32_16x16x32_bf16 a[8:11], v[40:43], a[184:187], a[8:11]
    s_add_u32 s14, s44, 147456
    s_add_u32 s15, s42, 221184
    s_cmp_eq_u32 s31, 0
    s_cselect_b32 s52, s14, s15
    v_mfma_f32_16x16x32_bf16 a[8:11], v[44:47], a[200:203], a[8:11]
    s_add_u32 s12, s10, 3
    ds_read_b64_tr_b16 v[60:61], v7 offset:46144
    v_mfma_f32_16x16x32_bf16 a[12:15], v[40:43], a[188:191], a[12:15]
    s_and_b32 s12, s12, 3
    buffer_load_dwordx4 a[244:247], v1, s[24:27], s57 offen offset:1024 sc1
    v_mfma_f32_16x16x32_bf16 a[12:15], v[44:47], a[204:207], a[12:15]
    ds_read_b64_tr_b16 v[62:63], v7 offset:48448
    s_waitcnt lgkmcnt(4)
    v_mfma_f32_16x16x32_bf16 a[16:19], v[48:51], a[176:179], a[16:19]
    v_mfma_f32_16x16x32_bf16 a[16:19], v[52:55], a[192:195], a[16:19]
    s_lshl_b32 s12, s12, 3
    ds_read_b64_tr_b16 v[40:41], v7 offset:36960
    v_mfma_f32_16x16x32_bf16 a[20:23], v[48:51], a[180:183], a[20:23]
    buffer_load_dwordx4 a[248:251], v1, s[24:27], s57 offen offset:2048 sc1
    v_mfma_f32_16x16x32_bf16 a[20:23], v[52:55], a[196:199], a[20:23]
    s_add_u32 s12, s12, s11
    ds_read_b64_tr_b16 v[42:43], v7 offset:39264
    v_mfma_f32_16x16x32_bf16 a[24:27], v[48:51], a[184:187], a[24:27]
    v_mfma_f32_16x16x32_bf16 a[24:27], v[52:55], a[200:203], a[24:27]
    s_mul_i32 s12, s12, 9216
    ds_read_b64_tr_b16 v[44:45], v7 offset:46176
    v_mfma_f32_16x16x32_bf16 a[28:31], v[48:51], a[188:191], a[28:31]
    v_mfma_f32_16x16x32_bf16 a[28:31], v[52:55], a[204:207], a[28:31]
    ds_read_b64_tr_b16 v[46:47], v7 offset:48480
    s_waitcnt lgkmcnt(4)
    v_mfma_f32_16x16x32_bf16 a[32:35], v[56:59], a[176:179], a[32:35]
    s_add_u32 s66, s12, 41943040
    v_mfma_f32_16x16x32_bf16 a[32:35], v[60:63], a[192:195], a[32:35]
    ds_read_b64_tr_b16 v[48:49], v7 offset:36992
    v_mfma_f32_16x16x32_bf16 a[36:39], v[56:59], a[180:183], a[36:39]
    s_lshl_b32 s13, s3, 11
    buffer_load_dwordx4 v8, s[20:23], s52 offen offset:0 lds
    v_mfma_f32_16x16x32_bf16 a[36:39], v[60:63], a[196:199], a[36:39]
    ds_read_b64_tr_b16 v[50:51], v7 offset:39296
    v_mfma_f32_16x16x32_bf16 a[40:43], v[56:59], a[184:187], a[40:43]
    buffer_load_dwordx4 a[252:255], v1, s[24:27], s57 offen offset:3072 sc1
    v_mfma_f32_16x16x32_bf16 a[40:43], v[60:63], a[200:203], a[40:43]
    ds_read_b64_tr_b16 v[52:53], v7 offset:46208
    v_add_u32 v2, s13, v1
    v_mfma_f32_16x16x32_bf16 a[44:47], v[56:59], a[188:191], a[44:47]
    v_mfma_f32_16x16x32_bf16 a[44:47], v[60:63], a[204:207], a[44:47]
    ds_read_b64_tr_b16 v[54:55], v7 offset:48512
    s_waitcnt lgkmcnt(4)
    v_mfma_f32_16x16x32_bf16 a[48:51], v[40:43], a[176:179], a[48:51]
    buffer_load_dwordx4 v9, s[20:23], s52 offen offset:1024 lds
    v_mfma_f32_16x16x32_bf16 a[48:51], v[44:47], a[192:195], a[48:51]
    s_add_u32 s57, s50, 8192
    ds_read_b64_tr_b16 v[56:57], v7 offset:37024
    v_and_b32 v4, 15, v0
    v_mfma_f32_16x16x32_bf16 a[52:55], v[40:43], a[180:183], a[52:55]
    s_lshl_b32 s13, s3, 8
    v_mfma_f32_16x16x32_bf16 a[52:55], v[44:47], a[196:199], a[52:55]
    s_add_u32 s13, s13, 8192
    ds_read_b64_tr_b16 v[58:59], v7 offset:39328
    v_mfma_f32_16x16x32_bf16 a[56:59], v[40:43], a[184:187], a[56:59]
    buffer_load_dwordx4 v10, s[20:23], s52 offen offset:2048 lds
    v_mfma_f32_16x16x32_bf16 a[56:59], v[44:47], a[200:203], a[56:59]
    ds_read_b64_tr_b16 v[60:61], v7 offset:46240
    v_mfma_f32_16x16x32_bf16 a[60:63], v[40:43], a[188:191], a[60:63]
    buffer_load_dwordx4 v[64:67], v1, s[24:27], s57 offen offset:0 sc1
    v_mfma_f32_16x16x32_bf16 a[60:63], v[44:47], a[204:207], a[60:63]
    ds_read_b64_tr_b16 v[62:63], v7 offset:48544
    s_waitcnt lgkmcnt(4)
    v_mfma_f32_16x16x32_bf16 a[64:67], v[48:51], a[176:179], a[64:67]
    s_lshl_b32 s12, s28, 2
    v_lshl_add_u32 v3, v4, 4, s13
    v_mfma_f32_16x16x32_bf16 a[64:67], v[52:55], a[192:195], a[64:67]
    ds_read_b64_tr_b16 v[40:41], v7 offset:37056
    v_mfma_f32_16x16x32_bf16 a[68:71], v[48:51], a[180:183], a[68:71]
    s_add_u32 s12, s12, s10
    buffer_load_dwordx4 v11, s[20:23], s52 offen offset:3072 lds
    v_mfma_f32_16x16x32_bf16 a[68:71], v[52:55], a[196:199], a[68:71]
    ds_read_b64_tr_b16 v[42:43], v7 offset:39360
    v_mfma_f32_16x16x32_bf16 a[72:75], v[48:51], a[184:187], a[72:75]
    v_mfma_f32_16x16x32_bf16 a[72:75], v[52:55], a[200:203], a[72:75]
    s_lshl_b32 s13, s12, 5
    ds_read_b64_tr_b16 v[44:45], v7 offset:46272
    v_mfma_f32_16x16x32_bf16 a[76:79], v[48:51], a[188:191], a[76:79]
    buffer_load_dwordx4 v[68:71], v1, s[24:27], s57 offen offset:1024 sc1
    v_mfma_f32_16x16x32_bf16 a[76:79], v[52:55], a[204:207], a[76:79]
    s_add_u32 m0, s40, 77824
    ds_read_b64_tr_b16 v[46:47], v7 offset:48576
    s_waitcnt lgkmcnt(4)
    v_mfma_f32_16x16x32_bf16 a[80:83], v[56:59], a[176:179], a[80:83]
    v_add_u32 v16, s13, v4
    v_mfma_f32_16x16x32_bf16 a[80:83], v[60:63], a[192:195], a[80:83]
    ds_read_b64_tr_b16 v[48:49], v7 offset:37088
    v_mul_u32_u24 v15, 1152, v16
    v_mfma_f32_16x16x32_bf16 a[84:87], v[56:59], a[180:183], a[84:87]
    buffer_load_dwordx4 v12, s[20:23], s52 offen offset:0 lds
    v_mfma_f32_16x16x32_bf16 a[84:87], v[60:63], a[196:199], a[84:87]
    ds_read_b64_tr_b16 v[50:51], v7 offset:39392
    v_mfma_f32_16x16x32_bf16 a[88:91], v[56:59], a[184:187], a[88:91]
    buffer_load_dwordx4 v[72:75], v1, s[24:27], s57 offen offset:2048 sc1
    v_mfma_f32_16x16x32_bf16 a[88:91], v[60:63], a[200:203], a[88:91]
    ds_read_b64_tr_b16 v[52:53], v7 offset:46304
    v_lshlrev_b32 v16, 2, v16
    v_mfma_f32_16x16x32_bf16 a[92:95], v[56:59], a[188:191], a[92:95]
    v_lshlrev_b32 v5, 4, v4
    v_mfma_f32_16x16x32_bf16 a[92:95], v[60:63], a[204:207], a[92:95]
    ds_read_b64_tr_b16 v[54:55], v7 offset:48608
    s_waitcnt lgkmcnt(4)
    v_mfma_f32_16x16x32_bf16 a[96:99], v[40:43], a[176:179], a[96:99]
    buffer_load_dwordx4 v13, s[20:23], s52 offen offset:1024 lds
    v_mfma_f32_16x16x32_bf16 a[96:99], v[44:47], a[192:195], a[96:99]
    ds_read_b64_tr_b16 v[56:57], v7 offset:37120
    v_bfe_u32 v4, v0, 4, 1
    v_mfma_f32_16x16x32_bf16 a[100:103], v[40:43], a[180:183], a[100:103]
    v_mfma_f32_16x16x32_bf16 a[100:103], v[44:47], a[196:199], a[100:103]
    ds_read_b64_tr_b16 v[58:59], v7 offset:39424
    v_lshrrev_b32 v6, 5, v0
    v_mfma_f32_16x16x32_bf16 a[104:107], v[40:43], a[184:187], a[104:107]
    buffer_load_dwordx4 v14, s[20:23], s52 offen offset:2048 lds
    v_mfma_f32_16x16x32_bf16 a[104:107], v[44:47], a[200:203], a[104:107]
    ds_read_b64_tr_b16 v[60:61], v7 offset:46336
    v_lshl_add_u32 v4, v4, 1, v6
    v_mfma_f32_16x16x32_bf16 a[108:111], v[40:43], a[188:191], a[108:111]
    buffer_load_dwordx4 v[76:79], v1, s[24:27], s57 offen offset:3072 sc1
    v_mfma_f32_16x16x32_bf16 a[108:111], v[44:47], a[204:207], a[108:111]
    ds_read_b64_tr_b16 v[62:63], v7 offset:48640
    s_waitcnt lgkmcnt(4)
    s_waitcnt vmcnt(34)
    s_barrier
    v_mfma_f32_16x16x32_bf16 a[112:115], v[48:51], a[176:179], a[112:115]
    v_lshl_add_u32 v15, v4, 4, v15
    v_mfma_f32_16x16x32_bf16 a[112:115], v[52:55], a[192:195], a[112:115]
    v_add_u32 v7, 4294893568, v7
    ds_read_b64_tr_b16 v[40:41], v7 offset:0
    v_mfma_f32_16x16x32_bf16 a[116:119], v[48:51], a[180:183], a[116:119]
    buffer_load_dwordx4 v17, s[20:23], s52 offen offset:3072 lds
    v_mfma_f32_16x16x32_bf16 a[116:119], v[52:55], a[196:199], a[116:119]
    ds_read_b64_tr_b16 v[42:43], v7 offset:2304
    v_lshl_add_u32 v5, v4, 9, v5
    v_mfma_f32_16x16x32_bf16 a[120:123], v[48:51], a[184:187], a[120:123]
    s_waitcnt vmcnt(15)
    v_cmp_eq_u32 vcc, 0, v23
    s_nop 4
    s_cbranch_vccnz L_k4_spin1
L_k4_back1:
    v_mfma_f32_16x16x32_bf16 a[120:123], v[52:55], a[200:203], a[120:123]
    s_add_u32 s57, s51, 8192
    ds_read_b64_tr_b16 v[44:45], v7 offset:9216
    s_mul_i32 s12, s12, 36864
    v_mfma_f32_16x16x32_bf16 a[124:127], v[48:51], a[188:191], a[124:127]
    s_add_u32 s12, s12, 11534336
    v_mfma_f32_16x16x32_bf16 a[124:127], v[52:55], a[204:207], a[124:127]
    s_add_u32 m0, s40, 81920
    ds_read_b64_tr_b16 v[46:47], v7 offset:11520
    s_waitcnt lgkmcnt(4)
    v_mfma_f32_16x16x32_bf16 a[128:131], v[56:59], a[176:179], a[128:131]
    v_mfma_f32_16x16x32_bf16 a[128:131], v[60:63], a[192:195], a[128:131]
    s_mul_i32 s13, s9, 18
    ds_read_b64_tr_b16 v[48:49], v7 offset:32
    v_mfma_f32_16x16x32_bf16 a[132:135], v[56:59], a[180:183], a[132:135]
    buffer_load_dwordx4 v18, s[20:23], s52 offen offset:0 lds
    v_mfma_f32_16x16x32_bf16 a[132:135], v[60:63], a[196:199], a[132:135]
    s_lshl_b32 s67, s3, 2
    ds_read_b64_tr_b16 v[50:51], v7 offset:2336
    v_mfma_f32_16x16x32_bf16 a[136:139], v[56:59], a[184:187], a[136:139]
    buffer_load_dwordx4 v[80:83], v1, s[24:27], s57 offen offset:0 sc1
    v_mfma_f32_16x16x32_bf16 a[136:139], v[60:63], a[200:203], a[136:139]
    s_add_u32 s67, s67, s13
    ds_read_b64_tr_b16 v[52:53], v7 offset:9248
    v_mfma_f32_16x16x32_bf16 a[140:143], v[56:59], a[188:191], a[140:143]
    v_mfma_f32_16x16x32_bf16 a[140:143], v[60:63], a[204:207], a[140:143]
    ds_read_b64_tr_b16 v[54:55], v7 offset:11552
    s_waitcnt lgkmcnt(4)
    s_waitcnt vmcnt(21)
    v_mfma_f32_16x16x32_bf16 a[0:3], v[40:43], a[208:211], a[0:3]
    s_barrier
    s_lshl_b32 s8, s67, 4
    v_mfma_f32_16x16x32_bf16 a[0:3], v[44:47], a[224:227], a[0:3]
    s_add_u32 m0, s40, 110592
    ds_read_b64_tr_b16 v[56:57], v7 offset:64
    v_mfma_f32_16x16x32_bf16 a[4:7], v[40:43], a[212:215], a[4:7]
    s_lshl_b32 s67, s67, 9
    buffer_load_dwordx4 v[84:87], v1, s[24:27], s57 offen offset:1024 sc1
    v_mfma_f32_16x16x32_bf16 a[4:7], v[44:47], a[228:231], a[4:7]
    ds_read_b64_tr_b16 v[58:59], v7 offset:2368
    v_mfma_f32_16x16x32_bf16 a[8:11], v[40:43], a[216:219], a[8:11]
    s_add_u32 s14, s43, 221184
    s_add_u32 s15, s44, 221184
    s_cmp_eq_u32 s31, 0
    s_cselect_b32 s52, s14, s15
    v_mfma_f32_16x16x32_bf16 a[8:11], v[44:47], a[232:235], a[8:11]
    s_add_u32 s67, s67, s12
    ds_read_b64_tr_b16 v[60:61], v7 offset:9280
    v_mfma_f32_16x16x32_bf16 a[12:15], v[40:43], a[220:223], a[12:15]
    v_mfma_f32_16x16x32_bf16 a[12:15], v[44:47], a[236:239], a[12:15]
    s_lshr_b32 s68, s3, 1
    ds_read_b64_tr_b16 v[62:63], v7 offset:11584
    s_waitcnt lgkmcnt(4)
    v_mfma_f32_16x16x32_bf16 a[16:19], v[48:51], a[208:211], a[16:19]
    buffer_load_dwordx4 v[88:91], v1, s[24:27], s57 offen offset:2048 sc1
    v_mfma_f32_16x16x32_bf16 a[16:19], v[52:55], a[224:227], a[16:19]
    s_add_u32 s68, s68, s13
    ds_read_b64_tr_b16 v[40:41], v7 offset:96
    v_mfma_f32_16x16x32_bf16 a[20:23], v[48:51], a[212:215], a[20:23]
    v_mfma_f32_16x16x32_bf16 a[20:23], v[52:55], a[228:231], a[20:23]
    s_add_u32 s68, s68, 16
    ds_read_b64_tr_b16 v[42:43], v7 offset:2400
    v_mfma_f32_16x16x32_bf16 a[24:27], v[48:51], a[216:219], a[24:27]
    v_mfma_f32_16x16x32_bf16 a[24:27], v[52:55], a[232:235], a[24:27]
    ds_read_b64_tr_b16 v[44:45], v7 offset:9312
    v_mfma_f32_16x16x32_bf16 a[28:31], v[48:51], a[220:223], a[28:31]
    s_and_b32 s69, s3, 1
    v_mfma_f32_16x16x32_bf16 a[28:31], v[52:55], a[236:239], a[28:31]
    ds_read_b64_tr_b16 v[46:47], v7 offset:11616
    s_waitcnt lgkmcnt(4)
    v_mfma_f32_16x16x32_bf16 a[32:35], v[56:59], a[208:211], a[32:35]
    s_lshl_b32 s70, s68, 9
    buffer_load_dwordx4 v[92:95], v1, s[24:27], s57 offen offset:3072 sc1
    v_mfma_f32_16x16x32_bf16 a[32:35], v[60:63], a[224:227], a[32:35]
    ds_read_b64_tr_b16 v[48:49], v7 offset:128
    v_mfma_f32_16x16x32_bf16 a[36:39], v[56:59], a[212:215], a[36:39]
    s_add_u32 s70, s70, s12
    buffer_load_dwordx4 v8, s[20:23], s52 offen offset:0 lds
    v_mfma_f32_16x16x32_bf16 a[36:39], v[60:63], a[228:231], a[36:39]
    ds_read_b64_tr_b16 v[50:51], v7 offset:2432
    v_mfma_f32_16x16x32_bf16 a[40:43], v[56:59], a[216:219], a[40:43]
    v_mfma_f32_16x16x32_bf16 a[40:43], v[60:63], a[232:235], a[40:43]
    s_lshl_b32 s13, s69, 8
    ds_read_b64_tr_b16 v[52:53], v7 offset:9344
    v_mfma_f32_16x16x32_bf16 a[44:47], v[56:59], a[220:223], a[44:47]
    v_mfma_f32_16x16x32_bf16 a[44:47], v[60:63], a[236:239], a[44:47]
    s_add_u32 s57, s48, 12288
    ds_read_b64_tr_b16 v[54:55], v7 offset:11648
    s_waitcnt lgkmcnt(4)
    v_mfma_f32_16x16x32_bf16 a[48:51], v[40:43], a[208:211], a[48:51]
    s_add_u32 s70, s70, s13
    buffer_load_dwordx4 v9, s[20:23], s52 offen offset:1024 lds
    v_mfma_f32_16x16x32_bf16 a[48:51], v[44:47], a[224:227], a[48:51]
    s_lshl_b32 s68, s68, 4
    ds_read_b64_tr_b16 v[56:57], v7 offset:160
    v_mfma_f32_16x16x32_bf16 a[52:55], v[40:43], a[212:215], a[52:55]
    v_mfma_f32_16x16x32_bf16 a[52:55], v[44:47], a[228:231], a[52:55]
    ds_read_b64_tr_b16 v[58:59], v7 offset:2464
    v_mfma_f32_16x16x32_bf16 a[56:59], v[40:43], a[216:219], a[56:59]
    s_mul_i32 s13, s69, 18432
    buffer_load_dwordx4 v10, s[20:23], s52 offen offset:2048 lds
    v_mfma_f32_16x16x32_bf16 a[56:59], v[44:47], a[232:235], a[56:59]
    ds_read_b64_tr_b16 v[60:61], v7 offset:9376
    v_mfma_f32_16x16x32_bf16 a[60:63], v[40:43], a[220:223], a[60:63]
    s_add_u32 s68, s68, s13
    buffer_load_dwordx4 v[224:227], v1, s[24:27], s57 offen offset:0 sc1
    v_mfma_f32_16x16x32_bf16 a[60:63], v[44:47], a[236:239], a[60:63]
    ds_read_b64_tr_b16 v[62:63], v7 offset:11680
    s_waitcnt lgkmcnt(4)
    v_mfma_f32_16x16x32_bf16 a[64:67], v[48:51], a[208:211], a[64:67]
    s_lshl_b32 s71, s2, 9
    v_mfma_f32_16x16x32_bf16 a[64:67], v[52:55], a[224:227], a[64:67]
    ds_read_b64_tr_b16 v[40:41], v7 offset:192
    v_mfma_f32_16x16x32_bf16 a[68:71], v[48:51], a[212:215], a[68:71]
    buffer_load_dwordx4 v11, s[20:23], s52 offen offset:3072 lds
    v_mfma_f32_16x16x32_bf16 a[68:71], v[52:55], a[228:231], a[68:71]
    s_add_u32 s71, s71, 15204352
    ds_read_b64_tr_b16 v[42:43], v7 offset:2496
    v_mfma_f32_16x16x32_bf16 a[72:75], v[48:51], a[216:219], a[72:75]
    buffer_load_dwordx4 v[228:231], v1, s[24:27], s57 offen offset:1024 sc1
    v_mfma_f32_16x16x32_bf16 a[72:75], v[52:55], a[232:235], a[72:75]
    s_lshl_b32 s13, s28, 9
    ds_read_b64_tr_b16 v[44:45], v7 offset:9408
    v_mfma_f32_16x16x32_bf16 a[76:79], v[48:51], a[220:223], a[76:79]
    v_mfma_f32_16x16x32_bf16 a[76:79], v[52:55], a[236:239], a[76:79]
    s_add_u32 m0, s40, 114688
    ds_read_b64_tr_b16 v[46:47], v7 offset:11712
    s_waitcnt lgkmcnt(4)
    v_mfma_f32_16x16x32_bf16 a[80:83], v[56:59], a[208:211], a[80:83]
    s_sub_u32 s71, s71, s13
    v_mfma_f32_16x16x32_bf16 a[80:83], v[60:63], a[224:227], a[80:83]
    ds_read_b64_tr_b16 v[48:49], v7 offset:224
    v_mfma_f32_16x16x32_bf16 a[84:87], v[56:59], a[212:215], a[84:87]
    buffer_load_dwordx4 v12, s[20:23], s52 offen offset:0 lds
    v_mfma_f32_16x16x32_bf16 a[84:87], v[60:63], a[228:231], a[84:87]
    ds_read_b64_tr_b16 v[50:51], v7 offset:2528
    v_mfma_f32_16x16x32_bf16 a[88:91], v[56:59], a[216:219], a[88:91]
    buffer_load_dwordx4 v[232:235], v1, s[24:27], s57 offen offset:2048 sc1
    v_mfma_f32_16x16x32_bf16 a[88:91], v[60:63], a[232:235], a[88:91]
    ds_read_b64_tr_b16 v[52:53], v7 offset:9440
    v_mfma_f32_16x16x32_bf16 a[92:95], v[56:59], a[220:223], a[92:95]
    v_mfma_f32_16x16x32_bf16 a[92:95], v[60:63], a[236:239], a[92:95]
    ds_read_b64_tr_b16 v[54:55], v7 offset:11744
    s_waitcnt lgkmcnt(4)
    v_mfma_f32_16x16x32_bf16 a[96:99], v[40:43], a[208:211], a[96:99]
    buffer_load_dwordx4 v13, s[20:23], s52 offen offset:1024 lds
    v_mfma_f32_16x16x32_bf16 a[96:99], v[44:47], a[224:227], a[96:99]
    ds_read_b64_tr_b16 v[56:57], v7 offset:256
    v_mfma_f32_16x16x32_bf16 a[100:103], v[40:43], a[212:215], a[100:103]
    buffer_load_dwordx4 v[236:239], v1, s[24:27], s57 offen offset:3072 sc1
    v_mfma_f32_16x16x32_bf16 a[100:103], v[44:47], a[228:231], a[100:103]
    ds_read_b64_tr_b16 v[58:59], v7 offset:2560
    v_mfma_f32_16x16x32_bf16 a[104:107], v[40:43], a[216:219], a[104:107]
    buffer_load_dwordx4 v14, s[20:23], s52 offen offset:2048 lds
    v_mfma_f32_16x16x32_bf16 a[104:107], v[44:47], a[232:235], a[104:107]
    ds_read_b64_tr_b16 v[60:61], v7 offset:9472
    v_mfma_f32_16x16x32_bf16 a[108:111], v[40:43], a[220:223], a[108:111]
    v_mfma_f32_16x16x32_bf16 a[108:111], v[44:47], a[236:239], a[108:111]
    ds_read_b64_tr_b16 v[62:63], v7 offset:11776
    s_waitcnt lgkmcnt(4)
    s_waitcnt vmcnt(33)
    s_barrier
    v_mfma_f32_16x16x32_bf16 a[112:115], v[48:51], a[208:211], a[112:115]
    v_mfma_f32_16x16x32_bf16 a[112:115], v[52:55], a[224:227], a[112:115]
    s_add_u32 s57, s50, 12288
    ds_read_b64_tr_b16 v[40:41], v7 offset:36864
    v_mfma_f32_16x16x32_bf16 a[116:119], v[48:51], a[212:215], a[116:119]
    buffer_load_dwordx4 v17, s[20:23], s52 offen offset:3072 lds
    v_mfma_f32_16x16x32_bf16 a[116:119], v[52:55], a[228:231], a[116:119]
    ds_read_b64_tr_b16 v[42:43], v7 offset:39168
    v_mfma_f32_16x16x32_bf16 a[120:123], v[48:51], a[216:219], a[120:123]
    buffer_load_dwordx4 v[240:243], v1, s[24:27], s57 offen offset:0 sc1
    v_mfma_f32_16x16x32_bf16 a[120:123], v[52:55], a[232:235], a[120:123]
    ds_read_b64_tr_b16 v[44:45], v7 offset:46080
    v_mfma_f32_16x16x32_bf16 a[124:127], v[48:51], a[220:223], a[124:127]
    v_mfma_f32_16x16x32_bf16 a[124:127], v[52:55], a[236:239], a[124:127]
    s_add_u32 m0, s40, 118784
    ds_read_b64_tr_b16 v[46:47], v7 offset:48384
    s_waitcnt lgkmcnt(4)
    v_mfma_f32_16x16x32_bf16 a[128:131], v[56:59], a[208:211], a[128:131]
    buffer_load_dwordx4 v[244:247], v1, s[24:27], s57 offen offset:1024 sc1
    v_mfma_f32_16x16x32_bf16 a[128:131], v[60:63], a[224:227], a[128:131]
    ds_read_b64_tr_b16 v[48:49], v7 offset:36896
    v_mfma_f32_16x16x32_bf16 a[132:135], v[56:59], a[212:215], a[132:135]
    buffer_load_dwordx4 v18, s[20:23], s52 offen offset:0 lds
    v_mfma_f32_16x16x32_bf16 a[132:135], v[60:63], a[228:231], a[132:135]
    ds_read_b64_tr_b16 v[50:51], v7 offset:39200
    v_mfma_f32_16x16x32_bf16 a[136:139], v[56:59], a[216:219], a[136:139]
    buffer_load_dwordx4 v[248:251], v1, s[24:27], s57 offen offset:2048 sc1
    v_mfma_f32_16x16x32_bf16 a[136:139], v[60:63], a[232:235], a[136:139]
    ds_read_b64_tr_b16 v[52:53], v7 offset:46112
    v_mfma_f32_16x16x32_bf16 a[140:143], v[56:59], a[220:223], a[140:143]
    v_mfma_f32_16x16x32_bf16 a[140:143], v[60:63], a[236:239], a[140:143]
    ds_read_b64_tr_b16 v[54:55], v7 offset:48416
    s_waitcnt lgkmcnt(4)
    s_waitcnt vmcnt(22)
    v_mfma_f32_16x16x32_bf16 a[0:3], v[40:43], a[240:243], a[0:3]
    s_barrier
    buffer_load_dwordx4 v[252:255], v1, s[24:27], s57 offen offset:3072 sc1
    v_mfma_f32_16x16x32_bf16 a[0:3], v[44:47], v[64:67], a[0:3]
    ds_read_b64_tr_b16 v[56:57], v7 offset:36928
    v_add_u32 v38, 0, v0
    v_mfma_f32_16x16x32_bf16 a[4:7], v[40:43], a[244:247], a[4:7]
    v_mul_u32_u24 v38, 3641, v38
    v_bfe_u32 v38, v38, 19, 1
    v_mfma_f32_16x16x32_bf16 a[4:7], v[44:47], v[68:71], a[4:7]
    s_add_u32 s57, s51, 12288
    ds_read_b64_tr_b16 v[58:59], v7 offset:39232
    v_xor_b32 v39, s30, v38
    v_mfma_f32_16x16x32_bf16 a[8:11], v[40:43], a[248:251], a[8:11]
    v_lshlrev_b32 v39, 1, v39
    v_sub_u32 v39, v39, v38
    v_mfma_f32_16x16x32_bf16 a[8:11], v[44:47], v[72:75], a[8:11]
    ds_read_b64_tr_b16 v[60:61], v7 offset:46144
    v_mul_i32_i24 v39, 18432, v39
    v_mfma_f32_16x16x32_bf16 a[12:15], v[40:43], a[252:255], a[12:15]
    v_add_u32 v8, v39, v8
    v_mfma_f32_16x16x32_bf16 a[12:15], v[44:47], v[76:79], a[12:15]
    ds_read_b64_tr_b16 v[62:63], v7 offset:48448
    s_waitcnt lgkmcnt(4)
    v_mfma_f32_16x16x32_bf16 a[16:19], v[48:51], a[240:243], a[16:19]
    v_add_u32 v38, 64, v0
    v_mul_u32_u24 v38, 3641, v38
    v_mfma_f32_16x16x32_bf16 a[16:19], v[52:55], v[64:67], a[16:19]
    ds_read_b64_tr_b16 v[40:41], v7 offset:36960
    v_bfe_u32 v38, v38, 19, 1
    v_mfma_f32_16x16x32_bf16 a[20:23], v[48:51], a[244:247], a[20:23]
    v_xor_b32 v39, s30, v38
    v_lshlrev_b32 v39, 1, v39
    v_mfma_f32_16x16x32_bf16 a[20:23], v[52:55], v[68:71], a[20:23]
    ds_read_b64_tr_b16 v[42:43], v7 offset:39264
    v_sub_u32 v39, v39, v38
    v_mfma_f32_16x16x32_bf16 a[24:27], v[48:51], a[248:251], a[24:27]
    v_mul_i32_i24 v39, 18432, v39
    v_add_u32 v9, v39, v9
    v_mfma_f32_16x16x32_bf16 a[24:27], v[52:55], v[72:75], a[24:27]
    ds_read_b64_tr_b16 v[44:45], v7 offset:46176
    v_add_u32 v38, 128, v0
    v_mfma_f32_16x16x32_bf16 a[28:31], v[48:51], a[252:255], a[28:31]
    v_mul_u32_u24 v38, 3641, v38
    v_bfe_u32 v38, v38, 19, 1
    v_mfma_f32_16x16x32_bf16 a[28:31], v[52:55], v[76:79], a[28:31]
    ds_read_b64_tr_b16 v[46:47], v7 offset:48480
    s_waitcnt lgkmcnt(4)
    v_mfma_f32_16x16x32_bf16 a[32:35], v[56:59], a[240:243], a[32:35]
    v_xor_b32 v39, s30, v38
    v_lshlrev_b32 v39, 1, v39
    v_mfma_f32_16x16x32_bf16 a[32:35], v[60:63], v[64:67], a[32:35]
    ds_read_b64_tr_b16 v[48:49], v7 offset:36992
    v_sub_u32 v39, v39, v38
    v_mfma_f32_16x16x32_bf16 a[36:39], v[56:59], a[244:247], a[36:39]
    v_mul_i32_i24 v39, 18432, v39
    v_add_u32 v10, v39, v10
    v_mfma_f32_16x16x32_bf16 a[36:39], v[60:63], v[68:71], a[36:39]
    ds_read_b64_tr_b16 v[50:51], v7 offset:39296
    v_add_u32 v38, 192, v0
    v_mfma_f32_16x16x32_bf16 a[40:43], v[56:59], a[248:251], a[40:43]
    v_mul_u32_u24 v38, 3641, v38
    v_bfe_u32 v38, v38, 19, 1
    v_mfma_f32_16x16x32_bf16 a[40:43], v[60:63], v[72:75], a[40:43]
    ds_read_b64_tr_b16 v[52:53], v7 offset:46208
    v_xor_b32 v39, s30, v38
    v_mfma_f32_16x16x32_bf16 a[44:47], v[56:59], a[252:255], a[44:47]
    v_lshlrev_b32 v39, 1, v39
    buffer_load_dwordx4 v[96:99], v1, s[24:27], s57 offen offset:0 sc1
    v_mfma_f32_16x16x32_bf16 a[44:47], v[60:63], v[76:79], a[44:47]
    ds_read_b64_tr_b16 v[54:55], v7 offset:48512
    s_waitcnt lgkmcnt(4)
    v_mfma_f32_16x16x32_bf16 a[48:51], v[40:43], a[240:243], a[48:51]
    v_sub_u32 v39, v39, v38
    v_mul_i32_i24 v39, 18432, v39
    v_mfma_f32_16x16x32_bf16 a[48:51], v[44:47], v[64:67], a[48:51]
    ds_read_b64_tr_b16 v[56:57], v7 offset:37024
    v_add_u32 v11, v39, v11
    v_mfma_f32_16x16x32_bf16 a[52:55], v[40:43], a[244:247], a[52:55]
    v_add_u32 v38, 256, v0
    v_mul_u32_u24 v38, 3641, v38
    v_mfma_f32_16x16x32_bf16 a[52:55], v[44:47], v[68:71], a[52:55]
    ds_read_b64_tr_b16 v[58:59], v7 offset:39328
    v_bfe_u32 v38, v38, 19, 1
    v_mfma_f32_16x16x32_bf16 a[56:59], v[40:43], a[248:251], a[56:59]
    v_xor_b32 v39, s30, v38
    v_lshlrev_b32 v39, 1, v39
    v_mfma_f32_16x16x32_bf16 a[56:59], v[44:47], v[72:75], a[56:59]
    ds_read_b64_tr_b16 v[60:61], v7 offset:46240
    v_sub_u32 v39, v39, v38
    v_mfma_f32_16x16x32_bf16 a[60:63], v[40:43], a[252:255], a[60:63]
    v_mul_i32_i24 v39, 18432, v39
    v_add_u32 v12, v39, v12
    v_mfma_f32_16x16x32_bf16 a[60:63], v[44:47], v[76:79], a[60:63]
    ds_read_b64_tr_b16 v[62:63], v7 offset:48544
    s_waitcnt lgkmcnt(4)
    v_mfma_f32_16x16x32_bf16 a[64:67], v[48:51], a[240:243], a[64:67]
    v_add_u32 v38, 320, v0
    v_mul_u32_u24 v38, 3641, v38
    v_mfma_f32_16x16x32_bf16 a[64:67], v[52:55], v[64:67], a[64:67]
    ds_read_b64_tr_b16 v[40:41], v7 offset:37056
    v_bfe_u32 v38, v38, 19, 1
    v_mfma_f32_16x16x32_bf16 a[68:71], v[48:51], a[244:247], a[68:71]
    v_xor_b32 v39, s30, v38
    v_lshlrev_b32 v39, 1, v39
    v_mfma_f32_16x16x32_bf16 a[68:71], v[52:55], v[68:71], a[68:71]
    ds_read_b64_tr_b16 v[42:43], v7 offset:39360
    v_sub_u32 v39, v39, v38
    v_mfma_f32_16x16x32_bf16 a[72:75], v[48:51], a[248:251], a[72:75]
    v_mul_i32_i24 v39, 18432, v39
    buffer_load_dwordx4 v[112:115], v1, s[24:27], s57 offen offset:1024 sc1
    v_mfma_f32_16x16x32_bf16 a[72:75], v[52:55], v[72:75], a[72:75]
    ds_read_b64_tr_b16 v[44:45], v7 offset:46272
    v_add_u32 v13, v39, v13
    v_mfma_f32_16x16x32_bf16 a[76:79], v[48:51], a[252:255], a[76:79]
    v_add_u32 v38, 384, v0
    v_mul_u32_u24 v38, 3641, v38
    v_mfma_f32_16x16x32_bf16 a[76:79], v[52:55], v[76:79], a[76:79]
    ds_read_b64_tr_b16 v[46:47], v7 offset:48576
    s_waitcnt lgkmcnt(4)
    v_mfma_f32_16x16x32_bf16 a[80:83], v[56:59], a[240:243], a[80:83]
    v_bfe_u32 v38, v38, 19, 1
    v_xor_b32 v39, s30, v38
    v_mfma_f32_16x16x32_bf16 a[80:83], v[60:63], v[64:67], a[80:83]
    ds_read_b64_tr_b16 v[48:49], v7 offset:37088
    v_lshlrev_b32 v39, 1, v39
    v_mfma_f32_16x16x32_bf16 a[84:87], v[56:59], a[244:247], a[84:87]
    v_sub_u32 v39, v39, v38
    v_mul_i32_i24 v39, 18432, v39
    v_mfma_f32_16x16x32_bf16 a[84:87], v[60:63], v[68:71], a[84:87]
    ds_read_b64_tr_b16 v[50:51], v7 offset:39392
    v_add_u32 v14, v39, v14
    v_mfma_f32_16x16x32_bf16 a[88:91], v[56:59], a[248:251], a[88:91]
    v_add_u32 v38, 448, v0
    v_mul_u32_u24 v38, 3641, v38
    v_mfma_f32_16x16x32_bf16 a[88:91], v[60:63], v[72:75], a[88:91]
    ds_read_b64_tr_b16 v[52:53], v7 offset:46304
    v_bfe_u32 v38, v38, 19, 1
    v_mfma_f32_16x16x32_bf16 a[92:95], v[56:59], a[252:255], a[92:95]
    v_xor_b32 v39, s30, v38
    buffer_load_dwordx4 v[128:131], v1, s[24:27], s57 offen offset:2048 sc1
    v_mfma_f32_16x16x32_bf16 a[92:95], v[60:63], v[76:79], a[92:95]
    ds_read_b64_tr_b16 v[54:55], v7 offset:48608
    s_waitcnt lgkmcnt(4)
    v_mfma_f32_16x16x32_bf16 a[96:99], v[40:43], a[240:243], a[96:99]
    v_lshlrev_b32 v39, 1, v39
    v_sub_u32 v39, v39, v38
    v_mfma_f32_16x16x32_bf16 a[96:99], v[44:47], v[64:67], a[96:99]
    ds_read_b64_tr_b16 v[56:57], v7 offset:37120
    v_mul_i32_i24 v39, 18432, v39
    v_mfma_f32_16x16x32_bf16 a[100:103], v[40:43], a[244:247], a[100:103]
    v_add_u32 v17, v39, v17
    v_add_u32 v38, 512, v0
    v_mfma_f32_16x16x32_bf16 a[100:103], v[44:47], v[68:71], a[100:103]
    ds_read_b64_tr_b16 v[58:59], v7 offset:39424
    v_mul_u32_u24 v38, 3641, v38
    v_mfma_f32_16x16x32_bf16 a[104:107], v[40:43], a[248:251], a[104:107]
    v_bfe_u32 v38, v38, 19, 1
    v_xor_b32 v39, s30, v38
    v_mfma_f32_16x16x32_bf16 a[104:107], v[44:47], v[72:75], a[104:107]
    ds_read_b64_tr_b16 v[60:61], v7 offset:46336
    v_lshlrev_b32 v39, 1, v39
    v_mfma_f32_16x16x32_bf16 a[108:111], v[40:43], a[252:255], a[108:111]
    v_sub_u32 v39, v39, v38
    v_mul_i32_i24 v39, 18432, v39
    v_mfma_f32_16x16x32_bf16 a[108:111], v[44:47], v[76:79], a[108:111]
    s_add_u32 m0, s40, 0
    ds_read_b64_tr_b16 v[62:63], v7 offset:48640
    s_waitcnt lgkmcnt(4)
    s_waitcnt vmcnt(24)
    s_barrier
    v_mfma_f32_16x16x32_bf16 a[112:115], v[48:51], a[240:243], a[112:115]
    v_add_u32 v18, v39, v18
    buffer_load_dwordx4 v[144:147], v1, s[24:27], s57 offen offset:3072 sc1
    v_mfma_f32_16x16x32_bf16 a[112:115], v[52:55], v[64:67], a[112:115]
    s_add_u32 s57, s48, 16384
    v_add_u32 v7, 73728, v7
    ds_read_b64_tr_b16 v[40:41], v7 offset:0
    v_mfma_f32_16x16x32_bf16 a[116:119], v[48:51], a[244:247], a[116:119]
    s_add_u32 s14, s45, 0
    s_add_u32 s15, s46, 0
    s_cmp_eq_u32 s31, 0
    s_cselect_b32 s52, s14, s15
    v_mfma_f32_16x16x32_bf16 a[116:119], v[52:55], v[68:71], a[116:119]
    ds_read_b64_tr_b16 v[42:43], v7 offset:2304
    buffer_load_dwordx2 v[110:111], v36, s[24:27], s57 offen offset:0 sc1
    v_mfma_f32_16x16x32_bf16 a[120:123], v[48:51], a[248:251], a[120:123]
    buffer_load_dwordx4 v8, s[20:23], s52 offen offset:0 lds
    buffer_load_dwordx2 v[126:127], v36, s[24:27], s57 offen offset:512 sc1
    v_mfma_f32_16x16x32_bf16 a[120:123], v[52:55], v[72:75], a[120:123]
    ds_read_b64_tr_b16 v[44:45], v7 offset:9216
    buffer_load_dwordx2 v[142:143], v36, s[24:27], s57 offen offset:1024 sc1
    v_mfma_f32_16x16x32_bf16 a[124:127], v[48:51], a[252:255], a[124:127]
    buffer_load_dwordx4 v9, s[20:23], s52 offen offset:1024 lds
    buffer_load_dwordx2 v[158:159], v36, s[24:27], s57 offen offset:1536 sc1
    v_mfma_f32_16x16x32_bf16 a[124:127], v[52:55], v[76:79], a[124:127]
    s_add_u32 s57, s50, 16384
    ds_read_b64_tr_b16 v[46:47], v7 offset:11520
    buffer_load_dwordx4 v10, s[20:23], s52 offen offset:2048 lds
    s_waitcnt lgkmcnt(4)
    v_mfma_f32_16x16x32_bf16 a[128:131], v[56:59], a[240:243], a[128:131]
    buffer_load_dwordx4 v11, s[20:23], s52 offen offset:3072 lds
    buffer_load_dwordx2 v[100:101], v36, s[24:27], s57 offen offset:0 sc1
    v_mfma_f32_16x16x32_bf16 a[128:131], v[60:63], v[64:67], a[128:131]
    s_add_u32 m0, s40, 4096
    ds_read_b64_tr_b16 v[48:49], v7 offset:32
    buffer_load_dwordx2 v[116:117], v36, s[24:27], s57 offen offset:512 sc1
    v_mfma_f32_16x16x32_bf16 a[132:135], v[56:59], a[244:247], a[132:135]
    buffer_load_dwordx4 v12, s[20:23], s52 offen offset:0 lds
    buffer_load_dwordx2 v[132:133], v36, s[24:27], s57 offen offset:1024 sc1
    v_mfma_f32_16x16x32_bf16 a[132:135], v[60:63], v[68:71], a[132:135]
    ds_read_b64_tr_b16 v[50:51], v7 offset:2336
    buffer_load_dwordx2 v[148:149], v36, s[24:27], s57 offen offset:1536 sc1
    v_mfma_f32_16x16x32_bf16 a[136:139], v[56:59], a[248:251], a[136:139]
    s_add_u32 s57, s51, 16384
    buffer_load_dwordx4 v13, s[20:23], s52 offen offset:1024 lds
    buffer_load_dwordx2 v[102:103], v36, s[24:27], s57 offen offset:0 sc1
    v_mfma_f32_16x16x32_bf16 a[136:139], v[60:63], v[72:75], a[136:139]
    ds_read_b64_tr_b16 v[52:53], v7 offset:9248
    buffer_load_dwordx4 v14, s[20:23], s52 offen offset:2048 lds
    buffer_load_dwordx4 v17, s[20:23], s52 offen offset:3072 lds
    v_mfma_f32_16x16x32_bf16 a[140:143], v[56:59], a[252:255], a[140:143]
    s_add_u32 m0, s40, 8192
    buffer_load_dwordx2 v[118:119], v36, s[24:27], s57 offen offset:512 sc1
    v_mfma_f32_16x16x32_bf16 a[140:143], v[60:63], v[76:79], a[140:143]
    ds_read_b64_tr_b16 v[54:55], v7 offset:11552
    buffer_load_dwordx4 v18, s[20:23], s52 offen offset:0 lds
    s_waitcnt lgkmcnt(4)
    s_waitcnt vmcnt(30)
    v_mfma_f32_16x16x32_bf16 a[0:3], v[40:43], v[80:83], a[0:3]
    s_barrier
    buffer_load_dwordx2 v[134:135], v36, s[24:27], s57 offen offset:1024 sc1
    buffer_load_dwordx2 v[150:151], v36, s[24:27], s57 offen offset:1536 sc1
    v_mfma_f32_16x16x32_bf16 a[0:3], v[44:47], v[224:227], a[0:3]
    ds_read_b64_tr_b16 v[56:57], v7 offset:64
    v_mfma_f32_16x16x32_bf16 a[4:7], v[40:43], v[84:87], a[4:7]
    v_mfma_f32_16x16x32_bf16 a[4:7], v[44:47], v[228:231], a[4:7]
    ds_read_b64_tr_b16 v[58:59], v7 offset:2368
    v_mfma_f32_16x16x32_bf16 a[8:11], v[40:43], v[88:91], a[8:11]
    v_add_u32 v22, 69632, v1
    v_mfma_f32_16x16x32_bf16 a[8:11], v[44:47], v[232:235], a[8:11]
    ds_read_b64_tr_b16 v[60:61], v7 offset:9280
    v_mfma_f32_16x16x32_bf16 a[12:15], v[40:43], v[92:95], a[12:15]
    v_mfma_f32_16x16x32_bf16 a[12:15], v[44:47], v[236:239], a[12:15]
    ds_read_b64_tr_b16 v[62:63], v7 offset:11584
    s_waitcnt lgkmcnt(4)
    v_mfma_f32_16x16x32_bf16 a[16:19], v[48:51], v[80:83], a[16:19]
    buffer_load_dwordx4 v[160:163], v5, s[24:27], s67 offen sc1
    v_mfma_f32_16x16x32_bf16 a[16:19], v[52:55], v[224:227], a[16:19]
    ds_read_b64_tr_b16 v[40:41], v7 offset:96
    v_mfma_f32_16x16x32_bf16 a[20:23], v[48:51], v[84:87], a[20:23]
    v_mfma_f32_16x16x32_bf16 a[20:23], v[52:55], v[228:231], a[20:23]
    ds_read_b64_tr_b16 v[42:43], v7 offset:2400
    v_mfma_f32_16x16x32_bf16 a[24:27], v[48:51], v[88:91], a[24:27]
    v_mfma_f32_16x16x32_bf16 a[24:27], v[52:55], v[232:235], a[24:27]
    ds_read_b64_tr_b16 v[44:45], v7 offset:9312
    v_mfma_f32_16x16x32_bf16 a[28:31], v[48:51], v[92:95], a[28:31]
    v_mfma_f32_16x16x32_bf16 a[28:31], v[52:55], v[236:239], a[28:31]
    ds_read_b64_tr_b16 v[46:47], v7 offset:11616
    s_waitcnt lgkmcnt(4)
    v_mfma_f32_16x16x32_bf16 a[32:35], v[56:59], v[80:83], a[32:35]
    v_mfma_f32_16x16x32_bf16 a[32:35], v[60:63], v[224:227], a[32:35]
    ds_read_b64_tr_b16 v[48:49], v7 offset:128
    v_mfma_f32_16x16x32_bf16 a[36:39], v[56:59], v[84:87], a[36:39]
    v_mfma_f32_16x16x32_bf16 a[36:39], v[60:63], v[228:231], a[36:39]
    ds_read_b64_tr_b16 v[50:51], v7 offset:2432
    v_mfma_f32_16x16x32_bf16 a[40:43], v[56:59], v[88:91], a[40:43]
    v_mfma_f32_16x16x32_bf16 a[40:43], v[60:63], v[232:235], a[40:43]
    ds_read_b64_tr_b16 v[52:53], v7 offset:9344
    v_mfma_f32_16x16x32_bf16 a[44:47], v[56:59], v[92:95], a[44:47]
    v_mfma_f32_16x16x32_bf16 a[44:47], v[60:63], v[236:239], a[44:47]
    ds_read_b64_tr_b16 v[54:55], v7 offset:11648
    s_waitcnt lgkmcnt(4)
    v_mfma_f32_16x16x32_bf16 a[48:51], v[40:43], v[80:83], a[48:51]
    v_mfma_f32_16x16x32_bf16 a[48:51], v[44:47], v[224:227], a[48:51]
    ds_read_b64_tr_b16 v[56:57], v7 offset:160
    v_mfma_f32_16x16x32_bf16 a[52:55], v[40:43], v[84:87], a[52:55]
    v_mfma_f32_16x16x32_bf16 a[52:55], v[44:47], v[228:231], a[52:55]
    ds_read_b64_tr_b16 v[58:59], v7 offset:2464
    v_mfma_f32_16x16x32_bf16 a[56:59], v[40:43], v[88:91], a[56:59]
    v_mfma_f32_16x16x32_bf16 a[56:59], v[44:47], v[232:235], a[56:59]
    ds_read_b64_tr_b16 v[60:61], v7 offset:9376
    v_mfma_f32_16x16x32_bf16 a[60:63], v[40:43], v[92:95], a[60:63]
    v_mfma_f32_16x16x32_bf16 a[60:63], v[44:47], v[236:239], a[60:63]
    ds_read_b64_tr_b16 v[62:63], v7 offset:11680
    s_waitcnt lgkmcnt(4)
    v_mfma_f32_16x16x32_bf16 a[64:67], v[48:51], v[80:83], a[64:67]
    v_mfma_f32_16x16x32_bf16 a[64:67], v[52:55], v[224:227], a[64:67]
    ds_read_b64_tr_b16 v[40:41], v7 offset:192
    v_mfma_f32_16x16x32_bf16 a[68:71], v[48:51], v[84:87], a[68:71]
    v_mfma_f32_16x16x32_bf16 a[68:71], v[52:55], v[228:231], a[68:71]
    ds_read_b64_tr_b16 v[42:43], v7 offset:2496
    v_mfma_f32_16x16x32_bf16 a[72:75], v[48:51], v[88:91], a[72:75]
    v_mfma_f32_16x16x32_bf16 a[72:75], v[52:55], v[232:235], a[72:75]
    ds_read_b64_tr_b16 v[44:45], v7 offset:9408
    v_mfma_f32_16x16x32_bf16 a[76:79], v[48:51], v[92:95], a[76:79]
    buffer_load_dwordx4 v[176:179], v5, s[24:27], s67 offen offset:256 sc1
    v_mfma_f32_16x16x32_bf16 a[76:79], v[52:55], v[236:239], a[76:79]
    ds_read_b64_tr_b16 v[46:47], v7 offset:11712
    s_waitcnt lgkmcnt(4)
    v_mfma_f32_16x16x32_bf16 a[80:83], v[56:59], v[80:83], a[80:83]
    v_mfma_f32_16x16x32_bf16 a[80:83], v[60:63], v[224:227], a[80:83]
    ds_read_b64_tr_b16 v[48:49], v7 offset:224
    v_mfma_f32_16x16x32_bf16 a[84:87], v[56:59], v[84:87], a[84:87]
    v_mfma_f32_16x16x32_bf16 a[84:87], v[60:63], v[228:231], a[84:87]
    ds_read_b64_tr_b16 v[50:51], v7 offset:2528
    v_mfma_f32_16x16x32_bf16 a[88:91], v[56:59], v[88:91], a[88:91]
    v_mfma_f32_16x16x32_bf16 a[88:91], v[60:63], v[232:235], a[88:91]
    ds_read_b64_tr_b16 v[52:53], v7 offset:9440
    v_mfma_f32_16x16x32_bf16 a[92:95], v[56:59], v[92:95], a[92:95]
    v_mfma_f32_16x16x32_bf16 a[92:95], v[60:63], v[236:239], a[92:95]
    ds_read_b64_tr_b16 v[54:55], v7 offset:11744
    s_waitcnt lgkmcnt(4)
    v_mfma_f32_16x16x32_bf16 a[96:99], v[40:43], v[80:83], a[96:99]
    v_mfma_f32_16x16x32_bf16 a[96:99], v[44:47], v[224:227], a[96:99]
    ds_read_b64_tr_b16 v[56:57], v7 offset:256
    v_mfma_f32_16x16x32_bf16 a[100:103], v[40:43], v[84:87], a[100:103]
    v_mfma_f32_16x16x32_bf16 a[100:103], v[44:47], v[228:231], a[100:103]
    ds_read_b64_tr_b16 v[58:59], v7 offset:2560
    v_mfma_f32_16x16x32_bf16 a[104:107], v[40:43], v[88:91], a[104:107]
    v_mfma_f32_16x16x32_bf16 a[104:107], v[44:47], v[232:235], a[104:107]
    ds_read_b64_tr_b16 v[60:61], v7 offset:9472
    v_mfma_f32_16x16x32_bf16 a[108:111], v[40:43], v[92:95], a[108:111]
    v_mfma_f32_16x16x32_bf16 a[108:111], v[44:47], v[236:239], a[108:111]
    ds_read_b64_tr_b16 v[62:63], v7 offset:11776
    s_waitcnt lgkmcnt(4)
    s_waitcnt vmcnt(4)
    s_barrier
    v_mfma_f32_16x16x32_bf16 a[112:115], v[48:51], v[80:83], a[112:115]
    ds_read_b64_tr_b16 v[164:165], v7 offset:36864
    v_mfma_f32_16x16x32_bf16 a[112:115], v[52:55], v[224:227], a[112:115]
    ds_read_b64_tr_b16 v[166:167], v7 offset:39168
    v_mfma_f32_16x16x32_bf16 a[116:119], v[48:51], v[84:87], a[116:119]
    ds_read_b64_tr_b16 v[168:169], v7 offset:46080
    v_mfma_f32_16x16x32_bf16 a[116:119], v[52:55], v[228:231], a[116:119]
    ds_read_b64_tr_b16 v[170:171], v7 offset:48384
    v_mfma_f32_16x16x32_bf16 a[120:123], v[48:51], v[88:91], a[120:123]
    v_add_u32 v7, 4294893568, v7
    ds_read_b64_tr_b16 v[172:173], v7 offset:0
    v_mfma_f32_16x16x32_bf16 a[120:123], v[52:55], v[232:235], a[120:123]
    ds_read_b64_tr_b16 v[174:175], v7 offset:2304
    v_mfma_f32_16x16x32_bf16 a[124:127], v[48:51], v[92:95], a[124:127]
    ds_read_b64_tr_b16 v[180:181], v7 offset:9216
    v_mfma_f32_16x16x32_bf16 a[124:127], v[52:55], v[236:239], a[124:127]
    ds_read_b64_tr_b16 v[182:183], v7 offset:11520
    s_waitcnt lgkmcnt(8)
    v_mfma_f32_16x16x32_bf16 a[128:131], v[56:59], v[80:83], a[128:131]
    v_mfma_f32_16x16x32_bf16 a[128:131], v[60:63], v[224:227], a[128:131]
    v_mfma_f32_16x16x32_bf16 a[132:135], v[56:59], v[84:87], a[132:135]
    v_mfma_f32_16x16x32_bf16 a[132:135], v[60:63], v[228:231], a[132:135]
    v_mfma_f32_16x16x32_bf16 a[136:139], v[56:59], v[88:91], a[136:139]
    v_mfma_f32_16x16x32_bf16 a[136:139], v[60:63], v[232:235], a[136:139]
    v_mfma_f32_16x16x32_bf16 a[140:143], v[56:59], v[92:95], a[140:143]
    v_mfma_f32_16x16x32_bf16 a[140:143], v[60:63], v[236:239], a[140:143]
    s_waitcnt lgkmcnt(0)
    s_waitcnt vmcnt(2)
    v_mfma_f32_16x16x32_bf16 a[0:3], v[164:167], v[240:243], a[0:3]
    v_add_u32 v7, 106496, v7
    ds_read_b64_tr_b16 v[40:41], v7 offset:4128
    v_mfma_f32_16x16x32_bf16 a[0:3], v[168:171], v[96:99], a[0:3]
    ds_read_b64_tr_b16 v[42:43], v7 offset:6432
    v_mfma_f32_16x16x32_bf16 a[0:3], v[172:175], v[108:111], a[0:3]
    ds_read_b64_tr_b16 v[44:45], v7 offset:13344
    v_mfma_f32_16x16x32_bf16 a[0:3], v[180:183], v[100:103], a[0:3]
    ds_read_b64_tr_b16 v[46:47], v7 offset:15648
    v_mfma_f32_16x16x32_bf16 a[4:7], v[164:167], v[244:247], a[4:7]
    v_mfma_f32_16x16x32_bf16 a[4:7], v[168:171], v[112:115], a[4:7]
    v_add_u32 v7, 4294860800, v7
    ds_read_b64_tr_b16 v[48:49], v7 offset:32
    v_mfma_f32_16x16x32_bf16 a[4:7], v[172:175], v[124:127], a[4:7]
    ds_read_b64_tr_b16 v[50:51], v7 offset:2336
    v_mfma_f32_16x16x32_bf16 a[4:7], v[180:183], v[116:119], a[4:7]
    ds_read_b64_tr_b16 v[52:53], v7 offset:9248
    v_mfma_f32_16x16x32_bf16 a[8:11], v[164:167], v[248:251], a[8:11]
    ds_read_b64_tr_b16 v[54:55], v7 offset:11552
    v_mfma_f32_16x16x32_bf16 a[8:11], v[168:171], v[128:131], a[8:11]
    v_mfma_f32_16x16x32_bf16 a[8:11], v[172:175], v[140:143], a[8:11]
    v_mfma_f32_16x16x32_bf16 a[8:11], v[180:183], v[132:135], a[8:11]
    v_mfma_f32_16x16x32_bf16 a[12:15], v[164:167], v[252:255], a[12:15]
    v_mfma_f32_16x16x32_bf16 a[12:15], v[168:171], v[144:147], a[12:15]
    v_mfma_f32_16x16x32_bf16 a[12:15], v[172:175], v[156:159], a[12:15]
    v_mfma_f32_16x16x32_bf16 a[12:15], v[180:183], v[148:151], a[12:15]
    s_waitcnt lgkmcnt(0)
    v_mfma_f32_16x16x32_bf16 a[16:19], v[40:43], v[240:243], a[16:19]
    v_add_u32 v7, 106496, v7
    ds_read_b64_tr_b16 v[164:165], v7 offset:4160
    v_mfma_f32_16x16x32_bf16 a[16:19], v[44:47], v[96:99], a[16:19]
    ds_read_b64_tr_b16 v[166:167], v7 offset:6464
    v_mfma_f32_16x16x32_bf16 a[16:19], v[48:51], v[108:111], a[16:19]
    ds_read_b64_tr_b16 v[168:169], v7 offset:13376
    v_mfma_f32_16x16x32_bf16 a[16:19], v[52:55], v[100:103], a[16:19]
    ds_read_b64_tr_b16 v[170:171], v7 offset:15680
    v_mfma_f32_16x16x32_bf16 a[20:23], v[40:43], v[244:247], a[20:23]
    v_mfma_f32_16x16x32_bf16 a[20:23], v[44:47], v[112:115], a[20:23]
    v_add_u32 v7, 4294860800, v7
    ds_read_b64_tr_b16 v[172:173], v7 offset:64
    v_mfma_f32_16x16x32_bf16 a[20:23], v[48:51], v[124:127], a[20:23]
    ds_read_b64_tr_b16 v[174:175], v7 offset:2368
    v_mfma_f32_16x16x32_bf16 a[20:23], v[52:55], v[116:119], a[20:23]
    ds_read_b64_tr_b16 v[180:181], v7 offset:9280
    v_mfma_f32_16x16x32_bf16 a[24:27], v[40:43], v[248:251], a[24:27]
    ds_read_b64_tr_b16 v[182:183], v7 offset:11584
    v_mfma_f32_16x16x32_bf16 a[24:27], v[44:47], v[128:131], a[24:27]
    v_mfma_f32_16x16x32_bf16 a[24:27], v[48:51], v[140:143], a[24:27]
    v_mfma_f32_16x16x32_bf16 a[24:27], v[52:55], v[132:135], a[24:27]
    v_mfma_f32_16x16x32_bf16 a[28:31], v[40:43], v[252:255], a[28:31]
    v_mfma_f32_16x16x32_bf16 a[28:31], v[44:47], v[144:147], a[28:31]
    v_mfma_f32_16x16x32_bf16 a[28:31], v[48:51], v[156:159], a[28:31]
    v_mfma_f32_16x16x32_bf16 a[28:31], v[52:55], v[148:151], a[28:31]
    s_waitcnt lgkmcnt(0)
    v_mfma_f32_16x16x32_bf16 a[32:35], v[164:167], v[240:243], a[32:35]
    v_add_u32 v7, 106496, v7
    ds_read_b64_tr_b16 v[40:41], v7 offset:4192
    v_mfma_f32_16x16x32_bf16 a[32:35], v[168:171], v[96:99], a[32:35]
    ds_read_b64_tr_b16 v[42:43], v7 offset:6496
    v_mfma_f32_16x16x32_bf16 a[32:35], v[172:175], v[108:111], a[32:35]
    ds_read_b64_tr_b16 v[44:45], v7 offset:13408
    v_mfma_f32_16x16x32_bf16 a[32:35], v[180:183], v[100:103], a[32:35]
    ds_read_b64_tr_b16 v[46:47], v7 offset:15712
    v_mfma_f32_16x16x32_bf16 a[36:39], v[164:167], v[244:247], a[36:39]
    ds_write_b128 v19, a[8:11] offset:0
    v_mfma_f32_16x16x32_bf16 a[36:39], v[168:171], v[112:115], a[36:39]
    v_add_u32 v7, 4294860800, v7
    ds_read_b64_tr_b16 v[48:49], v7 offset:96
    v_mfma_f32_16x16x32_bf16 a[36:39], v[172:175], v[124:127], a[36:39]
    ds_read_b64_tr_b16 v[50:51], v7 offset:2400
    v_mfma_f32_16x16x32_bf16 a[36:39], v[180:183], v[116:119], a[36:39]
    ds_read_b64_tr_b16 v[52:53], v7 offset:9312
    v_mfma_f32_16x16x32_bf16 a[40:43], v[164:167], v[248:251], a[40:43]
    ds_read_b64_tr_b16 v[54:55], v7 offset:11616
    v_mfma_f32_16x16x32_bf16 a[40:43], v[168:171], v[128:131], a[40:43]
    ds_write_b128 v19, a[24:27] offset:1024
    v_mfma_f32_16x16x32_bf16 a[40:43], v[172:175], v[140:143], a[40:43]
    ds_write_b128 v19, a[12:15] offset:2048
    v_mfma_f32_16x16x32_bf16 a[40:43], v[180:183], v[132:135], a[40:43]
    ds_write_b128 v19, a[28:31] offset:3072
    v_mfma_f32_16x16x32_bf16 a[44:47], v[164:167], v[252:255], a[44:47]
    v_mfma_f32_16x16x32_bf16 a[44:47], v[168:171], v[144:147], a[44:47]
    v_mfma_f32_16x16x32_bf16 a[44:47], v[172:175], v[156:159], a[44:47]
    v_mfma_f32_16x16x32_bf16 a[44:47], v[180:183], v[148:151], a[44:47]
    s_waitcnt lgkmcnt(3)
    v_mfma_f32_16x16x32_bf16 a[48:51], v[40:43], v[240:243], a[48:51]
    v_add_u32 v7, 106496, v7
    ds_read_b64_tr_b16 v[164:165], v7 offset:4224
    v_mfma_f32_16x16x32_bf16 a[48:51], v[44:47], v[96:99], a[48:51]
    ds_read_b64_tr_b16 v[166:167], v7 offset:6528
    v_mfma_f32_16x16x32_bf16 a[48:51], v[48:51], v[108:111], a[48:51]
    ds_read_b64_tr_b16 v[168:169], v7 offset:13440
    v_mfma_f32_16x16x32_bf16 a[48:51], v[52:55], v[100:103], a[48:51]
    ds_read_b64_tr_b16 v[170:171], v7 offset:15744
    v_mfma_f32_16x16x32_bf16 a[52:55], v[40:43], v[244:247], a[52:55]
    s_waitcnt lgkmcnt(4)
    s_barrier
    ds_read_b128 v[184:187], v20 offset:0
    v_mfma_f32_16x16x32_bf16 a[52:55], v[44:47], v[112:115], a[52:55]
    v_add_u32 v7, 4294860800, v7
    ds_read_b64_tr_b16 v[172:173], v7 offset:128
    v_mfma_f32_16x16x32_bf16 a[52:55], v[48:51], v[124:127], a[52:55]
    ds_read_b64_tr_b16 v[174:175], v7 offset:2432
    ds_read_b128 v[188:191], v20 offset:1024
    v_mfma_f32_16x16x32_bf16 a[52:55], v[52:55], v[116:119], a[52:55]
    ds_read_b64_tr_b16 v[180:181], v7 offset:9344
    ds_read_b128 v[196:199], v20 offset:2048
    v_mfma_f32_16x16x32_bf16 a[56:59], v[40:43], v[248:251], a[56:59]
    ds_read_b64_tr_b16 v[182:183], v7 offset:11648
    ds_read_b128 v[200:203], v20 offset:3072
    v_mfma_f32_16x16x32_bf16 a[56:59], v[44:47], v[128:131], a[56:59]
    v_mfma_f32_16x16x32_bf16 a[56:59], v[48:51], v[140:143], a[56:59]
    v_mfma_f32_16x16x32_bf16 a[56:59], v[52:55], v[132:135], a[56:59]
    v_mfma_f32_16x16x32_bf16 a[60:63], v[40:43], v[252:255], a[60:63]
    v_mfma_f32_16x16x32_bf16 a[60:63], v[44:47], v[144:147], a[60:63]
    s_waitcnt lgkmcnt(0)
    v_accvgpr_read_b32 v28, a0
    v_accvgpr_read_b32 v29, a1
    v_mfma_f32_16x16x32_bf16 a[60:63], v[48:51], v[156:159], a[60:63]
    v_accvgpr_read_b32 v30, a2
    v_accvgpr_read_b32 v31, a3
    v_mfma_f32_16x16x32_bf16 a[60:63], v[52:55], v[148:151], a[60:63]
    v_add_f32 v184, v184, v28
    s_waitcnt lgkmcnt(1)
    v_mfma_f32_16x16x32_bf16 a[64:67], v[164:167], v[240:243], a[64:67]
    v_add_u32 v7, 106496, v7
    ds_read_b64_tr_b16 v[40:41], v7 offset:4256
    v_add_f32 v185, v185, v29
    v_mfma_f32_16x16x32_bf16 a[64:67], v[168:171], v[96:99], a[64:67]
    s_add_u32 s55, s58, 0
    ds_read_b64_tr_b16 v[42:43], v7 offset:6560
    v_add_f32 v186, v186, v30
    v_add_f32 v187, v187, v31
    v_mfma_f32_16x16x32_bf16 a[64:67], v[172:175], v[108:111], a[64:67]
    ds_read_b64_tr_b16 v[44:45], v7 offset:13472
    v_cvt_pk_bf16_f32 v104, v184, v185
    v_mfma_f32_16x16x32_bf16 a[64:67], v[180:183], v[100:103], a[64:67]
    ds_read_b64_tr_b16 v[46:47], v7 offset:15776
    v_cvt_pk_bf16_f32 v105, v186, v187
    v_accvgpr_read_b32 v32, a16
    v_mfma_f32_16x16x32_bf16 a[68:71], v[164:167], v[244:247], a[68:71]
    ds_write_b128 v19, a[40:43] offset:4096
    v_mfma_f32_16x16x32_bf16 a[68:71], v[168:171], v[112:115], a[68:71]
    v_add_u32 v7, 4294860800, v7
    ds_read_b64_tr_b16 v[48:49], v7 offset:160
    v_accvgpr_read_b32 v33, a17
    v_accvgpr_read_b32 v34, a18
    v_mfma_f32_16x16x32_bf16 a[68:71], v[172:175], v[124:127], a[68:71]
    ds_read_b64_tr_b16 v[50:51], v7 offset:2464
    v_accvgpr_read_b32 v35, a19
    v_add_f32 v188, v188, v32
    v_add_f32 v189, v189, v33
    v_mfma_f32_16x16x32_bf16 a[68:71], v[180:183], v[116:119], a[68:71]
    ds_read_b64_tr_b16 v[52:53], v7 offset:9376
    v_add_f32 v190, v190, v34
    v_add_f32 v191, v191, v35
    v_cvt_pk_bf16_f32 v106, v188, v189
    v_mfma_f32_16x16x32_bf16 a[72:75], v[164:167], v[248:251], a[72:75]
    ds_read_b64_tr_b16 v[54:55], v7 offset:11680
    v_cvt_pk_bf16_f32 v107, v190, v191
    v_accvgpr_read_b32 v28, a4
    v_accvgpr_read_b32 v29, a5
    v_mfma_f32_16x16x32_bf16 a[72:75], v[168:171], v[128:131], a[72:75]
    ds_write_b128 v19, a[56:59] offset:5120
    v_mfma_f32_16x16x32_bf16 a[72:75], v[172:175], v[140:143], a[72:75]
    ds_write_b128 v19, a[44:47] offset:6144
    v_mfma_f32_16x16x32_bf16 a[72:75], v[180:183], v[132:135], a[72:75]
    ds_write_b128 v19, a[60:63] offset:7168
    v_mfma_f32_16x16x32_bf16 a[76:79], v[164:167], v[252:255], a[76:79]
    v_permlane16_swap_b32 v104, v106
    v_permlane16_swap_b32 v105, v107
    v_mfma_f32_16x16x32_bf16 a[76:79], v[168:171], v[144:147], a[76:79]
    buffer_store_dwordx4 v[104:107], v1, s[24:27], s55 offen sc1
    v_mfma_f32_16x16x32_bf16 a[76:79], v[172:175], v[156:159], a[76:79]
    s_cmp_eq_u32 s56, 0
    s_cbranch_scc1 L_own0
    ds_write_b128 v22, v[104:107] offset:0
L_own0:
    v_accvgpr_read_b32 v30, a6
    v_mfma_f32_16x16x32_bf16 a[76:79], v[180:183], v[148:151], a[76:79]
    v_accvgpr_read_b32 v31, a7
    s_waitcnt lgkmcnt(3)
    v_mfma_f32_16x16x32_bf16 a[80:83], v[40:43], v[240:243], a[80:83]
    v_add_u32 v7, 106496, v7
    ds_read_b64_tr_b16 v[164:165], v7 offset:4288
    v_add_f32 v196, v196, v28
    v_add_f32 v197, v197, v29
    v_mfma_f32_16x16x32_bf16 a[80:83], v[44:47], v[96:99], a[80:83]
    s_add_u32 s55, s58, 1024
    ds_read_b64_tr_b16 v[166:167], v7 offset:6592
    v_add_f32 v198, v198, v30
    v_add_f32 v199, v199, v31
    v_mfma_f32_16x16x32_bf16 a[80:83], v[48:51], v[108:111], a[80:83]
    ds_read_b64_tr_b16 v[168:169], v7 offset:13504
    v_cvt_pk_bf16_f32 v120, v196, v197
    v_cvt_pk_bf16_f32 v121, v198, v199
    v_mfma_f32_16x16x32_bf16 a[80:83], v[52:55], v[100:103], a[80:83]
    ds_read_b64_tr_b16 v[170:171], v7 offset:15808
    v_accvgpr_read_b32 v32, a20
    v_accvgpr_read_b32 v33, a21
    v_mfma_f32_16x16x32_bf16 a[84:87], v[40:43], v[244:247], a[84:87]
    s_waitcnt lgkmcnt(4)
    s_barrier
    ds_read_b128 v[204:207], v20 offset:4096
    v_accvgpr_read_b32 v34, a22
    v_accvgpr_read_b32 v35, a23
    v_mfma_f32_16x16x32_bf16 a[84:87], v[44:47], v[112:115], a[84:87]
    v_add_u32 v7, 4294860800, v7
    ds_read_b64_tr_b16 v[172:173], v7 offset:192
    v_add_f32 v200, v200, v32
    v_add_f32 v201, v201, v33
    v_mfma_f32_16x16x32_bf16 a[84:87], v[48:51], v[124:127], a[84:87]
    ds_read_b64_tr_b16 v[174:175], v7 offset:2496
    ds_read_b128 v[212:215], v20 offset:5120
    v_add_f32 v202, v202, v34
    v_add_f32 v203, v203, v35
    v_mfma_f32_16x16x32_bf16 a[84:87], v[52:55], v[116:119], a[84:87]
    ds_read_b64_tr_b16 v[180:181], v7 offset:9408
    ds_read_b128 v[216:219], v20 offset:6144
    v_cvt_pk_bf16_f32 v122, v200, v201
    v_cvt_pk_bf16_f32 v123, v202, v203
    v_mfma_f32_16x16x32_bf16 a[88:91], v[40:43], v[248:251], a[88:91]
    ds_read_b64_tr_b16 v[182:183], v7 offset:11712
    ds_read_b128 v[220:223], v20 offset:7168
    v_mfma_f32_16x16x32_bf16 a[88:91], v[44:47], v[128:131], a[88:91]
    v_permlane16_swap_b32 v120, v122
    v_permlane16_swap_b32 v121, v123
    v_mfma_f32_16x16x32_bf16 a[88:91], v[48:51], v[140:143], a[88:91]
    buffer_store_dwordx4 v[120:123], v1, s[24:27], s55 offen sc1
    v_mfma_f32_16x16x32_bf16 a[88:91], v[52:55], v[132:135], a[88:91]
    s_cmp_eq_u32 s56, 0
    s_cbranch_scc1 L_own1
    ds_write_b128 v22, v[120:123] offset:1024
L_own1:
    v_mfma_f32_16x16x32_bf16 a[92:95], v[40:43], v[252:255], a[92:95]
    v_mfma_f32_16x16x32_bf16 a[92:95], v[44:47], v[144:147], a[92:95]
    s_waitcnt lgkmcnt(0)
    v_accvgpr_read_b32 v28, a32
    v_accvgpr_read_b32 v29, a33
    v_mfma_f32_16x16x32_bf16 a[92:95], v[48:51], v[156:159], a[92:95]
    v_accvgpr_read_b32 v30, a34
    v_accvgpr_read_b32 v31, a35
    v_mfma_f32_16x16x32_bf16 a[92:95], v[52:55], v[148:151], a[92:95]
    v_add_f32 v204, v204, v28
    s_waitcnt lgkmcnt(1)
    v_mfma_f32_16x16x32_bf16 a[96:99], v[164:167], v[240:243], a[96:99]
    v_add_u32 v7, 106496, v7
    ds_read_b64_tr_b16 v[40:41], v7 offset:4320
    v_add_f32 v205, v205, v29
    v_mfma_f32_16x16x32_bf16 a[96:99], v[168:171], v[96:99], a[96:99]
    s_add_u32 s55, s58, 2048
    ds_read_b64_tr_b16 v[42:43], v7 offset:6624
    v_add_f32 v206, v206, v30
    v_add_f32 v207, v207, v31
    v_mfma_f32_16x16x32_bf16 a[96:99], v[172:175], v[108:111], a[96:99]
    ds_read_b64_tr_b16 v[44:45], v7 offset:13536
    v_cvt_pk_bf16_f32 v136, v204, v205
    v_mfma_f32_16x16x32_bf16 a[96:99], v[180:183], v[100:103], a[96:99]
    ds_read_b64_tr_b16 v[46:47], v7 offset:15840
    v_cvt_pk_bf16_f32 v137, v206, v207
    v_accvgpr_read_b32 v32, a48
    v_mfma_f32_16x16x32_bf16 a[100:103], v[164:167], v[244:247], a[100:103]
    ds_write_b128 v19, a[72:75] offset:0
    v_mfma_f32_16x16x32_bf16 a[100:103], v[168:171], v[112:115], a[100:103]
    v_add_u32 v7, 4294860800, v7
    ds_read_b64_tr_b16 v[48:49], v7 offset:224
    v_accvgpr_read_b32 v33, a49
    v_accvgpr_read_b32 v34, a50
    v_mfma_f32_16x16x32_bf16 a[100:103], v[172:175], v[124:127], a[100:103]
    ds_read_b64_tr_b16 v[50:51], v7 offset:2528
    v_accvgpr_read_b32 v35, a51
    v_add_f32 v212, v212, v32
    v_add_f32 v213, v213, v33
    v_mfma_f32_16x16x32_bf16 a[100:103], v[180:183], v[116:119], a[100:103]
    ds_read_b64_tr_b16 v[52:53], v7 offset:9440
    v_add_f32 v214, v214, v34
    v_add_f32 v215, v215, v35
    v_cvt_pk_bf16_f32 v138, v212, v213
    v_mfma_f32_16x16x32_bf16 a[104:107], v[164:167], v[248:251], a[104:107]
    ds_read_b64_tr_b16 v[54:55], v7 offset:11744
    v_cvt_pk_bf16_f32 v139, v214, v215
    v_accvgpr_read_b32 v28, a36
    v_accvgpr_read_b32 v29, a37
    v_mfma_f32_16x16x32_bf16 a[104:107], v[168:171], v[128:131], a[104:107]
    ds_write_b128 v19, a[88:91] offset:1024
    v_mfma_f32_16x16x32_bf16 a[104:107], v[172:175], v[140:143], a[104:107]
    ds_write_b128 v19, a[76:79] offset:2048
    v_mfma_f32_16x16x32_bf16 a[104:107], v[180:183], v[132:135], a[104:107]
    ds_write_b128 v19, a[92:95] offset:3072
    v_mfma_f32_16x16x32_bf16 a[108:111], v[164:167], v[252:255], a[108:111]
    v_permlane16_swap_b32 v136, v138
    v_permlane16_swap_b32 v137, v139
    v_mfma_f32_16x16x32_bf16 a[108:111], v[168:171], v[144:147], a[108:111]
    buffer_store_dwordx4 v[136:139], v1, s[24:27], s55 offen sc1
    v_mfma_f32_16x16x32_bf16 a[108:111], v[172:175], v[156:159], a[108:111]
    s_cmp_eq_u32 s56, 0
    s_cbranch_scc1 L_own2
    ds_write_b128 v22, v[136:139] offset:2048
L_own2:
    v_accvgpr_read_b32 v30, a38
    v_mfma_f32_16x16x32_bf16 a[108:111], v[180:183], v[148:151], a[108:111]
    v_accvgpr_read_b32 v31, a39
    s_waitcnt lgkmcnt(3)
    v_mfma_f32_16x16x32_bf16 a[112:115], v[40:43], v[240:243], a[112:115]
    v_add_u32 v7, 106496, v7
    ds_read_b64_tr_b16 v[164:165], v7 offset:4352
    v_add_f32 v216, v216, v28
    v_add_f32 v217, v217, v29
    v_mfma_f32_16x16x32_bf16 a[112:115], v[44:47], v[96:99], a[112:115]
    s_add_u32 s55, s58, 3072
    ds_read_b64_tr_b16 v[166:167], v7 offset:6656
    v_add_f32 v218, v218, v30
    v_add_f32 v219, v219, v31
    v_mfma_f32_16x16x32_bf16 a[112:115], v[48:51], v[108:111], a[112:115]
    ds_read_b64_tr_b16 v[168:169], v7 offset:13568
    v_cvt_pk_bf16_f32 v152, v216, v217
    v_cvt_pk_bf16_f32 v153, v218, v219
    v_mfma_f32_16x16x32_bf16 a[112:115], v[52:55], v[100:103], a[112:115]
    ds_read_b64_tr_b16 v[170:171], v7 offset:15872
    v_accvgpr_read_b32 v32, a52
    v_accvgpr_read_b32 v33, a53
    v_mfma_f32_16x16x32_bf16 a[116:119], v[40:43], v[244:247], a[116:119]
    s_waitcnt lgkmcnt(4)
    s_barrier
    ds_read_b128 v[184:187], v20 offset:0
    v_accvgpr_read_b32 v34, a54
    v_accvgpr_read_b32 v35, a55
    v_mfma_f32_16x16x32_bf16 a[116:119], v[44:47], v[112:115], a[116:119]
    v_add_u32 v7, 4294860800, v7
    ds_read_b64_tr_b16 v[172:173], v7 offset:256
    v_add_f32 v220, v220, v32
    v_add_f32 v221, v221, v33
    v_mfma_f32_16x16x32_bf16 a[116:119], v[48:51], v[124:127], a[116:119]
    ds_read_b64_tr_b16 v[174:175], v7 offset:2560
    ds_read_b128 v[188:191], v20 offset:1024
    v_add_f32 v222, v222, v34
    v_add_f32 v223, v223, v35
    v_mfma_f32_16x16x32_bf16 a[116:119], v[52:55], v[116:119], a[116:119]
    ds_read_b64_tr_b16 v[180:181], v7 offset:9472
    ds_read_b128 v[196:199], v20 offset:2048
    v_cvt_pk_bf16_f32 v154, v220, v221
    v_cvt_pk_bf16_f32 v155, v222, v223
    v_mfma_f32_16x16x32_bf16 a[120:123], v[40:43], v[248:251], a[120:123]
    ds_read_b64_tr_b16 v[182:183], v7 offset:11776
    ds_read_b128 v[200:203], v20 offset:3072
    v_mfma_f32_16x16x32_bf16 a[120:123], v[44:47], v[128:131], a[120:123]
    v_permlane16_swap_b32 v152, v154
    v_permlane16_swap_b32 v153, v155
    v_mfma_f32_16x16x32_bf16 a[120:123], v[48:51], v[140:143], a[120:123]
    buffer_store_dwordx4 v[152:155], v1, s[24:27], s55 offen sc1
    v_mfma_f32_16x16x32_bf16 a[120:123], v[52:55], v[132:135], a[120:123]
    s_cmp_eq_u32 s56, 0
    s_cbranch_scc1 L_own3
    ds_write_b128 v22, v[152:155] offset:3072
L_own3:
    v_mfma_f32_16x16x32_bf16 a[124:127], v[40:43], v[252:255], a[124:127]
    v_mfma_f32_16x16x32_bf16 a[124:127], v[44:47], v[144:147], a[124:127]
    s_waitcnt lgkmcnt(0)
    v_accvgpr_read_b32 v28, a64
    v_accvgpr_read_b32 v29, a65
    v_mfma_f32_16x16x32_bf16 a[124:127], v[48:51], v[156:159], a[124:127]
    v_accvgpr_read_b32 v30, a66
    v_accvgpr_read_b32 v31, a67
    v_add_f32 v184, v184, v28
    v_mfma_f32_16x16x32_bf16 a[124:127], v[52:55], v[148:151], a[124:127]
    s_add_u32 s55, s58, 4096
    v_add_f32 v185, v185, v29
    v_add_f32 v186, v186, v30
    v_add_f32 v187, v187, v31
    s_waitcnt lgkmcnt(1)
    v_mfma_f32_16x16x32_bf16 a[128:131], v[164:167], v[240:243], a[128:131]
    v_cvt_pk_bf16_f32 v104, v184, v185
    v_cvt_pk_bf16_f32 v105, v186, v187
    v_accvgpr_read_b32 v32, a80
    v_mfma_f32_16x16x32_bf16 a[128:131], v[168:171], v[96:99], a[128:131]
    v_accvgpr_read_b32 v33, a81
    v_accvgpr_read_b32 v34, a82
    v_accvgpr_read_b32 v35, a83
    v_mfma_f32_16x16x32_bf16 a[128:131], v[172:175], v[108:111], a[128:131]
    v_add_f32 v188, v188, v32
    v_add_f32 v189, v189, v33
    v_add_f32 v190, v190, v34
    v_add_f32 v191, v191, v35
    v_mfma_f32_16x16x32_bf16 a[128:131], v[180:183], v[100:103], a[128:131]
    v_cvt_pk_bf16_f32 v106, v188, v189
    v_cvt_pk_bf16_f32 v107, v190, v191
    v_accvgpr_read_b32 v28, a68
    v_mfma_f32_16x16x32_bf16 a[132:135], v[164:167], v[244:247], a[132:135]
    ds_write_b128 v19, a[104:107] offset:4096
    v_accvgpr_read_b32 v29, a69
    v_mfma_f32_16x16x32_bf16 a[132:135], v[168:171], v[112:115], a[132:135]
    ds_write_b128 v19, a[120:123] offset:5120
    v_accvgpr_read_b32 v30, a70
    v_mfma_f32_16x16x32_bf16 a[132:135], v[172:175], v[124:127], a[132:135]
    ds_write_b128 v19, a[108:111] offset:6144
    v_accvgpr_read_b32 v31, a71
    v_mfma_f32_16x16x32_bf16 a[132:135], v[180:183], v[116:119], a[132:135]
    ds_write_b128 v19, a[124:127] offset:7168
    v_add_f32 v196, v196, v28
    v_mfma_f32_16x16x32_bf16 a[136:139], v[164:167], v[248:251], a[136:139]
    v_permlane16_swap_b32 v104, v106
    v_permlane16_swap_b32 v105, v107
    s_cmp_eq_u32 s56, 0
    s_cbranch_scc1 L_own4
    ds_write_b128 v22, v[104:107] offset:4096
L_own4:
    v_mfma_f32_16x16x32_bf16 a[136:139], v[168:171], v[128:131], a[136:139]
    buffer_store_dwordx4 v[104:107], v1, s[24:27], s55 offen sc1
    v_mfma_f32_16x16x32_bf16 a[136:139], v[172:175], v[140:143], a[136:139]
    s_add_u32 s55, s58, 5120
    v_add_f32 v197, v197, v29
    v_add_f32 v198, v198, v30
    v_add_f32 v199, v199, v31
    v_cvt_pk_bf16_f32 v120, v196, v197
    v_cvt_pk_bf16_f32 v121, v198, v199
    v_accvgpr_read_b32 v32, a84
    v_mfma_f32_16x16x32_bf16 a[136:139], v[180:183], v[132:135], a[136:139]
    v_accvgpr_read_b32 v33, a85
    v_accvgpr_read_b32 v34, a86
    v_accvgpr_read_b32 v35, a87
    v_add_f32 v200, v200, v32
    v_add_f32 v201, v201, v33
    v_mfma_f32_16x16x32_bf16 a[140:143], v[164:167], v[252:255], a[140:143]
    v_add_f32 v202, v202, v34
    v_add_f32 v203, v203, v35
    v_cvt_pk_bf16_f32 v122, v200, v201
    v_cvt_pk_bf16_f32 v123, v202, v203
    v_mfma_f32_16x16x32_bf16 a[140:143], v[168:171], v[144:147], a[140:143]
    v_mfma_f32_16x16x32_bf16 a[140:143], v[172:175], v[156:159], a[140:143]
    v_permlane16_swap_b32 v120, v122
    v_permlane16_swap_b32 v121, v123
    s_cmp_eq_u32 s56, 0
    s_cbranch_scc1 L_own5
    ds_write_b128 v22, v[120:123] offset:5120
L_own5:
    v_mfma_f32_16x16x32_bf16 a[140:143], v[180:183], v[148:151], a[140:143]
    buffer_store_dwordx4 v[120:123], v1, s[24:27], s55 offen sc1
    ds_write_b128 v19, a[136:139] offset:43008
    s_nop 5
    ds_write_b128 v19, a[140:143] offset:44032
    s_waitcnt lgkmcnt(0)
    s_barrier
    ds_read_b128 v[204:207], v20 offset:4096
    ds_read_b128 v[212:215], v20 offset:5120
    ds_read_b128 v[216:219], v20 offset:6144
    ds_read_b128 v[220:223], v20 offset:7168
    ds_read_b128 v[184:187], v20 offset:43008
    ds_read_b128 v[188:191], v20 offset:44032
    s_waitcnt lgkmcnt(2)
    v_accvgpr_read_b32 v28, a96
    v_accvgpr_read_b32 v29, a97
    v_accvgpr_read_b32 v30, a98
    v_accvgpr_read_b32 v31, a99
    v_add_f32 v204, v204, v28
    v_add_f32 v205, v205, v29
    v_add_f32 v206, v206, v30
    v_add_f32 v207, v207, v31
    v_cvt_pk_bf16_f32 v136, v204, v205
    v_cvt_pk_bf16_f32 v137, v206, v207
    v_accvgpr_read_b32 v32, a112
    v_accvgpr_read_b32 v33, a113
    v_accvgpr_read_b32 v34, a114
    v_accvgpr_read_b32 v35, a115
    v_add_f32 v212, v212, v32
    v_add_f32 v213, v213, v33
    v_add_f32 v214, v214, v34
    v_add_f32 v215, v215, v35
    v_cvt_pk_bf16_f32 v138, v212, v213
    v_cvt_pk_bf16_f32 v139, v214, v215
    s_add_u32 s55, s58, 6144
    v_permlane16_swap_b32 v136, v138
    v_permlane16_swap_b32 v137, v139
    buffer_store_dwordx4 v[136:139], v1, s[24:27], s55 offen sc1
    s_cmp_eq_u32 s56, 0
    s_cbranch_scc1 L_own6
    ds_write_b128 v22, v[136:139] offset:6144
L_own6:
    v_accvgpr_read_b32 v28, a100
    v_accvgpr_read_b32 v29, a101
    v_accvgpr_read_b32 v30, a102
    v_accvgpr_read_b32 v31, a103
    v_add_f32 v216, v216, v28
    v_add_f32 v217, v217, v29
    v_add_f32 v218, v218, v30
    v_add_f32 v219, v219, v31
    v_cvt_pk_bf16_f32 v152, v216, v217
    v_cvt_pk_bf16_f32 v153, v218, v219
    v_accvgpr_read_b32 v32, a116
    v_accvgpr_read_b32 v33, a117
    v_accvgpr_read_b32 v34, a118
    v_accvgpr_read_b32 v35, a119
    v_add_f32 v220, v220, v32
    v_add_f32 v221, v221, v33
    v_add_f32 v222, v222, v34
    v_add_f32 v223, v223, v35
    v_cvt_pk_bf16_f32 v154, v220, v221
    v_cvt_pk_bf16_f32 v155, v222, v223
    s_add_u32 s55, s58, 7168
    v_permlane16_swap_b32 v152, v154
    v_permlane16_swap_b32 v153, v155
    buffer_store_dwordx4 v[152:155], v1, s[24:27], s55 offen sc1
    s_cmp_eq_u32 s56, 0
    s_cbranch_scc1 L_own7
    ds_write_b128 v22, v[152:155] offset:7168
L_own7:
    s_waitcnt lgkmcnt(0)
    v_accvgpr_read_b32 v28, a128
    v_accvgpr_read_b32 v29, a129
    v_accvgpr_read_b32 v30, a130
    v_accvgpr_read_b32 v31, a131
    v_add_f32 v184, v184, v28
    v_add_f32 v185, v185, v29
    v_add_f32 v186, v186, v30
    v_add_f32 v187, v187, v31
    v_cvt_pk_bf16_f32 v104, v184, v185
    v_cvt_pk_bf16_f32 v105, v186, v187
    v_accvgpr_read_b32 v32, a132
    v_accvgpr_read_b32 v33, a133
    v_accvgpr_read_b32 v34, a134
    v_accvgpr_read_b32 v35, a135
    v_add_f32 v188, v188, v32
    v_add_f32 v189, v189, v33
    v_add_f32 v190, v190, v34
    v_add_f32 v191, v191, v35
    v_cvt_pk_bf16_f32 v106, v188, v189
    v_cvt_pk_bf16_f32 v107, v190, v191
    s_add_u32 s55, s58, 8192
    v_permlane16_swap_b32 v104, v106
    v_permlane16_swap_b32 v105, v107
    buffer_store_dwordx4 v[104:107], v1, s[24:27], s55 offen sc1
    s_cmp_eq_u32 s56, 0
    s_cbranch_scc1 L_own8
    ds_write_b128 v22, v[104:107] offset:8192
L_own8:
    s_lshl_b32 s62, s28, 4
    s_add_u32 s62, s62, s29
    s_lshl_b32 s62, s62, 7
    s_add_u32 s62, s62, 15958016
    s_waitcnt vmcnt(0)
    s_waitcnt lgkmcnt(0)
    s_barrier
    s_cmp_lg_u32 s3, 0
    s_cbranch_scc1 L_sig8
    v_mov_b32 v28, 1
    s_mov_b64 exec, 1
    buffer_store_dword v28, off, s[24:27], s62 sc1
    s_mov_b64 exec, -1
L_sig8:
    s_mov_b32 s16, s78
    s_mov_b32 s17, s79
    s_mov_b32 s18, 2359296
    s_mov_b32 s19, 0x20000
    v_add_u32 v9, 69632, v2
    v_add_u32 v11, 69632, v3
    ds_read_b128 v[84:87], v11
    ds_read_b128 v[44:47], v9
    ds_read_b128 v[64:67], v9 offset:1024
    s_mov_b32 s14, 14983168
    buffer_load_dword v7, v16, s[24:27], s14 offen sc1
    buffer_load_dword v17, v16, s[24:27], s14 offen offset:64 sc1
    buffer_load_dword v8, v16, s[24:27], s71 offen sc1
    buffer_load_dword v18, v16, s[24:27], s71 offen offset:64 sc1
    v_and_b32 v9, 15, v0
    v_lshlrev_b32 v9, 4, v9
    v_lshrrev_b32 v10, 2, v16
    v_mul_u32_u24 v10, 1152, v10
    s_mov_b64 exec, 0xffff
    buffer_load_dwordx4 v[192:195], v9, s[24:27], s70 offen sc1
    s_mov_b64 exec, -1
    s_lshl_b32 s14, s28, 4
    s_add_u32 s14, s14, s9
    s_lshl_b32 s14, s14, 7
    s_add_u32 s14, s14, 15958016
    v_lshl_add_u32 v19, v0, 9, s14
    v_mov_b32 v20, 1
    s_cmp_lg_u32 s3, 0
    s_cbranch_scc1 L_pdone9
    s_mov_b32 s15, 0
    s_mov_b32 exec_lo, 15
    s_mov_b32 exec_hi, 0
L_poll9:
    buffer_load_dword v21, v19, s[24:27], 0 offen sc1
    s_add_u32 s15, s15, 1
    s_waitcnt vmcnt(0)
    v_cmp_lt_u32 vcc, v21, v20
    s_cmp_gt_u32 s15, 1048576
    s_cbranch_scc1 L_pexit9
    s_nop 2
    s_cbranch_vccz L_pexit9
    s_sleep 1
    s_branch L_poll9
L_pexit9:
    s_mov_b64 exec, -1
L_pdone9:
    s_barrier
    s_mov_b64 exec, 0xffff
    buffer_load_dwordx4 v[88:91], v3, s[24:27], s64 offen sc1
    buffer_load_dwordx4 v[92:95], v3, s[24:27], s65 offen sc1
    buffer_load_dwordx4 v[96:99], v3, s[24:27], s66 offen sc1
    s_mov_b64 exec, -1
    buffer_load_dwordx4 v[48:51], v2, s[24:27], s64 offen sc1
    buffer_load_dwordx4 v[52:55], v2, s[24:27], s65 offen sc1
    buffer_load_dwordx4 v[56:59], v2, s[24:27], s66 offen sc1
    buffer_load_dwordx4 v[68:71], v2, s[24:27], s64 offen offset:1024 sc1
    buffer_load_dwordx4 v[72:75], v2, s[24:27], s65 offen offset:1024 sc1
    buffer_load_dwordx4 v[76:79], v2, s[24:27], s66 offen offset:1024 sc1
    s_cmp_eq_u32 s69, 0
    s_cselect_b64 vcc, -1, 0
    s_waitcnt vmcnt(9)
    v_cndmask_b32 v21, v17, v7, vcc
    v_cndmask_b32 v22, v18, v8, vcc
    s_mov_b64 exec, 0xffff
    s_waitcnt lgkmcnt(2)
    v_lshlrev_b32 v130, 16, v84
    v_and_b32 v131, 0xffff0000, v84
    v_lshlrev_b32 v132, 16, v85
    v_and_b32 v133, 0xffff0000, v85
    v_lshlrev_b32 v134, 16, v86
    v_and_b32 v135, 0xffff0000, v86
    v_lshlrev_b32 v136, 16, v87
    v_and_b32 v137, 0xffff0000, v87
    s_waitcnt vmcnt(8)
    v_lshlrev_b32 v12, 16, v88
    v_and_b32 v13, 0xffff0000, v88
    v_add_f32 v130, v130, v12
    v_add_f32 v131, v131, v13
    v_lshlrev_b32 v12, 16, v89
    v_and_b32 v13, 0xffff0000, v89
    v_add_f32 v132, v132, v12
    v_add_f32 v133, v133, v13
    v_lshlrev_b32 v12, 16, v90
    v_and_b32 v13, 0xffff0000, v90
    v_add_f32 v134, v134, v12
    v_add_f32 v135, v135, v13
    v_lshlrev_b32 v12, 16, v91
    v_and_b32 v13, 0xffff0000, v91
    v_add_f32 v136, v136, v12
    v_add_f32 v137, v137, v13
    s_waitcnt vmcnt(7)
    v_lshlrev_b32 v12, 16, v92
    v_and_b32 v13, 0xffff0000, v92
    v_add_f32 v130, v130, v12
    v_add_f32 v131, v131, v13
    v_lshlrev_b32 v12, 16, v93
    v_and_b32 v13, 0xffff0000, v93
    v_add_f32 v132, v132, v12
    v_add_f32 v133, v133, v13
    v_lshlrev_b32 v12, 16, v94
    v_and_b32 v13, 0xffff0000, v94
    v_add_f32 v134, v134, v12
    v_add_f32 v135, v135, v13
    v_lshlrev_b32 v12, 16, v95
    v_and_b32 v13, 0xffff0000, v95
    v_add_f32 v136, v136, v12
    v_add_f32 v137, v137, v13
    s_waitcnt vmcnt(6)
    v_lshlrev_b32 v12, 16, v96
    v_and_b32 v13, 0xffff0000, v96
    v_add_f32 v130, v130, v12
    v_add_f32 v131, v131, v13
    v_lshlrev_b32 v12, 16, v97
    v_and_b32 v13, 0xffff0000, v97
    v_add_f32 v132, v132, v12
    v_add_f32 v133, v133, v13
    v_lshlrev_b32 v12, 16, v98
    v_and_b32 v13, 0xffff0000, v98
    v_add_f32 v134, v134, v12
    v_add_f32 v135, v135, v13
    v_lshlrev_b32 v12, 16, v99
    v_and_b32 v13, 0xffff0000, v99
    v_add_f32 v136, v136, v12
    v_add_f32 v137, v137, v13
    v_lshlrev_b32 v12, 16, v192
    v_and_b32 v13, 0xffff0000, v192
    v_add_f32 v12, v12, v21
    v_add_f32 v13, v13, v21
    v_fmac_f32 v12, v130, v22
    v_fmac_f32 v13, v131, v22
    v_cvt_pk_bf16_f32 v80, v12, v13
    v_lshlrev_b32 v12, 16, v193
    v_and_b32 v13, 0xffff0000, v193
    v_add_f32 v12, v12, v21
    v_add_f32 v13, v13, v21
    v_fmac_f32 v12, v132, v22
    v_fmac_f32 v13, v133, v22
    v_cvt_pk_bf16_f32 v81, v12, v13
    v_lshlrev_b32 v12, 16, v194
    v_and_b32 v13, 0xffff0000, v194
    v_add_f32 v12, v12, v21
    v_add_f32 v13, v13, v21
    v_fmac_f32 v12, v134, v22
    v_fmac_f32 v13, v135, v22
    v_cvt_pk_bf16_f32 v82, v12, v13
    v_lshlrev_b32 v12, 16, v195
    v_and_b32 v13, 0xffff0000, v195
    v_add_f32 v12, v12, v21
    v_add_f32 v13, v13, v21
    v_fmac_f32 v12, v136, v22
    v_fmac_f32 v13, v137, v22
    v_cvt_pk_bf16_f32 v83, v12, v13
    buffer_store_dwordx4 v[80:83], v10, s[16:19], s68 offen
    s_mov_b64 exec, -1
    s_waitcnt lgkmcnt(1)
    v_lshlrev_b32 v130, 16, v44
    v_and_b32 v131, 0xffff0000, v44
    v_lshlrev_b32 v132, 16, v45
    v_and_b32 v133, 0xffff0000, v45
    v_lshlrev_b32 v134, 16, v46
    v_and_b32 v135, 0xffff0000, v46
    v_lshlrev_b32 v136, 16, v47
    v_and_b32 v137, 0xffff0000, v47
    s_waitcnt vmcnt(6)
    v_lshlrev_b32 v12, 16, v48
    v_and_b32 v13, 0xffff0000, v48
    v_add_f32 v130, v130, v12
    v_add_f32 v131, v131, v13
    v_lshlrev_b32 v12, 16, v49
    v_and_b32 v13, 0xffff0000, v49
    v_add_f32 v132, v132, v12
    v_add_f32 v133, v133, v13
    v_lshlrev_b32 v12, 16, v50
    v_and_b32 v13, 0xffff0000, v50
    v_add_f32 v134, v134, v12
    v_add_f32 v135, v135, v13
    v_lshlrev_b32 v12, 16, v51
    v_and_b32 v13, 0xffff0000, v51
    v_add_f32 v136, v136, v12
    v_add_f32 v137, v137, v13
    s_waitcnt vmcnt(5)
    v_lshlrev_b32 v12, 16, v52
    v_and_b32 v13, 0xffff0000, v52
    v_add_f32 v130, v130, v12
    v_add_f32 v131, v131, v13
    v_lshlrev_b32 v12, 16, v53
    v_and_b32 v13, 0xffff0000, v53
    v_add_f32 v132, v132, v12
    v_add_f32 v133, v133, v13
    v_lshlrev_b32 v12, 16, v54
    v_and_b32 v13, 0xffff0000, v54
    v_add_f32 v134, v134, v12
    v_add_f32 v135, v135, v13
    v_lshlrev_b32 v12, 16, v55
    v_and_b32 v13, 0xffff0000, v55
    v_add_f32 v136, v136, v12
    v_add_f32 v137, v137, v13
    s_waitcnt vmcnt(4)
    v_lshlrev_b32 v12, 16, v56
    v_and_b32 v13, 0xffff0000, v56
    v_add_f32 v130, v130, v12
    v_add_f32 v131, v131, v13
    v_lshlrev_b32 v12, 16, v57
    v_and_b32 v13, 0xffff0000, v57
    v_add_f32 v132, v132, v12
    v_add_f32 v133, v133, v13
    v_lshlrev_b32 v12, 16, v58
    v_and_b32 v13, 0xffff0000, v58
    v_add_f32 v134, v134, v12
    v_add_f32 v135, v135, v13
    v_lshlrev_b32 v12, 16, v59
    v_and_b32 v13, 0xffff0000, v59
    v_add_f32 v136, v136, v12
    v_add_f32 v137, v137, v13
    v_lshlrev_b32 v12, 16, v160
    v_and_b32 v13, 0xffff0000, v160
    v_add_f32 v12, v12, v7
    v_add_f32 v13, v13, v7
    v_fmac_f32 v12, v130, v8
    v_fmac_f32 v13, v131, v8
    v_cvt_pk_bf16_f32 v40, v12, v13
    v_lshlrev_b32 v12, 16, v161
    v_and_b32 v13, 0xffff0000, v161
    v_add_f32 v12, v12, v7
    v_add_f32 v13, v13, v7
    v_fmac_f32 v12, v132, v8
    v_fmac_f32 v13, v133, v8
    v_cvt_pk_bf16_f32 v41, v12, v13
    v_lshlrev_b32 v12, 16, v162
    v_and_b32 v13, 0xffff0000, v162
    v_add_f32 v12, v12, v7
    v_add_f32 v13, v13, v7
    v_fmac_f32 v12, v134, v8
    v_fmac_f32 v13, v135, v8
    v_cvt_pk_bf16_f32 v42, v12, v13
    v_lshlrev_b32 v12, 16, v163
    v_and_b32 v13, 0xffff0000, v163
    v_add_f32 v12, v12, v7
    v_add_f32 v13, v13, v7
    v_fmac_f32 v12, v136, v8
    v_fmac_f32 v13, v137, v8
    v_cvt_pk_bf16_f32 v43, v12, v13
    buffer_store_dwordx4 v[40:43], v15, s[16:19], s8 offen
    s_add_u32 s8, s8, 18432
    s_waitcnt lgkmcnt(0)
    v_lshlrev_b32 v130, 16, v64
    v_and_b32 v131, 0xffff0000, v64
    v_lshlrev_b32 v132, 16, v65
    v_and_b32 v133, 0xffff0000, v65
    v_lshlrev_b32 v134, 16, v66
    v_and_b32 v135, 0xffff0000, v66
    v_lshlrev_b32 v136, 16, v67
    v_and_b32 v137, 0xffff0000, v67
    s_waitcnt vmcnt(4)
    v_lshlrev_b32 v12, 16, v68
    v_and_b32 v13, 0xffff0000, v68
    v_add_f32 v130, v130, v12
    v_add_f32 v131, v131, v13
    v_lshlrev_b32 v12, 16, v69
    v_and_b32 v13, 0xffff0000, v69
    v_add_f32 v132, v132, v12
    v_add_f32 v133, v133, v13
    v_lshlrev_b32 v12, 16, v70
    v_and_b32 v13, 0xffff0000, v70
    v_add_f32 v134, v134, v12
    v_add_f32 v135, v135, v13
    v_lshlrev_b32 v12, 16, v71
    v_and_b32 v13, 0xffff0000, v71
    v_add_f32 v136, v136, v12
    v_add_f32 v137, v137, v13
    s_waitcnt vmcnt(3)
    v_lshlrev_b32 v12, 16, v72
    v_and_b32 v13, 0xffff0000, v72
    v_add_f32 v130, v130, v12
    v_add_f32 v131, v131, v13
    v_lshlrev_b32 v12, 16, v73
    v_and_b32 v13, 0xffff0000, v73
    v_add_f32 v132, v132, v12
    v_add_f32 v133, v133, v13
    v_lshlrev_b32 v12, 16, v74
    v_and_b32 v13, 0xffff0000, v74
    v_add_f32 v134, v134, v12
    v_add_f32 v135, v135, v13
    v_lshlrev_b32 v12, 16, v75
    v_and_b32 v13, 0xffff0000, v75
    v_add_f32 v136, v136, v12
    v_add_f32 v137, v137, v13
    s_waitcnt vmcnt(2)
    v_lshlrev_b32 v12, 16, v76
    v_and_b32 v13, 0xffff0000, v76
    v_add_f32 v130, v130, v12
    v_add_f32 v131, v131, v13
    v_lshlrev_b32 v12, 16, v77
    v_and_b32 v13, 0xffff0000, v77
    v_add_f32 v132, v132, v12
    v_add_f32 v133, v133, v13
    v_lshlrev_b32 v12, 16, v78
    v_and_b32 v13, 0xffff0000, v78
    v_add_f32 v134, v134, v12
    v_add_f32 v135, v135, v13
    v_lshlrev_b32 v12, 16, v79
    v_and_b32 v13, 0xffff0000, v79
    v_add_f32 v136, v136, v12
    v_add_f32 v137, v137, v13
    v_lshlrev_b32 v12, 16, v176
    v_and_b32 v13, 0xffff0000, v176
    v_add_f32 v12, v12, v17
    v_add_f32 v13, v13, v17
    v_fmac_f32 v12, v130, v18
    v_fmac_f32 v13, v131, v18
    v_cvt_pk_bf16_f32 v60, v12, v13
    v_lshlrev_b32 v12, 16, v177
    v_and_b32 v13, 0xffff0000, v177
    v_add_f32 v12, v12, v17
    v_add_f32 v13, v13, v17
    v_fmac_f32 v12, v132, v18
    v_fmac_f32 v13, v133, v18
    v_cvt_pk_bf16_f32 v61, v12, v13
    v_lshlrev_b32 v12, 16, v178
    v_and_b32 v13, 0xffff0000, v178
    v_add_f32 v12, v12, v17
    v_add_f32 v13, v13, v17
    v_fmac_f32 v12, v134, v18
    v_fmac_f32 v13, v135, v18
    v_cvt_pk_bf16_f32 v62, v12, v13
    v_lshlrev_b32 v12, 16, v179
    v_and_b32 v13, 0xffff0000, v179
    v_add_f32 v12, v12, v17
    v_add_f32 v13, v13, v17
    v_fmac_f32 v12, v136, v18
    v_fmac_f32 v13, v137, v18
    v_cvt_pk_bf16_f32 v63, v12, v13
    buffer_store_dwordx4 v[60:63], v15, s[16:19], s8 offen
L_exit:
    s_endpgm
L_k4_spin0:
    s_mov_b32 s15, 0
L_k4_spinl0:
    buffer_load_dword v23, v21, s[24:27], 0 offen offset:0 sc1
    s_add_u32 s15, s15, 1
    s_waitcnt vmcnt(0)
    v_cmp_eq_u32 vcc, 0, v23
    s_cmp_gt_u32 s15, 1048576
    s_cbranch_scc1 L_k4_back0
    s_nop 2
    s_cbranch_vccz L_k4_back0
    s_sleep 1
    s_branch L_k4_spinl0
L_k4_spin1:
    s_mov_b32 s15, 0
L_k4_spinl1:
    buffer_load_dword v23, v21, s[24:27], 0 offen offset:4 sc1
    s_add_u32 s15, s15, 1
    s_waitcnt vmcnt(0)
    v_cmp_eq_u32 vcc, 0, v23
    s_cmp_gt_u32 s15, 1048576
    s_cbranch_scc1 L_k4_back1
    s_nop 2
    s_cbranch_vccz L_k4_back1
    s_sleep 1
    s_branch L_k4_spinl1
L_p2_wbspin:
    s_mov_b32 s29, 0
L_p2_wbl:
    buffer_load_dword v244, v245, s[48:51], 0 offen offset:128 sc1
    s_add_u32 s29, s29, 1
    s_waitcnt vmcnt(0)
    v_cmp_eq_u32 vcc, 0, v244
    s_cmp_gt_u32 s29, 1048576
    s_cbranch_scc1 L_p2_wbok
    s_nop 2
    s_cbranch_vccz L_p2_wbok
    s_sleep 4
    s_branch L_p2_wbl
L_p2_max:
    s_mov_b32 s28, 1
    s_waitcnt vmcnt(0)
    s_nop 15
    v_mfma_f32_32x32x16_bf16 v[144:159], v[16:19], v[96:99], v[112:127]
    v_mfma_f32_32x32x16_bf16 v[144:159], v[20:23], v[100:103], v[144:159]
    v_mfma_f32_32x32x16_bf16 v[160:175], v[24:27], v[96:99], 0
    v_mfma_f32_32x32x16_bf16 v[160:175], v[28:31], v[100:103], v[160:175]
    s_nop 9
    v_max_f32 v240, v144, v145
    v_max_f32 v241, v146, v147
    v_max3_f32 v240, v148, v149, v240
    v_max3_f32 v241, v150, v151, v241
    v_mfma_f32_32x32x16_bf16 v[176:191], v[24:27], v[104:107], v[112:127]
    v_max3_f32 v240, v152, v153, v240
    v_max3_f32 v241, v154, v155, v241
    v_max3_f32 v240, v156, v157, v240
    v_max3_f32 v241, v158, v159, v241
    v_mfma_f32_32x32x16_bf16 v[176:191], v[28:31], v[108:111], v[176:191]
    v_max3_f32 v240, v160, v161, v240
    v_max3_f32 v241, v162, v163, v241
    v_max3_f32 v240, v164, v165, v240
    v_max3_f32 v241, v166, v167, v241
    v_mfma_f32_32x32x16_bf16 v[144:159], v[32:35], v[96:99], 0
    v_max3_f32 v240, v168, v169, v240
    v_max3_f32 v241, v170, v171, v241
    v_max3_f32 v240, v172, v173, v240
    v_max3_f32 v241, v174, v175, v241
    v_mfma_f32_32x32x16_bf16 v[144:159], v[36:39], v[100:103], v[144:159]
    s_nop 1
    v_max_f32 v242, v176, v177
    v_max_f32 v243, v178, v179
    v_max3_f32 v242, v180, v181, v242
    v_max3_f32 v243, v182, v183, v243
    v_mfma_f32_32x32x16_bf16 v[160:175], v[32:35], v[104:107], 0
    v_max3_f32 v242, v184, v185, v242
    v_max3_f32 v243, v186, v187, v243
    v_max3_f32 v242, v188, v189, v242
    v_max3_f32 v243, v190, v191, v243
    v_mfma_f32_32x32x16_bf16 v[160:175], v[36:39], v[108:111], v[160:175]
    v_max3_f32 v240, v144, v145, v240
    v_max3_f32 v241, v146, v147, v241
    v_max3_f32 v240, v148, v149, v240
    v_max3_f32 v241, v150, v151, v241
    v_mfma_f32_32x32x16_bf16 v[176:191], v[40:43], v[96:99], 0
    v_max3_f32 v240, v152, v153, v240
    v_max3_f32 v241, v154, v155, v241
    v_max3_f32 v240, v156, v157, v240
    v_max3_f32 v241, v158, v159, v241
    v_mfma_f32_32x32x16_bf16 v[176:191], v[44:47], v[100:103], v[176:191]
    s_nop 1
    v_max3_f32 v242, v160, v161, v242
    v_max3_f32 v243, v162, v163, v243
    v_max3_f32 v242, v164, v165, v242
    v_max3_f32 v243, v166, v167, v243
    v_mfma_f32_32x32x16_bf16 v[144:159], v[40:43], v[104:107], 0
    v_max3_f32 v242, v168, v169, v242
    v_max3_f32 v243, v170, v171, v243
    v_max3_f32 v242, v172, v173, v242
    v_max3_f32 v243, v174, v175, v243
    v_mfma_f32_32x32x16_bf16 v[144:159], v[44:47], v[108:111], v[144:159]
    v_max3_f32 v240, v176, v177, v240
    v_max3_f32 v241, v178, v179, v241
    v_max3_f32 v240, v180, v181, v240
    v_max3_f32 v241, v182, v183, v241
    v_mfma_f32_32x32x16_bf16 v[160:175], v[48:51], v[96:99], 0
    v_max3_f32 v240, v184, v185, v240
    v_max3_f32 v241, v186, v187, v241
    v_max3_f32 v240, v188, v189, v240
    v_max3_f32 v241, v190, v191, v241
    v_mfma_f32_32x32x16_bf16 v[160:175], v[52:55], v[100:103], v[160:175]
    s_nop 1
    v_max3_f32 v242, v144, v145, v242
    v_max3_f32 v243, v146, v147, v243
    v_max3_f32 v242, v148, v149, v242
    v_max3_f32 v243, v150, v151, v243
    v_mfma_f32_32x32x16_bf16 v[176:191], v[48:51], v[104:107], 0
    v_max3_f32 v242, v152, v153, v242
    v_max3_f32 v243, v154, v155, v243
    v_max3_f32 v242, v156, v157, v242
    v_max3_f32 v243, v158, v159, v243
    v_mfma_f32_32x32x16_bf16 v[176:191], v[52:55], v[108:111], v[176:191]
    v_max3_f32 v240, v160, v161, v240
    v_max3_f32 v241, v162, v163, v241
    v_max3_f32 v240, v164, v165, v240
    v_max3_f32 v241, v166, v167, v241
    v_mfma_f32_32x32x16_bf16 v[144:159], v[56:59], v[96:99], 0
    v_max3_f32 v240, v168, v169, v240
    v_max3_f32 v241, v170, v171, v241
    v_max3_f32 v240, v172, v173, v240
    v_max3_f32 v241, v174, v175, v241
    v_mfma_f32_32x32x16_bf16 v[144:159], v[60:63], v[100:103], v[144:159]
    s_nop 1
    v_max3_f32 v242, v176, v177, v242
    v_max3_f32 v243, v178, v179, v243
    v_max3_f32 v242, v180, v181, v242
    v_max3_f32 v243, v182, v183, v243
    v_mfma_f32_32x32x16_bf16 v[160:175], v[56:59], v[104:107], 0
    v_max3_f32 v242, v184, v185, v242
    v_max3_f32 v243, v186, v187, v243
    v_max3_f32 v242, v188, v189, v242
    v_max3_f32 v243, v190, v191, v243
    v_mfma_f32_32x32x16_bf16 v[160:175], v[60:63], v[108:111], v[160:175]
    v_max3_f32 v240, v144, v145, v240
    v_max3_f32 v241, v146, v147, v241
    v_max3_f32 v240, v148, v149, v240
    v_max3_f32 v241, v150, v151, v241
    v_mfma_f32_32x32x16_bf16 v[176:191], v[64:67], v[96:99], 0
    v_max3_f32 v240, v152, v153, v240
    v_max3_f32 v241, v154, v155, v241
    v_max3_f32 v240, v156, v157, v240
    v_max3_f32 v241, v158, v159, v241
    v_mfma_f32_32x32x16_bf16 v[176:191], v[68:71], v[100:103], v[176:191]
    s_nop 1
    v_max3_f32 v242, v160, v161, v242
    v_max3_f32 v243, v162, v163, v243
    v_max3_f32 v242, v164, v165, v242
    v_max3_f32 v243, v166, v167, v243
    v_mfma_f32_32x32x16_bf16 v[144:159], v[64:67], v[104:107], 0
    v_max3_f32 v242, v168, v169, v242
    v_max3_f32 v243, v170, v171, v243
    v_max3_f32 v242, v172, v173, v242
    v_max3_f32 v243, v174, v175, v243
    v_mfma_f32_32x32x16_bf16 v[144:159], v[68:71], v[108:111], v[144:159]
    v_max3_f32 v240, v176, v177, v240
    v_max3_f32 v241, v178, v179, v241
    v_max3_f32 v240, v180, v181, v240
    v_max3_f32 v241, v182, v183, v241
    v_mfma_f32_32x32x16_bf16 v[160:175], v[72:75], v[96:99], 0
    v_max3_f32 v240, v184, v185, v240
    v_max3_f32 v241, v186, v187, v241
    v_max3_f32 v240, v188, v189, v240
    v_max3_f32 v241, v190, v191, v241
    v_mfma_f32_32x32x16_bf16 v[160:175], v[76:79], v[100:103], v[160:175]
    s_nop 1
    v_max3_f32 v242, v144, v145, v242
    v_max3_f32 v243, v146, v147, v243
    v_max3_f32 v242, v148, v149, v242
    v_max3_f32 v243, v150, v151, v243
    v_mfma_f32_32x32x16_bf16 v[176:191], v[72:75], v[104:107], 0
    v_max3_f32 v242, v152, v153, v242
    v_max3_f32 v243, v154, v155, v243
    v_max3_f32 v242, v156, v157, v242
    v_max3_f32 v243, v158, v159, v243
    v_mfma_f32_32x32x16_bf16 v[176:191], v[76:79], v[108:111], v[176:191]
    v_max3_f32 v240, v160, v161, v240
    v_max3_f32 v241, v162, v163, v241
    v_max3_f32 v240, v164, v165, v240
    v_max3_f32 v241, v166, v167, v241
    v_mfma_f32_32x32x16_bf16 v[144:159], v[80:83], v[96:99], v[128:143]
    v_max3_f32 v240, v168, v169, v240
    v_max3_f32 v241, v170, v171, v241
    v_max3_f32 v240, v172, v173, v240
    v_max3_f32 v241, v174, v175, v241
    v_mfma_f32_32x32x16_bf16 v[144:159], v[84:87], v[100:103], v[144:159]
    s_nop 1
    v_max3_f32 v242, v176, v177, v242
    v_max3_f32 v243, v178, v179, v243
    v_max3_f32 v242, v180, v181, v242
    v_max3_f32 v243, v182, v183, v243
    v_mfma_f32_32x32x16_bf16 v[160:175], v[80:83], v[104:107], 0
    v_max3_f32 v242, v184, v185, v242
    v_max3_f32 v243, v186, v187, v243
    v_max3_f32 v242, v188, v189, v242
    v_max3_f32 v243, v190, v191, v243
    v_mfma_f32_32x32x16_bf16 v[160:175], v[84:87], v[108:111], v[160:175]
    v_max3_f32 v240, v144, v145, v240
    v_max3_f32 v241, v146, v147, v241
    v_max3_f32 v240, v148, v149, v240
    v_max3_f32 v241, v150, v151, v241
    v_mfma_f32_32x32x16_bf16 v[176:191], v[88:91], v[104:107], v[128:143]
    v_max3_f32 v240, v152, v153, v240
    v_max3_f32 v241, v154, v155, v241
    v_max3_f32 v240, v156, v157, v240
    v_max3_f32 v241, v158, v159, v241
    v_mfma_f32_32x32x16_bf16 v[176:191], v[92:95], v[108:111], v[176:191]
    s_nop 1
    v_max3_f32 v242, v160, v161, v242
    v_max3_f32 v243, v162, v163, v243
    v_max3_f32 v242, v164, v165, v242
    v_max3_f32 v243, v166, v167, v243
    v_max3_f32 v242, v168, v169, v242
    v_max3_f32 v243, v170, v171, v243
    v_max3_f32 v242, v172, v173, v242
    v_max3_f32 v243, v174, v175, v243
    s_nop 1
    v_max3_f32 v242, v176, v177, v242
    v_max3_f32 v243, v178, v179, v243
    v_max3_f32 v242, v180, v181, v242
    v_max3_f32 v243, v182, v183, v243
    v_max3_f32 v242, v184, v185, v242
    v_max3_f32 v243, v186, v187, v243
    v_max3_f32 v242, v188, v189, v242
    v_max3_f32 v243, v190, v191, v243
    v_cmp_gt_u32 vcc, 32, v0
    v_max_f32 v240, v240, v241
    v_mov_b32 v241, v240
    s_nop 1
    v_permlane32_swap_b32 v240, v241
    v_max_f32 v240, v240, v241
    v_and_b32 v8, 0xffff0000, v240
    v_sub_f32 v10, v240, v8
    v_and_b32 v11, 0xffff0000, v10
    v_sub_f32 v10, v10, v11
    v_cvt_pk_bf16_f32 v8, -v8, -v11
    v_cvt_pk_bf16_f32 v10, -v10, v9
    v_cndmask_b32 v102, 0, v8, vcc
    v_cndmask_b32 v103, 0, v10, vcc
    v_max_f32 v242, v242, v243
    v_mov_b32 v243, v242
    s_nop 1
    v_permlane32_swap_b32 v242, v243
    v_max_f32 v242, v242, v243
    v_and_b32 v8, 0xffff0000, v242
    v_sub_f32 v10, v242, v8
    v_and_b32 v11, 0xffff0000, v10
    v_sub_f32 v10, v10, v11
    v_cvt_pk_bf16_f32 v8, -v8, -v11
    v_cvt_pk_bf16_f32 v10, -v10, v9
    v_cndmask_b32 v110, 0, v8, vcc
    v_cndmask_b32 v111, 0, v10, vcc
    s_nop 7
    s_branch L_p2_pass2
L_p1_spinT:
    s_mov_b32 s14, 0
L_p1_splT:
    buffer_load_dword v66, v60, s[48:51], 0 offen sc1
    s_add_u32 s14, s14, 1
    s_waitcnt vmcnt(0)
    v_cmp_ne_u32 vcc, 0, v66
    s_nop 0
    s_bcnt1_i32_b32 s52, vcc_lo
    s_cmp_gt_u32 s14, 1048576
    s_cbranch_scc1 L_p1_n6T
    s_cmp_ge_u32 s52, 32
    s_cbranch_scc1 L_p1_n6T
    s_sleep 4
    s_branch L_p1_splT
L_p1_spinD:
    s_mov_b32 s14, 0
L_p1_splD:
    buffer_load_dword v66, v60, s[48:51], 0 offen sc1
    s_add_u32 s14, s14, 1
    s_waitcnt vmcnt(0)
    v_cmp_ne_u32 vcc, 0, v66
    s_nop 0
    s_bcnt1_i32_b32 s52, vcc_lo
    s_cmp_gt_u32 s14, 1048576
    s_cbranch_scc1 L_p1_n6D
    s_cmp_ge_u32 s52, 32
    s_cbranch_scc1 L_p1_n6D
    s_sleep 4
    s_branch L_p1_splD
L_code_end:
    s_endpgm
.section .rodata,"a"
.p2align 6
.amdhsa_kernel sequential_preLN__sliding_block__swiglu_ffn__prompt_kernel
  .amdhsa_next_free_vgpr 512
  .amdhsa_next_free_sgpr 102
  .amdhsa_accum_offset 256
  .amdhsa_group_segment_fixed_size 0
  .amdhsa_kernarg_size 80
  .amdhsa_user_sgpr_count 2
  .amdhsa_user_sgpr_kernarg_segment_ptr 1
  .amdhsa_system_sgpr_workgroup_id_x 1
  .amdhsa_float_denorm_mode_32 3
  .amdhsa_ieee_mode 0
.end_amdhsa_kernel
```
